```python
import torch

def _softmax(x, axis=-1):
    return torch.softmax(x, dim=axis)
def _gelu(x):
    return torch.nn.functional.gelu(x, approximate="tanh")
def _silu(x):
    return torch.nn.functional.silu(x)
def _sigmoid(x):
    return torch.sigmoid(x)
def _layernorm(x, axis=-1, eps=1e-5):
    m = x.mean(dim=axis, keepdim=True)
    v = x.var(dim=axis, keepdim=True, unbiased=False)
    return (x - m) / torch.sqrt(v + eps)
def _scatter_add(tgt, idx, src, axis=0):
    return tgt.clone().index_add_(axis, idx, src)
def _segment_sum(src, seg, n):
    out = torch.zeros((n,) + src.shape[1:], dtype=src.dtype)
    return out.index_add_(0, seg, src)
def _pad(x, pw):
    flat = tuple(v for pair in reversed(pw) for v in pair)
    return torch.nn.functional.pad(x, flat)

kernel_name = 'concat_heads__linear_attn_block__sliding_local_dilated__prompt'

def setup_inputs():

    _w = (lambda a: (lambda t: t.to(torch.bfloat16) if t.is_floating_point() else t)(torch.as_tensor(a)))
    def _A_setup():
        B, S, D = 1, 2048, 640
        return {
            "x": _w((lambda *s: torch.randn(*s, dtype=torch.bfloat16) * 0.05)(B, S, D)),
            "wqkv": _w((lambda *s: torch.randn(*s, dtype=torch.bfloat16) * 1.6)(D, 3 * D)),
            "wo": _w((lambda *s: torch.randn(*s, dtype=torch.bfloat16) * 0.8)(D, D)),
        }
    _A_in = _A_setup()

    def _B_setup():
        B, S, D = 1, 2048, 640
        return {
            "x": _w((lambda *s: torch.randn(*s, dtype=torch.bfloat16) * 0.2)(B, S, D)),
            "wqkv": _w((lambda *s: torch.randn(*s, dtype=torch.bfloat16) * 0.2)(D, 3 * D)),
            "wo": _w((lambda *s: torch.randn(*s, dtype=torch.bfloat16) * 0.05)(D, D)),
        }
    _B_in = _B_setup()

    return {
        "A_x": _A_in["x"],
        "A_wqkv": _A_in["wqkv"],
        "A_wo": _A_in["wo"],
        "B_x": _B_in["x"],
        "B_wqkv": _B_in["wqkv"],
        "B_wo": _B_in["wo"],
    }

def reference(A_x, A_wqkv, A_wo, B_x, B_wqkv, B_wo):
    def _A_ref(x, wqkv, wo):
        B, S, D = x.shape
        H = 32; Dh = D // H
        qkv = (lambda x, *d: x.permute(*d))((x @ wqkv).reshape(B, S, 3, H, Dh), 2, 0, 3, 1, 4)
        q, k, v = qkv[0], qkv[1], qkv[2]
        phi = lambda t: torch.where(t > 0, t + 1, torch.exp(t)) + 1e-6
        pq, pk = phi(q), phi(k)
        kv = torch.einsum("bhsd,bhse->bhde", pk, v)
        z = torch.einsum("bhsd->bhd", pk)
        num = torch.einsum("bhqd,bhde->bhqe", pq, kv)
        den = torch.einsum("bhqd,bhd->bhq", pq, z)[..., None] + 1e-6
        o = num / den
        return (lambda x, *d: x.permute(*d))(o, 0, 2, 1, 3).reshape(B, S, D) @ wo

    def _B_ref(x, wqkv, wo):
        B, S, D = x.shape
        H = 32; Dh = D // H
        W, dil = 8, 2
        qkv = (lambda x, *d: x.permute(*d))((x @ wqkv).reshape(B, S, 3, H, Dh), 2, 0, 3, 1, 4)
        q, k, v = qkv[0], qkv[1], qkv[2]
        scale = Dh ** -0.5
        pos = torch.arange(S)
        off = torch.arange(W) * dil
        idx = pos[:, None] - off[None, :]
        mask = idx >= 0
        idx_c = torch.where(mask, idx, 0).reshape(-1)
        kg = k[:, :, idx_c, :].reshape(B, H, S, W, Dh)
        vg = v[:, :, idx_c, :].reshape(B, H, S, W, Dh)
        logits = torch.einsum("bhsd,bhswd->bhsw", q, kg) * scale
        logits = torch.where(mask[None, None, :, :], logits, -1e9)
        attn = _softmax(logits, axis=-1)
        o = torch.einsum("bhsw,bhswd->bhsd", attn, vg)
        return (lambda x, *d: x.permute(*d))(o, 0, 2, 1, 3).reshape(B, S, D) @ wo

    a = _A_ref(A_x, A_wqkv, A_wo)
    b = _B_ref(B_x, B_wqkv, B_wo)
    return torch.concatenate([a, b], axis=-1)
```

```asm
; @launch grid=(256,1,1) block=(512,1,1) lds=158784
.amdgcn_target "amdgcn-amd-amdhsa--gfx950"
.text
.globl concat_heads__linear_attn_block__sliding_local_dilated__prompt_kernel
.p2align 8
.type concat_heads__linear_attn_block__sliding_local_dilated__prompt_kernel,@function
concat_heads__linear_attn_block__sliding_local_dilated__prompt_kernel:
    s_load_dwordx8 s[4:11], s[0:1], 0
    s_load_dwordx8 s[12:19], s[0:1], 32
    s_load_dwordx2 s[20:21], s[0:1], 64
    s_cmp_ge_u32 s2, 256
    s_cbranch_scc1 L_end
    s_getpc_b64 s[76:77]
Lpc0:
    s_lshr_b32 s78, s2, 5
    s_lshl_b32 s78, s78, 13
    v_lshlrev_b32 v183, 7, v0
    v_add_u32 v183, s78, v183
    v_cmp_gt_u32 vcc, 64, v0
    v_min_u32 v183, L_end-Lpc0, v183
    s_and_saveexec_b64 s[78:79], vcc
    s_cbranch_execz Lpc1
    global_load_dword v183, v183, s[76:77]
Lpc1:
    s_mov_b64 exec, -1
    s_bitcmp1_b32 s2, 2
    s_cbranch_scc1 L_B
    v_lshrrev_b32 v1, 6, v0
    v_and_b32 v0, 63, v0
    s_and_b32 s76, s2, 3
    v_readfirstlane_b32 s52, v1
    s_bfe_u32 s77, s2, 0x20003
    s_lshr_b32 s55, s2, 5
    s_lshl_b32 s54, s76, 2
    s_add_u32 s54, s54, s77
    s_and_b32 s53, s52, 3
    s_mov_b32 s57, 0
    s_cmp_lt_u32 s52, 4
    s_cbranch_scc1 L_AC
    s_setprio 3
    s_mul_i32 s77, s77, 3
    s_lshr_b32 s78, s55, 1
    s_mul_i32 s78, s78, 2
    s_add_u32 s77, s77, s78
    s_and_b32 s77, s77, 7
    s_mul_i32 s77, s77, 10
    s_mul_i32 s76, s76, 5
    s_add_u32 s77, s77, s76
    s_lshr_b32 s56, s77, 3
    s_cmp_ge_u32 s56, 10
    s_cselect_b32 s77, 10, 0
    s_sub_u32 s56, s56, s77
    s_lshl_b32 s76, s54, 2
    s_add_u32 s76, s76, s53
    s_mul_i32 s76, s76, 40960
    v_lshrrev_b32 v1, 3, v0
    v_and_b32 v2, 7, v0
    v_xor_b32 v2, v2, v1
    v_mul_u32_u24 v1, 1280, v1
    v_lshl_add_u32 v9, v2, 4, v1
    v_add_u32 v4, s76, v9
    v_add_u32 v5, 10240, v4
    v_add_u32 v6, 20480, v4
    v_add_u32 v7, 30720, v4
    s_lshl_b32 s72, s56, 7
    s_mul_i32 s78, s55, 160
    s_movk_i32 s58, 3840
    s_movk_i32 s59, -160
    s_mov_b32 s26, 2621440
    s_mov_b32 s27, 0x20000
    s_mov_b32 s30, 2457600
    s_mov_b32 s31, 0x20000
    s_waitcnt lgkmcnt(0)
    s_mov_b64 s[24:25], s[4:5]
    s_mov_b64 s[28:29], s[6:7]
    s_mul_i32 s69, s53, 12288
    s_add_u32 s69, s69, 102400
    s_add_u32 m0, s69, 0
    s_nop 0
    buffer_load_dwordx4 v4, s[24:27], s72 offen lds
    s_add_u32 m0, s69, 1024
    s_nop 0
    buffer_load_dwordx4 v5, s[24:27], s72 offen lds
    s_add_u32 m0, s69, 2048
    s_nop 0
    buffer_load_dwordx4 v6, s[24:27], s72 offen lds
    s_add_u32 m0, s69, 3072
    s_nop 0
    buffer_load_dwordx4 v7, s[24:27], s72 offen lds
    s_add_u32 s72, s72, 128
    s_cmp_eq_u32 s72, 1280
    s_cselect_b32 s72, 0, s72
    v_add_u32 v1, 0, v0
    v_mul_u32_u24 v2, 6554, v1
    v_lshrrev_b32 v2, 16, v2
    v_lshl_add_u32 v1, v1, 4, s78
    v_mad_i32_i24 v1, v2, s59, v1
    v_bfe_u32 v3, v2, 2, 2
    v_lshl_add_u32 v3, v3, 2, v2
    v_lshrrev_b32 v2, 4, v2
    v_mad_i32_i24 v3, v2, -12, v3
    v_mad_u32_u24 v8, v3, s58, v1
    v_add_u32 v1, 64, v0
    v_mul_u32_u24 v2, 6554, v1
    v_lshrrev_b32 v2, 16, v2
    v_lshl_add_u32 v1, v1, 4, s78
    v_mad_i32_i24 v1, v2, s59, v1
    v_bfe_u32 v3, v2, 2, 2
    v_lshl_add_u32 v3, v3, 2, v2
    v_lshrrev_b32 v2, 4, v2
    v_mad_i32_i24 v3, v2, -12, v3
    v_mad_u32_u24 v9, v3, s58, v1
    v_add_u32 v1, 128, v0
    v_mul_u32_u24 v2, 6554, v1
    v_lshrrev_b32 v2, 16, v2
    v_lshl_add_u32 v1, v1, 4, s78
    v_mad_i32_i24 v1, v2, s59, v1
    v_bfe_u32 v3, v2, 2, 2
    v_lshl_add_u32 v3, v3, 2, v2
    v_lshrrev_b32 v2, 4, v2
    v_mad_i32_i24 v3, v2, -12, v3
    v_mad_u32_u24 v10, v3, s58, v1
    v_add_u32 v1, 192, v0
    v_mul_u32_u24 v2, 6554, v1
    v_lshrrev_b32 v2, 16, v2
    v_lshl_add_u32 v1, v1, 4, s78
    v_mad_i32_i24 v1, v2, s59, v1
    v_bfe_u32 v3, v2, 2, 2
    v_lshl_add_u32 v3, v3, 2, v2
    v_lshrrev_b32 v2, 4, v2
    v_mad_i32_i24 v3, v2, -12, v3
    v_mad_u32_u24 v11, v3, s58, v1
    v_add_u32 v1, 256, v0
    v_mul_u32_u24 v2, 6554, v1
    v_lshrrev_b32 v2, 16, v2
    v_lshl_add_u32 v1, v1, 4, s78
    v_mad_i32_i24 v1, v2, s59, v1
    v_bfe_u32 v3, v2, 2, 2
    v_lshl_add_u32 v3, v3, 2, v2
    v_lshrrev_b32 v2, 4, v2
    v_mad_i32_i24 v3, v2, -12, v3
    v_mad_u32_u24 v12, v3, s58, v1
    s_lshr_b32 s76, s53, 1
    s_mul_i32 s68, s76, 5120
    s_mul_i32 s70, s76, 122880
    s_and_b32 s71, s53, 1
    s_mov_b32 s76, 0
    s_mov_b32 s77, 2130706432
    s_mov_b32 s78, 61440
    s_cmp_eq_u32 s71, 0
    s_cselect_b32 s76, 0, s76
    s_cselect_b32 s77, 1280, s77
    s_cselect_b32 s78, 20480, s78
    s_add_u32 s76, s76, s56
    s_cmp_ge_u32 s76, 10
    s_cselect_b32 s79, 10, 0
    s_sub_u32 s76, s76, s79
    s_mul_i32 s76, s76, 245760
    s_add_u32 s76, s76, s70
    s_add_u32 s73, s76, s77
    s_add_u32 s4, s78, s68
    s_add_u32 m0, s4, 0
    s_nop 0
    buffer_load_dwordx4 v8, s[28:31], s73 offen lds
    s_add_u32 m0, s4, 1024
    s_nop 0
    buffer_load_dwordx4 v9, s[28:31], s73 offen lds
    s_add_u32 m0, s4, 2048
    s_nop 0
    buffer_load_dwordx4 v10, s[28:31], s73 offen lds
    s_add_u32 m0, s4, 3072
    s_nop 0
    buffer_load_dwordx4 v11, s[28:31], s73 offen lds
    s_add_u32 m0, s4, 4096
    s_nop 0
    buffer_load_dwordx4 v12, s[28:31], s73 offen lds
    s_add_u32 m0, s69, 4096
    s_nop 0
    buffer_load_dwordx4 v4, s[24:27], s72 offen lds
    s_add_u32 m0, s69, 5120
    s_nop 0
    buffer_load_dwordx4 v5, s[24:27], s72 offen lds
    s_add_u32 m0, s69, 6144
    s_nop 0
    buffer_load_dwordx4 v6, s[24:27], s72 offen lds
    s_add_u32 m0, s69, 7168
    s_nop 0
    buffer_load_dwordx4 v7, s[24:27], s72 offen lds
    s_add_u32 s72, s72, 128
    s_cmp_eq_u32 s72, 1280
    s_cselect_b32 s72, 0, s72
    s_mov_b32 s76, 0
    s_mov_b32 s77, 2130706432
    s_mov_b32 s78, 71680
    s_cmp_eq_u32 s71, 0
    s_cselect_b32 s76, 1, s76
    s_cselect_b32 s77, 1280, s77
    s_cselect_b32 s78, 40960, s78
    s_add_u32 s76, s76, s56
    s_cmp_ge_u32 s76, 10
    s_cselect_b32 s79, 10, 0
    s_sub_u32 s76, s76, s79
    s_mul_i32 s76, s76, 245760
    s_add_u32 s76, s76, s70
    s_add_u32 s73, s76, s77
    s_add_u32 s4, s78, s68
    s_add_u32 m0, s4, 0
    s_nop 0
    buffer_load_dwordx4 v8, s[28:31], s73 offen lds
    s_add_u32 m0, s4, 1024
    s_nop 0
    buffer_load_dwordx4 v9, s[28:31], s73 offen lds
    s_add_u32 m0, s4, 2048
    s_nop 0
    buffer_load_dwordx4 v10, s[28:31], s73 offen lds
    s_add_u32 m0, s4, 3072
    s_nop 0
    buffer_load_dwordx4 v11, s[28:31], s73 offen lds
    s_add_u32 m0, s4, 4096
    s_nop 0
    buffer_load_dwordx4 v12, s[28:31], s73 offen lds
    s_mov_b32 s32, s8
    s_mov_b32 s33, s9
    s_mov_b32 s34, 819200
    s_mov_b32 s35, 0x20000
    s_mov_b32 s48, s16
    s_mov_b32 s49, s17
    s_mov_b32 s50, 5242880
    s_mov_b32 s51, 0x20000
    s_mov_b32 s44, s18
    s_mov_b32 s45, s19
    s_mov_b32 s46, 256
    s_mov_b32 s47, 0x20000
    s_mov_b32 s36, s20
    s_mov_b32 s37, s21
    s_mov_b32 s38, 8388608
    s_mov_b32 s39, 0x20000
    s_mov_b32 s23, 40960
    s_mul_i32 s20, s53, 5120
    s_mul_i32 s21, s53, 51200
    s_mul_i32 s22, s53, 204800
    s_getreg_b32 s76, hwreg(HW_REG_XCC_ID, 0, 3)
    s_lshl_b32 s76, s76, 2
    s_lshl_b32 s99, 1, s76
    s_lshl_b32 s98, 8, s76
    s_lshr_b32 s93, s55, 2
    s_xor_b32 s93, s93, 0
    s_lshl_b32 s92, s54, 3
    s_lshl_b32 s76, s53, 1
    s_add_u32 s92, s92, s76
    s_mul_i32 s92, s92, 40960
    s_add_u32 s92, s92, 0
    s_lshl_b32 s97, s54, 2
    s_add_u32 s19, s97, s53
    s_lshl_b32 s19, s19, 7
    s_add_u32 s19, s19, 6815744
    s_add_u32 s97, s97, 32
    s_mov_b32 s76, 40960
    s_mov_b32 s77, 61440
    s_cmp_eq_u32 s93, 0
    s_cselect_b32 s78, 0, s76
    s_cselect_b32 s79, 20480, s77
    s_add_u32 s76, s55, 0
    s_and_b32 s76, s76, 3
    s_lshl_b32 s77, s93, 2
    s_add_u32 s77, s77, s76
    s_mul_i32 s82, s77, 5120
    s_cmp_ge_u32 s76, 2
    s_cselect_b32 s77, s79, s78
    s_and_b32 s76, s76, 1
    s_mul_i32 s76, s76, 10240
    s_add_u32 s87, s77, s76
    s_add_u32 s76, s55, 1
    s_and_b32 s76, s76, 3
    s_lshl_b32 s77, s93, 2
    s_add_u32 s77, s77, s76
    s_mul_i32 s83, s77, 5120
    s_cmp_ge_u32 s76, 2
    s_cselect_b32 s77, s79, s78
    s_and_b32 s76, s76, 1
    s_mul_i32 s76, s76, 10240
    s_add_u32 s88, s77, s76
    s_add_u32 s76, s55, 2
    s_and_b32 s76, s76, 3
    s_lshl_b32 s77, s93, 2
    s_add_u32 s77, s77, s76
    s_mul_i32 s84, s77, 5120
    s_cmp_ge_u32 s76, 2
    s_cselect_b32 s77, s79, s78
    s_and_b32 s76, s76, 1
    s_mul_i32 s76, s76, 10240
    s_add_u32 s89, s77, s76
    s_add_u32 s76, s55, 3
    s_and_b32 s76, s76, 3
    s_lshl_b32 s77, s93, 2
    s_add_u32 s77, s77, s76
    s_mul_i32 s85, s77, 5120
    s_cmp_ge_u32 s76, 2
    s_cselect_b32 s77, s79, s78
    s_and_b32 s76, s76, 1
    s_mul_i32 s76, s76, 10240
    s_add_u32 s90, s77, s76
    s_mul_i32 s76, s93, 10240
    s_add_u32 s91, s76, 81920
    s_mul_i32 s86, s93, 20480
    s_xor_b32 s79, s52, 4
    s_mul_i32 s94, s52, 5120
    s_add_u32 s94, s94, 102400
    s_mul_i32 s95, s79, 5120
    s_add_u32 s95, s95, 102400
    s_lshl_b32 s76, s54, 7
    s_lshl_b32 s78, s53, 5
    s_add_u32 s76, s76, s78
    s_add_u32 s76, s76, 16
    s_mul_i32 s76, s76, 2560
    s_mul_i32 s78, s55, 160
    s_add_u32 s76, s76, s78
    s_add_u32 s96, s76, 0
    s_lshl_b32 s76, s55, 2
    v_lshlrev_b32 v1, 2, v0
    v_add_u32 v2, 28, v1
    v_add_u32 v2, s76, v2
    v_cmp_eq_u32 vcc, 0, v0
    s_nop 1
    v_cndmask_b32 v1, v2, v1, vcc
    v_add_u32 v1, s76, v1
    v_mov_b32 v2, 0
    s_mov_b64 exec, 7
    buffer_store_dword v2, v1, s[36:39], s19 offen sc1
    s_mov_b64 exec, -1
    s_lshl_b32 s76, s55, 4
    s_add_u32 s76, s76, s54
    s_lshl_b32 s76, s76, 12
    s_add_u32 s76, s76, 6291456
    s_lshl_b32 s77, s53, 6
    v_add_u32 v1, s77, v0
    v_mul_u32_u24 v2, 1171, v1
    v_lshrrev_b32 v2, 16, v2
    v_lshlrev_b32 v1, 4, v1
    v_mul_u32_u24 v3, 896, v2
    v_sub_u32 v3, v1, v3
    v_cmp_gt_u32 s[6:7], 4, v2
    v_cmp_gt_u32 vcc, 840, v3
    s_nop 0
    s_and_b64 s[8:9], vcc, s[6:7]
    v_cmp_gt_u32 vcc, 832, v3
    s_nop 0
    s_and_b64 s[6:7], vcc, s[6:7]
    s_lshl_b32 s5, s55, 2
    s_add_u32 s5, s5, 0
    v_cndmask_b32 v28, 0, -1, s[8:9]
    v_cndmask_b32 v29, 0, -1, s[8:9]
    v_cndmask_b32 v30, 0, -1, s[6:7]
    v_cndmask_b32 v31, 0, -1, s[6:7]
    buffer_store_dwordx4 v[28:31], v1, s[36:39], s76 offen sc1
    s_mul_i32 s77, s55, 5120
    s_add_u32 s77, s77, s92
    v_lshlrev_b32 v1, 4, v0
    v_add_u32 v23, s77, v1
    s_add_u32 s77, s77, 1024
    v_lshrrev_b32 v1, 5, v0
    v_mul_u32_u24 v1, 2304, v1
    v_lshl_add_u32 v1, v0, 3, v1
    v_add_u32 v24, s77, v1
    v_and_b32 v1, 15, v0
    v_lshrrev_b32 v2, 4, v0
    v_and_b32 v3, 7, v0
    v_xor_b32 v2, v2, v3
    v_lshlrev_b32 v1, 7, v1
    v_lshl_add_u32 v1, v2, 4, v1
    v_add_u32 v13, s69, v1
    v_xor_b32 v14, 64, v13
    s_mov_b32 s60, 0xffff
    s_mov_b32 s61, 0x0
    s_mov_b32 s62, 0xffff0000
    s_mov_b32 s63, 0x0
    s_mov_b32 s64, 0x0
    s_mov_b32 s65, 0xffff
    s_mov_b32 s66, 0x0
    s_mov_b32 s67, 0xffff0000
    v_lshrrev_b32 v1, 2, v0
    v_mul_u32_u24 v1, 160, v1
    v_and_b32 v2, 3, v0
    v_lshl_add_u32 v15, v2, 3, v1
    v_mul_u32_u24 v2, 40, v2
    v_add3_u32 v17, v1, v2, 32
    v_add_u32 v16, 61440, v15
    v_add_u32 v18, 61440, v17
    v_and_b32 v1, 15, v0
    v_lshrrev_b32 v2, 4, v0
    v_lshlrev_b32 v19, 3, v0
    v_add_u32 v19, 102400, v19
    v_lshlrev_b32 v20, 3, v1
    v_add_u32 v20, 102912, v20
    v_lshrrev_b32 v3, 2, v1
    v_and_b32 v1, 3, v1
    v_cmp_eq_u32 vcc, 0, v1
    s_nop 1
    v_cndmask_b32 v3, 4, v3, vcc
    v_lshlrev_b32 v3, 3, v3
    v_add_u32 v22, 103200, v3
    v_mul_u32_u24 v2, 40, v2
    v_add_u32 v21, v2, v3
    v_add_u32 v21, 103040, v21
    s_mov_b32 s74, 0x3fb8aa3b
    s_mov_b32 s75, 0x358637bd
    v_mov_b32 v28, 0x358637bd
    v_mov_b32 v29, 0x358637bd
    v_mov_b32 v30, 0x358637bd
    v_mov_b32 v31, 0x358637bd
    s_waitcnt vmcnt(11)
    s_barrier
    ds_read_b128 a[24:27], v13 offset:0
    ds_read_b128 a[28:31], v13 offset:2048
    ds_read_b128 a[32:35], v14 offset:0
    ds_read_b128 a[36:39], v14 offset:2048
    s_add_u32 m0, s69, 8192
    s_nop 0
    buffer_load_dwordx4 v4, s[24:27], s72 offen lds
    s_add_u32 m0, s69, 9216
    s_nop 0
    buffer_load_dwordx4 v5, s[24:27], s72 offen lds
    s_add_u32 m0, s69, 10240
    s_nop 0
    buffer_load_dwordx4 v6, s[24:27], s72 offen lds
    s_add_u32 m0, s69, 11264
    s_nop 0
    buffer_load_dwordx4 v7, s[24:27], s72 offen lds
    s_add_u32 s72, s72, 128
    s_cmp_eq_u32 s72, 1280
    s_cselect_b32 s72, 0, s72
    s_mov_b32 s76, 0
    s_mov_b32 s77, 2560
    s_mov_b32 s78, 81920
    s_cmp_eq_u32 s71, 0
    s_cselect_b32 s76, 2, s76
    s_cselect_b32 s77, 1280, s77
    s_cselect_b32 s78, 0, s78
    s_add_u32 s76, s76, s56
    s_cmp_ge_u32 s76, 10
    s_cselect_b32 s79, 10, 0
    s_sub_u32 s76, s76, s79
    s_mul_i32 s76, s76, 245760
    s_add_u32 s76, s76, s70
    s_add_u32 s73, s76, s77
    s_add_u32 s4, s78, s68
    s_add_u32 m0, s4, 0
    s_nop 0
    buffer_load_dwordx4 v8, s[28:31], s73 offen lds
    s_add_u32 m0, s4, 1024
    s_nop 0
    buffer_load_dwordx4 v9, s[28:31], s73 offen lds
    s_add_u32 m0, s4, 2048
    s_nop 0
    buffer_load_dwordx4 v10, s[28:31], s73 offen lds
    s_add_u32 m0, s4, 3072
    s_nop 0
    buffer_load_dwordx4 v11, s[28:31], s73 offen lds
    s_add_u32 m0, s4, 4096
    s_nop 0
    buffer_load_dwordx4 v12, s[28:31], s73 offen lds
    s_waitcnt vmcnt(11) lgkmcnt(0)
    s_barrier
    ds_read_b128 a[40:43], v13 offset:4096
    ds_read_b128 a[44:47], v13 offset:6144
    ds_read_b128 a[48:51], v14 offset:4096
    ds_read_b128 a[52:55], v14 offset:6144
    s_add_u32 m0, s69, 0
    s_nop 0
    buffer_load_dwordx4 v4, s[24:27], s72 offen lds
    s_add_u32 m0, s69, 1024
    s_nop 0
    buffer_load_dwordx4 v5, s[24:27], s72 offen lds
    s_add_u32 m0, s69, 2048
    s_nop 0
    buffer_load_dwordx4 v6, s[24:27], s72 offen lds
    s_add_u32 m0, s69, 3072
    s_nop 0
    buffer_load_dwordx4 v7, s[24:27], s72 offen lds
    s_add_u32 s72, s72, 128
    s_cmp_eq_u32 s72, 1280
    s_cselect_b32 s72, 0, s72
    s_mov_b32 s76, 1
    s_mov_b32 s77, 2560
    s_mov_b32 s78, 92160
    s_cmp_eq_u32 s71, 0
    s_cselect_b32 s76, 3, s76
    s_cselect_b32 s77, 1280, s77
    s_cselect_b32 s78, 10240, s78
    s_add_u32 s76, s76, s56
    s_cmp_ge_u32 s76, 10
    s_cselect_b32 s79, 10, 0
    s_sub_u32 s76, s76, s79
    s_mul_i32 s76, s76, 245760
    s_add_u32 s76, s76, s70
    s_add_u32 s73, s76, s77
    s_add_u32 s4, s78, s68
    s_add_u32 m0, s4, 0
    s_nop 0
    buffer_load_dwordx4 v8, s[28:31], s73 offen lds
    s_add_u32 m0, s4, 1024
    s_nop 0
    buffer_load_dwordx4 v9, s[28:31], s73 offen lds
    s_add_u32 m0, s4, 2048
    s_nop 0
    buffer_load_dwordx4 v10, s[28:31], s73 offen lds
    s_add_u32 m0, s4, 3072
    s_nop 0
    buffer_load_dwordx4 v11, s[28:31], s73 offen lds
    s_add_u32 m0, s4, 4096
    s_nop 0
    buffer_load_dwordx4 v12, s[28:31], s73 offen lds
    s_waitcnt vmcnt(9) lgkmcnt(0)
    s_barrier
    ds_read_b128 a[56:59], v13 offset:8192
    ds_read_b128 a[60:63], v13 offset:10240
    ds_read_b128 a[64:67], v14 offset:8192
    ds_read_b128 a[68:71], v14 offset:10240
    s_add_u32 m0, s69, 4096
    s_nop 0
    buffer_load_dwordx4 v4, s[24:27], s72 offen lds
    s_add_u32 m0, s69, 5120
    s_nop 0
    buffer_load_dwordx4 v5, s[24:27], s72 offen lds
    s_add_u32 m0, s69, 6144
    s_nop 0
    buffer_load_dwordx4 v6, s[24:27], s72 offen lds
    s_add_u32 m0, s69, 7168
    s_nop 0
    buffer_load_dwordx4 v7, s[24:27], s72 offen lds
    s_add_u32 s72, s72, 128
    s_cmp_eq_u32 s72, 1280
    s_cselect_b32 s72, 0, s72
    s_mov_b32 s76, 2
    s_mov_b32 s77, 2560
    s_mov_b32 s78, 30720
    s_cmp_eq_u32 s71, 0
    s_cselect_b32 s76, 4, s76
    s_cselect_b32 s77, 1280, s77
    s_cselect_b32 s78, 20480, s78
    s_add_u32 s76, s76, s56
    s_cmp_ge_u32 s76, 10
    s_cselect_b32 s79, 10, 0
    s_sub_u32 s76, s76, s79
    s_mul_i32 s76, s76, 245760
    s_add_u32 s76, s76, s70
    s_add_u32 s73, s76, s77
    s_add_u32 s4, s78, s68
    s_add_u32 m0, s4, 0
    s_nop 0
    buffer_load_dwordx4 v8, s[28:31], s73 offen lds
    s_add_u32 m0, s4, 1024
    s_nop 0
    buffer_load_dwordx4 v9, s[28:31], s73 offen lds
    s_add_u32 m0, s4, 2048
    s_nop 0
    buffer_load_dwordx4 v10, s[28:31], s73 offen lds
    s_add_u32 m0, s4, 3072
    s_nop 0
    buffer_load_dwordx4 v11, s[28:31], s73 offen lds
    s_add_u32 m0, s4, 4096
    s_nop 0
    buffer_load_dwordx4 v12, s[28:31], s73 offen lds
    s_cmp_eq_u32 s53, 0
    s_cbranch_scc0 LA_sig
    s_lshl_b32 s77, s55, 2
    s_add_u32 s77, s77, 0
    v_mov_b32 v1, s97
    v_mov_b32 v2, s77
    v_cmp_eq_u32 vcc, 0, v0
    s_nop 1
    v_cndmask_b32 v1, v2, v1, vcc
    v_mov_b32 v2, s99
    v_cndmask_b32 v2, 1, v2, vcc
    s_mov_b64 exec, 3
    buffer_atomic_add v2, v1, s[44:47], 0 offen sc1
    s_mov_b64 exec, -1
LA_sig:
    s_waitcnt vmcnt(9) lgkmcnt(0)
    s_barrier
    ds_read_b128 v[72:75], v13 offset:0
    ds_read_b128 v[76:79], v13 offset:2048
    ds_read_b128 v[80:83], v14 offset:0
    ds_read_b128 v[84:87], v14 offset:2048
    s_add_u32 m0, s69, 8192
    s_nop 0
    buffer_load_dwordx4 v4, s[24:27], s72 offen lds
    s_add_u32 m0, s69, 9216
    s_nop 0
    buffer_load_dwordx4 v5, s[24:27], s72 offen lds
    s_add_u32 m0, s69, 10240
    s_nop 0
    buffer_load_dwordx4 v6, s[24:27], s72 offen lds
    s_add_u32 m0, s69, 11264
    s_nop 0
    buffer_load_dwordx4 v7, s[24:27], s72 offen lds
    s_add_u32 s72, s72, 128
    s_cmp_eq_u32 s72, 1280
    s_cselect_b32 s72, 0, s72
    s_mov_b32 s76, 3
    s_mov_b32 s77, 2560
    s_mov_b32 s78, 51200
    s_cmp_eq_u32 s71, 0
    s_cselect_b32 s76, 5, s76
    s_cselect_b32 s77, 1280, s77
    s_cselect_b32 s78, 40960, s78
    s_add_u32 s76, s76, s56
    s_cmp_ge_u32 s76, 10
    s_cselect_b32 s79, 10, 0
    s_sub_u32 s76, s76, s79
    s_mul_i32 s76, s76, 245760
    s_add_u32 s76, s76, s70
    s_add_u32 s73, s76, s77
    s_add_u32 s4, s78, s68
    s_add_u32 m0, s4, 0
    s_nop 0
    buffer_load_dwordx4 v8, s[28:31], s73 offen lds
    s_add_u32 m0, s4, 1024
    s_nop 0
    buffer_load_dwordx4 v9, s[28:31], s73 offen lds
    s_add_u32 m0, s4, 2048
    s_nop 0
    buffer_load_dwordx4 v10, s[28:31], s73 offen lds
    s_add_u32 m0, s4, 3072
    s_nop 0
    buffer_load_dwordx4 v11, s[28:31], s73 offen lds
    s_add_u32 m0, s4, 4096
    s_nop 0
    buffer_load_dwordx4 v12, s[28:31], s73 offen lds
    s_waitcnt vmcnt(9) lgkmcnt(0)
    s_barrier
    ds_read_b128 v[88:91], v13 offset:4096
    ds_read_b128 v[92:95], v13 offset:6144
    ds_read_b128 v[96:99], v14 offset:4096
    ds_read_b128 v[100:103], v14 offset:6144
    s_add_u32 m0, s69, 0
    s_nop 0
    buffer_load_dwordx4 v4, s[24:27], s72 offen lds
    s_add_u32 m0, s69, 1024
    s_nop 0
    buffer_load_dwordx4 v5, s[24:27], s72 offen lds
    s_add_u32 m0, s69, 2048
    s_nop 0
    buffer_load_dwordx4 v6, s[24:27], s72 offen lds
    s_add_u32 m0, s69, 3072
    s_nop 0
    buffer_load_dwordx4 v7, s[24:27], s72 offen lds
    s_add_u32 s72, s72, 128
    s_cmp_eq_u32 s72, 1280
    s_cselect_b32 s72, 0, s72
    s_mov_b32 s76, 4
    s_mov_b32 s77, 2560
    s_mov_b32 s78, 81920
    s_cmp_eq_u32 s71, 0
    s_cselect_b32 s76, 6, s76
    s_cselect_b32 s77, 1280, s77
    s_cselect_b32 s78, 0, s78
    s_add_u32 s76, s76, s56
    s_cmp_ge_u32 s76, 10
    s_cselect_b32 s79, 10, 0
    s_sub_u32 s76, s76, s79
    s_mul_i32 s76, s76, 245760
    s_add_u32 s76, s76, s70
    s_add_u32 s73, s76, s77
    s_add_u32 s4, s78, s68
    s_add_u32 m0, s4, 0
    s_nop 0
    buffer_load_dwordx4 v8, s[28:31], s73 offen lds
    s_add_u32 m0, s4, 1024
    s_nop 0
    buffer_load_dwordx4 v9, s[28:31], s73 offen lds
    s_add_u32 m0, s4, 2048
    s_nop 0
    buffer_load_dwordx4 v10, s[28:31], s73 offen lds
    s_add_u32 m0, s4, 3072
    s_nop 0
    buffer_load_dwordx4 v11, s[28:31], s73 offen lds
    s_add_u32 m0, s4, 4096
    s_nop 0
    buffer_load_dwordx4 v12, s[28:31], s73 offen lds
    s_waitcnt vmcnt(9) lgkmcnt(0)
    s_barrier
    ds_read_b128 v[104:107], v13 offset:8192
    ds_read_b128 v[108:111], v13 offset:10240
    ds_read_b128 v[112:115], v14 offset:8192
    ds_read_b128 v[116:119], v14 offset:10240
    s_add_u32 m0, s69, 4096
    s_nop 0
    buffer_load_dwordx4 v4, s[24:27], s72 offen lds
    s_add_u32 m0, s69, 5120
    s_nop 0
    buffer_load_dwordx4 v5, s[24:27], s72 offen lds
    s_add_u32 m0, s69, 6144
    s_nop 0
    buffer_load_dwordx4 v6, s[24:27], s72 offen lds
    s_add_u32 m0, s69, 7168
    s_nop 0
    buffer_load_dwordx4 v7, s[24:27], s72 offen lds
    s_add_u32 s72, s72, 128
    s_cmp_eq_u32 s72, 1280
    s_cselect_b32 s72, 0, s72
    s_mov_b32 s76, 5
    s_mov_b32 s77, 2560
    s_mov_b32 s78, 92160
    s_cmp_eq_u32 s71, 0
    s_cselect_b32 s76, 7, s76
    s_cselect_b32 s77, 1280, s77
    s_cselect_b32 s78, 10240, s78
    s_add_u32 s76, s76, s56
    s_cmp_ge_u32 s76, 10
    s_cselect_b32 s79, 10, 0
    s_sub_u32 s76, s76, s79
    s_mul_i32 s76, s76, 245760
    s_add_u32 s76, s76, s70
    s_add_u32 s73, s76, s77
    s_add_u32 s4, s78, s68
    s_add_u32 m0, s4, 0
    s_nop 0
    buffer_load_dwordx4 v8, s[28:31], s73 offen lds
    s_add_u32 m0, s4, 1024
    s_nop 0
    buffer_load_dwordx4 v9, s[28:31], s73 offen lds
    s_add_u32 m0, s4, 2048
    s_nop 0
    buffer_load_dwordx4 v10, s[28:31], s73 offen lds
    s_add_u32 m0, s4, 3072
    s_nop 0
    buffer_load_dwordx4 v11, s[28:31], s73 offen lds
    s_add_u32 m0, s4, 4096
    s_nop 0
    buffer_load_dwordx4 v12, s[28:31], s73 offen lds
    s_waitcnt vmcnt(9) lgkmcnt(0)
    s_barrier
    ds_read_b128 v[120:123], v13 offset:0
    ds_read_b128 v[124:127], v13 offset:2048
    ds_read_b128 v[128:131], v14 offset:0
    ds_read_b128 v[132:135], v14 offset:2048
    s_add_u32 m0, s69, 8192
    s_nop 0
    buffer_load_dwordx4 v4, s[24:27], s72 offen lds
    s_add_u32 m0, s69, 9216
    s_nop 0
    buffer_load_dwordx4 v5, s[24:27], s72 offen lds
    s_add_u32 m0, s69, 10240
    s_nop 0
    buffer_load_dwordx4 v6, s[24:27], s72 offen lds
    s_add_u32 m0, s69, 11264
    s_nop 0
    buffer_load_dwordx4 v7, s[24:27], s72 offen lds
    s_add_u32 s72, s72, 128
    s_cmp_eq_u32 s72, 1280
    s_cselect_b32 s72, 0, s72
    s_mov_b32 s76, 6
    s_mov_b32 s77, 2560
    s_mov_b32 s78, 30720
    s_cmp_eq_u32 s71, 0
    s_cselect_b32 s76, 8, s76
    s_cselect_b32 s77, 1280, s77
    s_cselect_b32 s78, 20480, s78
    s_add_u32 s76, s76, s56
    s_cmp_ge_u32 s76, 10
    s_cselect_b32 s79, 10, 0
    s_sub_u32 s76, s76, s79
    s_mul_i32 s76, s76, 245760
    s_add_u32 s76, s76, s70
    s_add_u32 s73, s76, s77
    s_add_u32 s4, s78, s68
    s_add_u32 m0, s4, 0
    s_nop 0
    buffer_load_dwordx4 v8, s[28:31], s73 offen lds
    s_add_u32 m0, s4, 1024
    s_nop 0
    buffer_load_dwordx4 v9, s[28:31], s73 offen lds
    s_add_u32 m0, s4, 2048
    s_nop 0
    buffer_load_dwordx4 v10, s[28:31], s73 offen lds
    s_add_u32 m0, s4, 3072
    s_nop 0
    buffer_load_dwordx4 v11, s[28:31], s73 offen lds
    s_add_u32 m0, s4, 4096
    s_nop 0
    buffer_load_dwordx4 v12, s[28:31], s73 offen lds
    s_waitcnt vmcnt(9) lgkmcnt(0)
    s_barrier
    ds_read_b128 v[136:139], v13 offset:4096
    ds_read_b128 v[140:143], v13 offset:6144
    ds_read_b128 v[144:147], v14 offset:4096
    ds_read_b128 v[148:151], v14 offset:6144
    s_add_u32 m0, s69, 0
    s_nop 0
    buffer_load_dwordx4 v4, s[24:27], s72 offen lds
    s_add_u32 m0, s69, 1024
    s_nop 0
    buffer_load_dwordx4 v5, s[24:27], s72 offen lds
    s_add_u32 m0, s69, 2048
    s_nop 0
    buffer_load_dwordx4 v6, s[24:27], s72 offen lds
    s_add_u32 m0, s69, 3072
    s_nop 0
    buffer_load_dwordx4 v7, s[24:27], s72 offen lds
    s_add_u32 s72, s72, 128
    s_cmp_eq_u32 s72, 1280
    s_cselect_b32 s72, 0, s72
    s_mov_b32 s76, 7
    s_mov_b32 s77, 2560
    s_mov_b32 s78, 51200
    s_cmp_eq_u32 s71, 0
    s_cselect_b32 s76, 9, s76
    s_cselect_b32 s77, 1280, s77
    s_cselect_b32 s78, 40960, s78
    s_add_u32 s76, s76, s56
    s_cmp_ge_u32 s76, 10
    s_cselect_b32 s79, 10, 0
    s_sub_u32 s76, s76, s79
    s_mul_i32 s76, s76, 245760
    s_add_u32 s76, s76, s70
    s_add_u32 s73, s76, s77
    s_add_u32 s4, s78, s68
    s_add_u32 m0, s4, 0
    s_nop 0
    buffer_load_dwordx4 v8, s[28:31], s73 offen lds
    s_add_u32 m0, s4, 1024
    s_nop 0
    buffer_load_dwordx4 v9, s[28:31], s73 offen lds
    s_add_u32 m0, s4, 2048
    s_nop 0
    buffer_load_dwordx4 v10, s[28:31], s73 offen lds
    s_add_u32 m0, s4, 3072
    s_nop 0
    buffer_load_dwordx4 v11, s[28:31], s73 offen lds
    s_add_u32 m0, s4, 4096
    s_nop 0
    buffer_load_dwordx4 v12, s[28:31], s73 offen lds
    s_waitcnt vmcnt(9) lgkmcnt(0)
    s_barrier
    ds_read_b128 v[152:155], v13 offset:8192
    ds_read_b128 v[156:159], v13 offset:10240
    ds_read_b128 v[160:163], v14 offset:8192
    ds_read_b128 v[164:167], v14 offset:10240
    s_mov_b32 s76, 8
    s_mov_b32 s77, 2560
    s_mov_b32 s78, 81920
    s_cmp_eq_u32 s71, 0
    s_cselect_b32 s76, 0, s76
    s_cselect_b32 s77, 0, s77
    s_cselect_b32 s78, 0, s78
    s_add_u32 s76, s76, s56
    s_cmp_ge_u32 s76, 10
    s_cselect_b32 s79, 10, 0
    s_sub_u32 s76, s76, s79
    s_mul_i32 s76, s76, 245760
    s_add_u32 s76, s76, s70
    s_add_u32 s73, s76, s77
    s_add_u32 s4, s78, s68
    s_add_u32 m0, s4, 0
    s_nop 0
    buffer_load_dwordx4 v8, s[28:31], s73 offen lds
    s_add_u32 m0, s4, 1024
    s_nop 0
    buffer_load_dwordx4 v9, s[28:31], s73 offen lds
    s_add_u32 m0, s4, 2048
    s_nop 0
    buffer_load_dwordx4 v10, s[28:31], s73 offen lds
    s_add_u32 m0, s4, 3072
    s_nop 0
    buffer_load_dwordx4 v11, s[28:31], s73 offen lds
    s_add_u32 m0, s4, 4096
    s_nop 0
    buffer_load_dwordx4 v12, s[28:31], s73 offen lds
    buffer_load_dword v2, off, s[44:47], s97 sc1
    buffer_load_dword v3, off, s[44:47], s5 sc1
    s_waitcnt vmcnt(7) lgkmcnt(0)
    s_barrier
    ds_read_b128 v[168:171], v13 offset:0
    ds_read_b128 v[172:175], v13 offset:2048
    ds_read_b128 v[176:179], v14 offset:0
    ds_read_b128 v[180:183], v14 offset:2048
    s_mov_b32 s76, 9
    s_mov_b32 s77, 2560
    s_mov_b32 s78, 92160
    s_cmp_eq_u32 s71, 0
    s_cselect_b32 s76, 1, s76
    s_cselect_b32 s77, 0, s77
    s_cselect_b32 s78, 10240, s78
    s_add_u32 s76, s76, s56
    s_cmp_ge_u32 s76, 10
    s_cselect_b32 s79, 10, 0
    s_sub_u32 s76, s76, s79
    s_mul_i32 s76, s76, 245760
    s_add_u32 s76, s76, s70
    s_add_u32 s73, s76, s77
    s_add_u32 s4, s78, s68
    s_add_u32 m0, s4, 0
    s_nop 0
    buffer_load_dwordx4 v8, s[28:31], s73 offen lds
    s_add_u32 m0, s4, 1024
    s_nop 0
    buffer_load_dwordx4 v9, s[28:31], s73 offen lds
    s_add_u32 m0, s4, 2048
    s_nop 0
    buffer_load_dwordx4 v10, s[28:31], s73 offen lds
    s_add_u32 m0, s4, 3072
    s_nop 0
    buffer_load_dwordx4 v11, s[28:31], s73 offen lds
    s_add_u32 m0, s4, 4096
    s_nop 0
    buffer_load_dwordx4 v12, s[28:31], s73 offen lds
    s_waitcnt vmcnt(7) lgkmcnt(0)
    s_barrier
    s_mov_b32 s76, 3
    s_mov_b32 s77, 0
    s_mov_b32 s78, 30720
    s_cmp_eq_u32 s71, 0
    s_cselect_b32 s76, 2, s76
    s_cselect_b32 s77, 0, s77
    s_cselect_b32 s78, 20480, s78
    s_add_u32 s76, s76, s56
    s_cmp_ge_u32 s76, 10
    s_cselect_b32 s79, 10, 0
    s_sub_u32 s76, s76, s79
    s_mul_i32 s76, s76, 245760
    s_add_u32 s76, s76, s70
    s_add_u32 s73, s76, s77
    s_add_u32 s4, s78, s68
    s_add_u32 m0, s4, 0
    s_nop 0
    buffer_load_dwordx4 v8, s[28:31], s73 offen lds
    s_add_u32 m0, s4, 1024
    s_nop 0
    buffer_load_dwordx4 v9, s[28:31], s73 offen lds
    s_add_u32 m0, s4, 2048
    s_nop 0
    buffer_load_dwordx4 v10, s[28:31], s73 offen lds
    s_add_u32 m0, s4, 3072
    s_nop 0
    buffer_load_dwordx4 v11, s[28:31], s73 offen lds
    s_add_u32 m0, s4, 4096
    s_nop 0
    buffer_load_dwordx4 v12, s[28:31], s73 offen lds
    s_waitcnt vmcnt(5)
    s_barrier
    v_readfirstlane_b32 s80, v2
    s_mov_b32 s11, 0
LA_cnt:
    v_readfirstlane_b32 s76, v3
    s_nop 0
    s_cmp_ge_u32 s76, 16
    s_cbranch_scc1 LA_cnt_ok
    buffer_load_dword v3, off, s[44:47], s5 sc1
    s_waitcnt vmcnt(0)
    s_add_u32 s11, s11, 1
    s_cmp_lt_u32 s11, 32768
    s_cbranch_scc1 LA_cnt
LA_cnt_ok:
    v_add_u32 v4, 135168, v15
    v_add_u32 v5, 135168, v17
    s_mov_b32 s76, 5
    s_mov_b32 s77, 0
    s_mov_b32 s78, 51200
    s_cmp_eq_u32 s71, 0
    s_cselect_b32 s76, 4, s76
    s_cselect_b32 s77, 0, s77
    s_cselect_b32 s78, 40960, s78
    s_add_u32 s76, s76, s56
    s_cmp_ge_u32 s76, 10
    s_cselect_b32 s79, 10, 0
    s_sub_u32 s76, s76, s79
    s_mul_i32 s76, s76, 245760
    s_add_u32 s76, s76, s70
    s_add_u32 s73, s76, s77
    s_add_u32 s4, s78, s68
    s_add_u32 m0, s4, 0
    s_nop 0
    buffer_load_dwordx4 v8, s[28:31], s73 offen lds
    s_add_u32 m0, s4, 1024
    s_nop 0
    buffer_load_dwordx4 v9, s[28:31], s73 offen lds
    s_add_u32 m0, s4, 2048
    s_nop 0
    buffer_load_dwordx4 v10, s[28:31], s73 offen lds
    s_add_u32 m0, s4, 3072
    s_nop 0
    buffer_load_dwordx4 v11, s[28:31], s73 offen lds
    s_add_u32 m0, s4, 4096
    s_nop 0
    buffer_load_dwordx4 v12, s[28:31], s73 offen lds
    s_mov_b32 s76, 7
    s_mov_b32 s77, 0
    s_mov_b32 s78, 71680
    s_cmp_eq_u32 s71, 0
    s_cselect_b32 s76, 6, s76
    s_cselect_b32 s77, 0, s77
    s_cselect_b32 s78, 61440, s78
    s_add_u32 s76, s76, s56
    s_cmp_ge_u32 s76, 10
    s_cselect_b32 s79, 10, 0
    s_sub_u32 s76, s76, s79
    s_mul_i32 s76, s76, 245760
    s_add_u32 s76, s76, s70
    s_add_u32 s73, s76, s77
    s_add_u32 s4, s78, s68
    s_add_u32 m0, s4, 0
    s_nop 0
    buffer_load_dwordx4 v8, s[28:31], s73 offen lds
    s_add_u32 m0, s4, 1024
    s_nop 0
    buffer_load_dwordx4 v9, s[28:31], s73 offen lds
    s_add_u32 m0, s4, 2048
    s_nop 0
    buffer_load_dwordx4 v10, s[28:31], s73 offen lds
    s_add_u32 m0, s4, 3072
    s_nop 0
    buffer_load_dwordx4 v11, s[28:31], s73 offen lds
    s_add_u32 m0, s4, 4096
    s_nop 0
    buffer_load_dwordx4 v12, s[28:31], s73 offen lds
    s_mov_b32 s76, 9
    s_mov_b32 s77, 0
    s_mov_b32 s78, 145408
    s_cmp_eq_u32 s71, 0
    s_cselect_b32 s76, 8, s76
    s_cselect_b32 s77, 0, s77
    s_cselect_b32 s78, 135168, s78
    s_add_u32 s76, s76, s56
    s_cmp_ge_u32 s76, 10
    s_cselect_b32 s79, 10, 0
    s_sub_u32 s76, s76, s79
    s_mul_i32 s76, s76, 245760
    s_add_u32 s76, s76, s70
    s_add_u32 s73, s76, s77
    s_add_u32 s4, s78, s68
    s_add_u32 m0, s4, 0
    s_nop 0
    buffer_load_dwordx4 v8, s[28:31], s73 offen lds
    s_add_u32 m0, s4, 1024
    s_nop 0
    buffer_load_dwordx4 v9, s[28:31], s73 offen lds
    s_add_u32 m0, s4, 2048
    s_nop 0
    buffer_load_dwordx4 v10, s[28:31], s73 offen lds
    s_add_u32 m0, s4, 3072
    s_nop 0
    buffer_load_dwordx4 v11, s[28:31], s73 offen lds
    s_add_u32 m0, s4, 4096
    s_nop 0
    buffer_load_dwordx4 v12, s[28:31], s73 offen lds
    v_min_u32 v26, 39, v0
    v_mul_u32_u24 v1, 6554, v26
    v_lshrrev_b32 v1, 16, v1
    v_lshlrev_b32 v26, 7, v26
    v_mul_u32_u24 v2, 1280, v1
    v_add_u32 v26, v26, v2
    v_lshrrev_b32 v1, 1, v1
    v_mul_u32_u24 v1, 35840, v1
    s_mul_i32 s76, s55, 5120
    s_add_u32 s76, s76, s92
    v_add_u32 v26, v26, v1
    buffer_load_dword v26, v26, s[48:51], s76 offen sc1
    s_and_b32 s76, s54, 3
    s_lshl_b32 s77, s55, 2
    s_add_u32 s76, s76, s77
    s_mul_i32 s76, s76, 25600
    s_mul_i32 s77, s53, 6400
    s_add_u32 s81, s76, s77
    v_min_u32 v6, 49, v0
    v_lshlrev_b32 v6, 7, v6
    buffer_load_dword v6, v6, s[32:35], s81 offen
    v_mov_b32 v13, 158720
    v_mov_b32 v14, 1
    s_setprio 0
    ds_read_b64_tr_b16 a[0:1], v15 offset:0
    ds_read_b64_tr_b16 a[2:3], v15 offset:2560
    ds_read_b64_tr_b16 a[4:5], v15 offset:40
    ds_read_b64_tr_b16 a[6:7], v15 offset:2600
    ds_read_b64_tr_b16 a[8:9], v15 offset:80
    ds_read_b64_tr_b16 a[10:11], v15 offset:2640
    ds_read_b64_tr_b16 a[12:13], v15 offset:120
    ds_read_b64_tr_b16 a[14:15], v15 offset:2680
    ds_read_b64_tr_b16 a[16:17], v17 offset:0
    ds_read_b64_tr_b16 a[18:19], v17 offset:2560
    s_waitcnt lgkmcnt(6)
    v_mfma_f32_16x16x32_bf16 v[32:35], a[0:3], a[24:27], v[28:31]
    ds_read_b64_tr_b16 a[20:21], v15 offset:5120
    v_mfma_f32_16x16x32_bf16 v[52:55], a[0:3], a[28:31], v[28:31]
    ds_read_b64_tr_b16 a[22:23], v15 offset:7680
    v_mfma_f32_16x16x32_bf16 v[36:39], a[4:7], a[24:27], v[28:31]
    ds_read_b64_tr_b16 a[0:1], v15 offset:5160
    v_mfma_f32_16x16x32_bf16 v[56:59], a[4:7], a[28:31], v[28:31]
    ds_read_b64_tr_b16 a[2:3], v15 offset:7720
    s_waitcnt lgkmcnt(6)
    v_mfma_f32_16x16x32_bf16 v[40:43], a[8:11], a[24:27], v[28:31]
    ds_read_b64_tr_b16 a[4:5], v15 offset:5200
    v_mfma_f32_16x16x32_bf16 v[60:63], a[8:11], a[28:31], v[28:31]
    ds_read_b64_tr_b16 a[6:7], v15 offset:7760
    v_mfma_f32_16x16x32_bf16 v[44:47], a[12:15], a[24:27], v[28:31]
    ds_read_b64_tr_b16 a[8:9], v15 offset:5240
    v_mfma_f32_16x16x32_bf16 v[64:67], a[12:15], a[28:31], v[28:31]
    ds_read_b64_tr_b16 a[10:11], v15 offset:7800
    s_waitcnt lgkmcnt(6)
    v_mfma_f32_16x16x32_bf16 v[48:51], a[16:19], a[24:27], v[28:31]
    ds_read_b64_tr_b16 a[12:13], v17 offset:5120
    v_mfma_f32_16x16x32_bf16 v[68:71], a[16:19], a[28:31], v[28:31]
    ds_read_b64_tr_b16 a[14:15], v17 offset:7680
    v_mfma_f32_16x16x32_bf16 v[32:35], a[20:23], a[32:35], v[32:35]
    ds_read_b64_tr_b16 a[16:17], v15 offset:10240
    v_mfma_f32_16x16x32_bf16 v[52:55], a[20:23], a[36:39], v[52:55]
    ds_read_b64_tr_b16 a[18:19], v15 offset:12800
    s_waitcnt lgkmcnt(6)
    v_mfma_f32_16x16x32_bf16 v[36:39], a[0:3], a[32:35], v[36:39]
    ds_read_b64_tr_b16 a[20:21], v15 offset:10280
    v_mfma_f32_16x16x32_bf16 v[56:59], a[0:3], a[36:39], v[56:59]
    ds_read_b64_tr_b16 a[22:23], v15 offset:12840
    v_mfma_f32_16x16x32_bf16 v[40:43], a[4:7], a[32:35], v[40:43]
    ds_read_b64_tr_b16 a[0:1], v15 offset:10320
    v_mfma_f32_16x16x32_bf16 v[60:63], a[4:7], a[36:39], v[60:63]
    ds_read_b64_tr_b16 a[2:3], v15 offset:12880
    s_waitcnt lgkmcnt(6)
    v_mfma_f32_16x16x32_bf16 v[44:47], a[8:11], a[32:35], v[44:47]
    ds_read_b64_tr_b16 a[4:5], v15 offset:10360
    v_mfma_f32_16x16x32_bf16 v[64:67], a[8:11], a[36:39], v[64:67]
    ds_read_b64_tr_b16 a[6:7], v15 offset:12920
    v_mfma_f32_16x16x32_bf16 v[48:51], a[12:15], a[32:35], v[48:51]
    ds_read_b64_tr_b16 a[8:9], v17 offset:10240
    v_mfma_f32_16x16x32_bf16 v[68:71], a[12:15], a[36:39], v[68:71]
    ds_read_b64_tr_b16 a[10:11], v17 offset:12800
    s_waitcnt lgkmcnt(6)
    v_mfma_f32_16x16x32_bf16 v[32:35], a[16:19], a[40:43], v[32:35]
    ds_read_b64_tr_b16 a[12:13], v15 offset:15360
    v_mfma_f32_16x16x32_bf16 v[52:55], a[16:19], a[44:47], v[52:55]
    ds_read_b64_tr_b16 a[14:15], v15 offset:17920
    v_mfma_f32_16x16x32_bf16 v[36:39], a[20:23], a[40:43], v[36:39]
    ds_read_b64_tr_b16 a[16:17], v15 offset:15400
    v_mfma_f32_16x16x32_bf16 v[56:59], a[20:23], a[44:47], v[56:59]
    ds_read_b64_tr_b16 a[18:19], v15 offset:17960
    s_waitcnt lgkmcnt(6)
    v_mfma_f32_16x16x32_bf16 v[40:43], a[0:3], a[40:43], v[40:43]
    ds_read_b64_tr_b16 a[20:21], v15 offset:15440
    v_mfma_f32_16x16x32_bf16 v[60:63], a[0:3], a[44:47], v[60:63]
    ds_read_b64_tr_b16 a[22:23], v15 offset:18000
    v_mfma_f32_16x16x32_bf16 v[44:47], a[4:7], a[40:43], v[44:47]
    ds_read_b64_tr_b16 a[0:1], v15 offset:15480
    v_mfma_f32_16x16x32_bf16 v[64:67], a[4:7], a[44:47], v[64:67]
    ds_read_b64_tr_b16 a[2:3], v15 offset:18040
    s_waitcnt lgkmcnt(6)
    v_mfma_f32_16x16x32_bf16 v[48:51], a[8:11], a[40:43], v[48:51]
    ds_read_b64_tr_b16 a[4:5], v17 offset:15360
    v_mfma_f32_16x16x32_bf16 v[68:71], a[8:11], a[44:47], v[68:71]
    ds_read_b64_tr_b16 a[6:7], v17 offset:17920
    s_waitcnt lgkmcnt(0)
    s_waitcnt vmcnt(2)
    s_mov_b64 exec, 1
    ds_add_u32 v13, v14 offset:4
    s_mov_b64 exec, -1
LA_c1:
    ds_read_b32 v1, v13 offset:4
    s_waitcnt lgkmcnt(0)
    v_readfirstlane_b32 s76, v1
    s_nop 0
    s_cmp_lt_u32 s76, 4
    s_cbranch_scc1 LA_c1
    v_mfma_f32_16x16x32_bf16 v[32:35], a[12:15], a[48:51], v[32:35]
    ds_read_b64_tr_b16 a[8:9], v15 offset:20480
    v_mfma_f32_16x16x32_bf16 v[52:55], a[12:15], a[52:55], v[52:55]
    ds_read_b64_tr_b16 a[10:11], v15 offset:23040
    v_mfma_f32_16x16x32_bf16 v[36:39], a[16:19], a[48:51], v[36:39]
    ds_read_b64_tr_b16 a[12:13], v15 offset:20520
    v_mfma_f32_16x16x32_bf16 v[56:59], a[16:19], a[52:55], v[56:59]
    ds_read_b64_tr_b16 a[14:15], v15 offset:23080
    v_mfma_f32_16x16x32_bf16 v[40:43], a[20:23], a[48:51], v[40:43]
    ds_read_b64_tr_b16 a[16:17], v15 offset:20560
    v_mfma_f32_16x16x32_bf16 v[60:63], a[20:23], a[52:55], v[60:63]
    ds_read_b64_tr_b16 a[18:19], v15 offset:23120
    v_mfma_f32_16x16x32_bf16 v[44:47], a[0:3], a[48:51], v[44:47]
    ds_read_b64_tr_b16 a[20:21], v15 offset:20600
    v_mfma_f32_16x16x32_bf16 v[64:67], a[0:3], a[52:55], v[64:67]
    ds_read_b64_tr_b16 a[22:23], v15 offset:23160
    v_mfma_f32_16x16x32_bf16 v[48:51], a[4:7], a[48:51], v[48:51]
    ds_read_b64_tr_b16 a[0:1], v17 offset:20480
    v_mfma_f32_16x16x32_bf16 v[68:71], a[4:7], a[52:55], v[68:71]
    ds_read_b64_tr_b16 a[2:3], v17 offset:23040
    s_waitcnt lgkmcnt(6)
    v_mfma_f32_16x16x32_bf16 v[32:35], a[8:11], a[56:59], v[32:35]
    ds_read_b64_tr_b16 a[4:5], v15 offset:25600
    v_mfma_f32_16x16x32_bf16 v[52:55], a[8:11], a[60:63], v[52:55]
    ds_read_b64_tr_b16 a[6:7], v15 offset:28160
    v_mfma_f32_16x16x32_bf16 v[36:39], a[12:15], a[56:59], v[36:39]
    ds_read_b64_tr_b16 a[8:9], v15 offset:25640
    v_mfma_f32_16x16x32_bf16 v[56:59], a[12:15], a[60:63], v[56:59]
    ds_read_b64_tr_b16 a[10:11], v15 offset:28200
    s_waitcnt lgkmcnt(6)
    v_mfma_f32_16x16x32_bf16 v[40:43], a[16:19], a[56:59], v[40:43]
    ds_read_b64_tr_b16 a[12:13], v15 offset:25680
    v_mfma_f32_16x16x32_bf16 v[60:63], a[16:19], a[60:63], v[60:63]
    ds_read_b64_tr_b16 a[14:15], v15 offset:28240
    v_mfma_f32_16x16x32_bf16 v[44:47], a[20:23], a[56:59], v[44:47]
    ds_read_b64_tr_b16 a[16:17], v15 offset:25720
    v_mfma_f32_16x16x32_bf16 v[64:67], a[20:23], a[60:63], v[64:67]
    ds_read_b64_tr_b16 a[18:19], v15 offset:28280
    s_waitcnt lgkmcnt(6)
    v_mfma_f32_16x16x32_bf16 v[48:51], a[0:3], a[56:59], v[48:51]
    ds_read_b64_tr_b16 a[20:21], v17 offset:25600
    v_mfma_f32_16x16x32_bf16 v[68:71], a[0:3], a[60:63], v[68:71]
    ds_read_b64_tr_b16 a[22:23], v17 offset:28160
    v_mfma_f32_16x16x32_bf16 v[32:35], a[4:7], a[64:67], v[32:35]
    ds_read_b64_tr_b16 a[0:1], v15 offset:30720
    v_mfma_f32_16x16x32_bf16 v[52:55], a[4:7], a[68:71], v[52:55]
    ds_read_b64_tr_b16 a[2:3], v15 offset:33280
    s_waitcnt lgkmcnt(6)
    v_mfma_f32_16x16x32_bf16 v[36:39], a[8:11], a[64:67], v[36:39]
    ds_read_b64_tr_b16 a[4:5], v15 offset:30760
    v_mfma_f32_16x16x32_bf16 v[56:59], a[8:11], a[68:71], v[56:59]
    ds_read_b64_tr_b16 a[6:7], v15 offset:33320
    v_mfma_f32_16x16x32_bf16 v[40:43], a[12:15], a[64:67], v[40:43]
    ds_read_b64_tr_b16 a[8:9], v15 offset:30800
    v_mfma_f32_16x16x32_bf16 v[60:63], a[12:15], a[68:71], v[60:63]
    ds_read_b64_tr_b16 a[10:11], v15 offset:33360
    s_waitcnt lgkmcnt(6)
    v_mfma_f32_16x16x32_bf16 v[44:47], a[16:19], a[64:67], v[44:47]
    ds_read_b64_tr_b16 a[12:13], v15 offset:30840
    v_mfma_f32_16x16x32_bf16 v[64:67], a[16:19], a[68:71], v[64:67]
    ds_read_b64_tr_b16 a[14:15], v15 offset:33400
    v_mfma_f32_16x16x32_bf16 v[48:51], a[20:23], a[64:67], v[48:51]
    ds_read_b64_tr_b16 a[16:17], v17 offset:30720
    v_mfma_f32_16x16x32_bf16 v[68:71], a[20:23], a[68:71], v[68:71]
    ds_read_b64_tr_b16 a[18:19], v17 offset:33280
    s_waitcnt lgkmcnt(6)
    v_mfma_f32_16x16x32_bf16 v[32:35], a[0:3], v[72:75], v[32:35]
    ds_read_b64_tr_b16 a[20:21], v15 offset:35840
    v_mfma_f32_16x16x32_bf16 v[52:55], a[0:3], v[76:79], v[52:55]
    ds_read_b64_tr_b16 a[22:23], v15 offset:38400
    v_mfma_f32_16x16x32_bf16 v[36:39], a[4:7], v[72:75], v[36:39]
    ds_read_b64_tr_b16 a[0:1], v15 offset:35880
    v_mfma_f32_16x16x32_bf16 v[56:59], a[4:7], v[76:79], v[56:59]
    ds_read_b64_tr_b16 a[2:3], v15 offset:38440
    s_waitcnt lgkmcnt(6)
    v_mfma_f32_16x16x32_bf16 v[40:43], a[8:11], v[72:75], v[40:43]
    ds_read_b64_tr_b16 a[4:5], v15 offset:35920
    v_mfma_f32_16x16x32_bf16 v[60:63], a[8:11], v[76:79], v[60:63]
    ds_read_b64_tr_b16 a[6:7], v15 offset:38480
    v_mfma_f32_16x16x32_bf16 v[44:47], a[12:15], v[72:75], v[44:47]
    ds_read_b64_tr_b16 a[8:9], v15 offset:35960
    v_mfma_f32_16x16x32_bf16 v[64:67], a[12:15], v[76:79], v[64:67]
    ds_read_b64_tr_b16 a[10:11], v15 offset:38520
    s_waitcnt lgkmcnt(6)
    v_mfma_f32_16x16x32_bf16 v[48:51], a[16:19], v[72:75], v[48:51]
    ds_read_b64_tr_b16 a[12:13], v17 offset:35840
    v_mfma_f32_16x16x32_bf16 v[68:71], a[16:19], v[76:79], v[68:71]
    ds_read_b64_tr_b16 a[14:15], v17 offset:38400
    s_waitcnt lgkmcnt(0)
    s_mov_b64 exec, 1
    ds_add_u32 v13, v14 offset:8
    s_mov_b64 exec, -1
    v_mfma_f32_16x16x32_bf16 v[32:35], a[20:23], v[80:83], v[32:35]
    ds_read_b64_tr_b16 a[16:17], v15 offset:40960
    v_mfma_f32_16x16x32_bf16 v[52:55], a[20:23], v[84:87], v[52:55]
    ds_read_b64_tr_b16 a[18:19], v15 offset:43520
    v_mfma_f32_16x16x32_bf16 v[36:39], a[0:3], v[80:83], v[36:39]
    ds_read_b64_tr_b16 a[20:21], v15 offset:41000
    v_mfma_f32_16x16x32_bf16 v[56:59], a[0:3], v[84:87], v[56:59]
    ds_read_b64_tr_b16 a[22:23], v15 offset:43560
    v_mfma_f32_16x16x32_bf16 v[40:43], a[4:7], v[80:83], v[40:43]
    ds_read_b64_tr_b16 a[0:1], v15 offset:41040
    v_mfma_f32_16x16x32_bf16 v[60:63], a[4:7], v[84:87], v[60:63]
    ds_read_b64_tr_b16 a[2:3], v15 offset:43600
    v_mfma_f32_16x16x32_bf16 v[44:47], a[8:11], v[80:83], v[44:47]
    ds_read_b64_tr_b16 a[4:5], v15 offset:41080
    v_mfma_f32_16x16x32_bf16 v[64:67], a[8:11], v[84:87], v[64:67]
    ds_read_b64_tr_b16 a[6:7], v15 offset:43640
    v_mfma_f32_16x16x32_bf16 v[48:51], a[12:15], v[80:83], v[48:51]
    ds_read_b64_tr_b16 a[8:9], v17 offset:40960
    v_mfma_f32_16x16x32_bf16 v[68:71], a[12:15], v[84:87], v[68:71]
    ds_read_b64_tr_b16 a[10:11], v17 offset:43520
    s_waitcnt lgkmcnt(6)
    v_mfma_f32_16x16x32_bf16 v[32:35], a[16:19], v[88:91], v[32:35]
    ds_read_b64_tr_b16 a[12:13], v15 offset:46080
    v_mfma_f32_16x16x32_bf16 v[52:55], a[16:19], v[92:95], v[52:55]
    ds_read_b64_tr_b16 a[14:15], v15 offset:48640
    v_mfma_f32_16x16x32_bf16 v[36:39], a[20:23], v[88:91], v[36:39]
    ds_read_b64_tr_b16 a[16:17], v15 offset:46120
    v_mfma_f32_16x16x32_bf16 v[56:59], a[20:23], v[92:95], v[56:59]
    ds_read_b64_tr_b16 a[18:19], v15 offset:48680
    s_waitcnt lgkmcnt(6)
    v_mfma_f32_16x16x32_bf16 v[40:43], a[0:3], v[88:91], v[40:43]
    ds_read_b64_tr_b16 a[20:21], v15 offset:46160
    v_mfma_f32_16x16x32_bf16 v[60:63], a[0:3], v[92:95], v[60:63]
    ds_read_b64_tr_b16 a[22:23], v15 offset:48720
    v_mfma_f32_16x16x32_bf16 v[44:47], a[4:7], v[88:91], v[44:47]
    ds_read_b64_tr_b16 a[0:1], v15 offset:46200
    v_mfma_f32_16x16x32_bf16 v[64:67], a[4:7], v[92:95], v[64:67]
    ds_read_b64_tr_b16 a[2:3], v15 offset:48760
    s_waitcnt lgkmcnt(6)
    v_mfma_f32_16x16x32_bf16 v[48:51], a[8:11], v[88:91], v[48:51]
    ds_read_b64_tr_b16 a[4:5], v17 offset:46080
    v_mfma_f32_16x16x32_bf16 v[68:71], a[8:11], v[92:95], v[68:71]
    ds_read_b64_tr_b16 a[6:7], v17 offset:48640
    v_mfma_f32_16x16x32_bf16 v[32:35], a[12:15], v[96:99], v[32:35]
    ds_read_b64_tr_b16 a[8:9], v15 offset:51200
    v_mfma_f32_16x16x32_bf16 v[52:55], a[12:15], v[100:103], v[52:55]
    ds_read_b64_tr_b16 a[10:11], v15 offset:53760
    s_waitcnt lgkmcnt(6)
    v_mfma_f32_16x16x32_bf16 v[36:39], a[16:19], v[96:99], v[36:39]
    ds_read_b64_tr_b16 a[12:13], v15 offset:51240
    v_mfma_f32_16x16x32_bf16 v[56:59], a[16:19], v[100:103], v[56:59]
    ds_read_b64_tr_b16 a[14:15], v15 offset:53800
    v_mfma_f32_16x16x32_bf16 v[40:43], a[20:23], v[96:99], v[40:43]
    ds_read_b64_tr_b16 a[16:17], v15 offset:51280
    v_mfma_f32_16x16x32_bf16 v[60:63], a[20:23], v[100:103], v[60:63]
    ds_read_b64_tr_b16 a[18:19], v15 offset:53840
    s_waitcnt lgkmcnt(6)
    v_mfma_f32_16x16x32_bf16 v[44:47], a[0:3], v[96:99], v[44:47]
    ds_read_b64_tr_b16 a[20:21], v15 offset:51320
    v_mfma_f32_16x16x32_bf16 v[64:67], a[0:3], v[100:103], v[64:67]
    ds_read_b64_tr_b16 a[22:23], v15 offset:53880
    v_mfma_f32_16x16x32_bf16 v[48:51], a[4:7], v[96:99], v[48:51]
    ds_read_b64_tr_b16 a[0:1], v17 offset:51200
    v_mfma_f32_16x16x32_bf16 v[68:71], a[4:7], v[100:103], v[68:71]
    ds_read_b64_tr_b16 a[2:3], v17 offset:53760
    s_waitcnt lgkmcnt(6)
    v_mfma_f32_16x16x32_bf16 v[32:35], a[8:11], v[104:107], v[32:35]
    ds_read_b64_tr_b16 a[4:5], v15 offset:56320
    v_mfma_f32_16x16x32_bf16 v[52:55], a[8:11], v[108:111], v[52:55]
    ds_read_b64_tr_b16 a[6:7], v15 offset:58880
    v_mfma_f32_16x16x32_bf16 v[36:39], a[12:15], v[104:107], v[36:39]
    ds_read_b64_tr_b16 a[8:9], v15 offset:56360
    v_mfma_f32_16x16x32_bf16 v[56:59], a[12:15], v[108:111], v[56:59]
    ds_read_b64_tr_b16 a[10:11], v15 offset:58920
    s_waitcnt lgkmcnt(6)
    v_mfma_f32_16x16x32_bf16 v[40:43], a[16:19], v[104:107], v[40:43]
    ds_read_b64_tr_b16 a[12:13], v15 offset:56400
    v_mfma_f32_16x16x32_bf16 v[60:63], a[16:19], v[108:111], v[60:63]
    ds_read_b64_tr_b16 a[14:15], v15 offset:58960
    v_mfma_f32_16x16x32_bf16 v[44:47], a[20:23], v[104:107], v[44:47]
    ds_read_b64_tr_b16 a[16:17], v15 offset:56440
    v_mfma_f32_16x16x32_bf16 v[64:67], a[20:23], v[108:111], v[64:67]
    ds_read_b64_tr_b16 a[18:19], v15 offset:59000
    s_waitcnt lgkmcnt(6)
    v_mfma_f32_16x16x32_bf16 v[48:51], a[0:3], v[104:107], v[48:51]
    ds_read_b64_tr_b16 a[20:21], v17 offset:56320
    v_mfma_f32_16x16x32_bf16 v[68:71], a[0:3], v[108:111], v[68:71]
    ds_read_b64_tr_b16 a[22:23], v17 offset:58880
    v_mfma_f32_16x16x32_bf16 v[32:35], a[4:7], v[112:115], v[32:35]
    ds_read_b64_tr_b16 a[0:1], v16 offset:0
    v_mfma_f32_16x16x32_bf16 v[52:55], a[4:7], v[116:119], v[52:55]
    ds_read_b64_tr_b16 a[2:3], v16 offset:2560
    s_waitcnt lgkmcnt(6)
    v_mfma_f32_16x16x32_bf16 v[36:39], a[8:11], v[112:115], v[36:39]
    ds_read_b64_tr_b16 a[4:5], v16 offset:40
    v_mfma_f32_16x16x32_bf16 v[56:59], a[8:11], v[116:119], v[56:59]
    ds_read_b64_tr_b16 a[6:7], v16 offset:2600
    v_mfma_f32_16x16x32_bf16 v[40:43], a[12:15], v[112:115], v[40:43]
    ds_read_b64_tr_b16 a[8:9], v16 offset:80
    v_mfma_f32_16x16x32_bf16 v[60:63], a[12:15], v[116:119], v[60:63]
    ds_read_b64_tr_b16 a[10:11], v16 offset:2640
    s_waitcnt lgkmcnt(6)
    v_mfma_f32_16x16x32_bf16 v[44:47], a[16:19], v[112:115], v[44:47]
    ds_read_b64_tr_b16 a[12:13], v16 offset:120
    v_mfma_f32_16x16x32_bf16 v[64:67], a[16:19], v[116:119], v[64:67]
    ds_read_b64_tr_b16 a[14:15], v16 offset:2680
    v_mfma_f32_16x16x32_bf16 v[48:51], a[20:23], v[112:115], v[48:51]
    ds_read_b64_tr_b16 a[16:17], v18 offset:0
    v_mfma_f32_16x16x32_bf16 v[68:71], a[20:23], v[116:119], v[68:71]
    ds_read_b64_tr_b16 a[18:19], v18 offset:2560
    s_waitcnt lgkmcnt(6)
    v_mfma_f32_16x16x32_bf16 v[32:35], a[0:3], v[120:123], v[32:35]
    ds_read_b64_tr_b16 a[20:21], v16 offset:5120
    v_mfma_f32_16x16x32_bf16 v[52:55], a[0:3], v[124:127], v[52:55]
    ds_read_b64_tr_b16 a[22:23], v16 offset:7680
    v_mfma_f32_16x16x32_bf16 v[36:39], a[4:7], v[120:123], v[36:39]
    ds_read_b64_tr_b16 a[0:1], v16 offset:5160
    v_mfma_f32_16x16x32_bf16 v[56:59], a[4:7], v[124:127], v[56:59]
    ds_read_b64_tr_b16 a[2:3], v16 offset:7720
    s_waitcnt lgkmcnt(6)
    v_mfma_f32_16x16x32_bf16 v[40:43], a[8:11], v[120:123], v[40:43]
    ds_read_b64_tr_b16 a[4:5], v16 offset:5200
    v_mfma_f32_16x16x32_bf16 v[60:63], a[8:11], v[124:127], v[60:63]
    ds_read_b64_tr_b16 a[6:7], v16 offset:7760
    v_mfma_f32_16x16x32_bf16 v[44:47], a[12:15], v[120:123], v[44:47]
    ds_read_b64_tr_b16 a[8:9], v16 offset:5240
    v_mfma_f32_16x16x32_bf16 v[64:67], a[12:15], v[124:127], v[64:67]
    ds_read_b64_tr_b16 a[10:11], v16 offset:7800
    s_waitcnt lgkmcnt(6)
    v_mfma_f32_16x16x32_bf16 v[48:51], a[16:19], v[120:123], v[48:51]
    ds_read_b64_tr_b16 a[12:13], v18 offset:5120
    v_mfma_f32_16x16x32_bf16 v[68:71], a[16:19], v[124:127], v[68:71]
    ds_read_b64_tr_b16 a[14:15], v18 offset:7680
    v_mfma_f32_16x16x32_bf16 v[32:35], a[20:23], v[128:131], v[32:35]
    ds_read_b64_tr_b16 a[16:17], v16 offset:10240
    v_mfma_f32_16x16x32_bf16 v[52:55], a[20:23], v[132:135], v[52:55]
    ds_read_b64_tr_b16 a[18:19], v16 offset:12800
    s_waitcnt lgkmcnt(6)
    v_mfma_f32_16x16x32_bf16 v[36:39], a[0:3], v[128:131], v[36:39]
    ds_read_b64_tr_b16 a[20:21], v16 offset:10280
    v_mfma_f32_16x16x32_bf16 v[56:59], a[0:3], v[132:135], v[56:59]
    ds_read_b64_tr_b16 a[22:23], v16 offset:12840
    v_mfma_f32_16x16x32_bf16 v[40:43], a[4:7], v[128:131], v[40:43]
    ds_read_b64_tr_b16 a[0:1], v16 offset:10320
    v_mfma_f32_16x16x32_bf16 v[60:63], a[4:7], v[132:135], v[60:63]
    ds_read_b64_tr_b16 a[2:3], v16 offset:12880
    s_waitcnt lgkmcnt(6)
    v_mfma_f32_16x16x32_bf16 v[44:47], a[8:11], v[128:131], v[44:47]
    ds_read_b64_tr_b16 a[4:5], v16 offset:10360
    v_mfma_f32_16x16x32_bf16 v[64:67], a[8:11], v[132:135], v[64:67]
    ds_read_b64_tr_b16 a[6:7], v16 offset:12920
    v_mfma_f32_16x16x32_bf16 v[48:51], a[12:15], v[128:131], v[48:51]
    ds_read_b64_tr_b16 a[8:9], v18 offset:10240
    v_mfma_f32_16x16x32_bf16 v[68:71], a[12:15], v[132:135], v[68:71]
    ds_read_b64_tr_b16 a[10:11], v18 offset:12800
    s_waitcnt lgkmcnt(6)
    v_mfma_f32_16x16x32_bf16 v[32:35], a[16:19], v[136:139], v[32:35]
    ds_read_b64_tr_b16 a[12:13], v16 offset:15360
    v_mfma_f32_16x16x32_bf16 v[52:55], a[16:19], v[140:143], v[52:55]
    ds_read_b64_tr_b16 a[14:15], v16 offset:17920
    v_mfma_f32_16x16x32_bf16 v[36:39], a[20:23], v[136:139], v[36:39]
    ds_read_b64_tr_b16 a[16:17], v16 offset:15400
    v_mfma_f32_16x16x32_bf16 v[56:59], a[20:23], v[140:143], v[56:59]
    ds_read_b64_tr_b16 a[18:19], v16 offset:17960
    s_waitcnt lgkmcnt(6)
    v_mfma_f32_16x16x32_bf16 v[40:43], a[0:3], v[136:139], v[40:43]
    ds_read_b64_tr_b16 a[20:21], v16 offset:15440
    v_mfma_f32_16x16x32_bf16 v[60:63], a[0:3], v[140:143], v[60:63]
    ds_read_b64_tr_b16 a[22:23], v16 offset:18000
    v_mfma_f32_16x16x32_bf16 v[44:47], a[4:7], v[136:139], v[44:47]
    ds_read_b64_tr_b16 a[0:1], v16 offset:15480
    v_mfma_f32_16x16x32_bf16 v[64:67], a[4:7], v[140:143], v[64:67]
    ds_read_b64_tr_b16 a[2:3], v16 offset:18040
    s_waitcnt lgkmcnt(6)
    v_mfma_f32_16x16x32_bf16 v[48:51], a[8:11], v[136:139], v[48:51]
    ds_read_b64_tr_b16 a[4:5], v18 offset:15360
    v_mfma_f32_16x16x32_bf16 v[68:71], a[8:11], v[140:143], v[68:71]
    ds_read_b64_tr_b16 a[6:7], v18 offset:17920
    v_mfma_f32_16x16x32_bf16 v[32:35], a[12:15], v[144:147], v[32:35]
    ds_read_b64_tr_b16 a[8:9], v4 offset:0
    v_mfma_f32_16x16x32_bf16 v[52:55], a[12:15], v[148:151], v[52:55]
    ds_read_b64_tr_b16 a[10:11], v4 offset:2560
    s_waitcnt lgkmcnt(6)
    v_mfma_f32_16x16x32_bf16 v[36:39], a[16:19], v[144:147], v[36:39]
    ds_read_b64_tr_b16 a[12:13], v4 offset:40
    v_mfma_f32_16x16x32_bf16 v[56:59], a[16:19], v[148:151], v[56:59]
    ds_read_b64_tr_b16 a[14:15], v4 offset:2600
    v_mfma_f32_16x16x32_bf16 v[40:43], a[20:23], v[144:147], v[40:43]
    ds_read_b64_tr_b16 a[16:17], v4 offset:80
    v_mfma_f32_16x16x32_bf16 v[60:63], a[20:23], v[148:151], v[60:63]
    ds_read_b64_tr_b16 a[18:19], v4 offset:2640
    s_waitcnt lgkmcnt(6)
    v_mfma_f32_16x16x32_bf16 v[44:47], a[0:3], v[144:147], v[44:47]
    ds_read_b64_tr_b16 a[20:21], v4 offset:120
    v_mfma_f32_16x16x32_bf16 v[64:67], a[0:3], v[148:151], v[64:67]
    ds_read_b64_tr_b16 a[22:23], v4 offset:2680
    v_mfma_f32_16x16x32_bf16 v[48:51], a[4:7], v[144:147], v[48:51]
    ds_read_b64_tr_b16 a[0:1], v5 offset:0
    v_mfma_f32_16x16x32_bf16 v[68:71], a[4:7], v[148:151], v[68:71]
    ds_read_b64_tr_b16 a[2:3], v5 offset:2560
    s_waitcnt lgkmcnt(6)
    v_mfma_f32_16x16x32_bf16 v[32:35], a[8:11], v[152:155], v[32:35]
    ds_read_b64_tr_b16 a[4:5], v4 offset:5120
    v_mfma_f32_16x16x32_bf16 v[52:55], a[8:11], v[156:159], v[52:55]
    ds_read_b64_tr_b16 a[6:7], v4 offset:7680
    v_mfma_f32_16x16x32_bf16 v[36:39], a[12:15], v[152:155], v[36:39]
    ds_read_b64_tr_b16 a[8:9], v4 offset:5160
    v_mfma_f32_16x16x32_bf16 v[56:59], a[12:15], v[156:159], v[56:59]
    ds_read_b64_tr_b16 a[10:11], v4 offset:7720
    s_waitcnt lgkmcnt(6)
    v_mfma_f32_16x16x32_bf16 v[40:43], a[16:19], v[152:155], v[40:43]
    ds_read_b64_tr_b16 a[12:13], v4 offset:5200
    v_mfma_f32_16x16x32_bf16 v[60:63], a[16:19], v[156:159], v[60:63]
    ds_read_b64_tr_b16 a[14:15], v4 offset:7760
    v_mfma_f32_16x16x32_bf16 v[44:47], a[20:23], v[152:155], v[44:47]
    ds_read_b64_tr_b16 a[16:17], v4 offset:5240
    v_mfma_f32_16x16x32_bf16 v[64:67], a[20:23], v[156:159], v[64:67]
    ds_read_b64_tr_b16 a[18:19], v4 offset:7800
    s_waitcnt lgkmcnt(6)
    v_mfma_f32_16x16x32_bf16 v[48:51], a[0:3], v[152:155], v[48:51]
    ds_read_b64_tr_b16 a[20:21], v5 offset:5120
    v_mfma_f32_16x16x32_bf16 v[68:71], a[0:3], v[156:159], v[68:71]
    ds_read_b64_tr_b16 a[22:23], v5 offset:7680
    v_mfma_f32_16x16x32_bf16 v[32:35], a[4:7], v[160:163], v[32:35]
    ds_read_b64_tr_b16 a[0:1], v4 offset:10240
    v_mfma_f32_16x16x32_bf16 v[52:55], a[4:7], v[164:167], v[52:55]
    ds_read_b64_tr_b16 a[2:3], v4 offset:12800
    s_waitcnt lgkmcnt(6)
    v_mfma_f32_16x16x32_bf16 v[36:39], a[8:11], v[160:163], v[36:39]
    ds_read_b64_tr_b16 a[4:5], v4 offset:10280
    v_mfma_f32_16x16x32_bf16 v[56:59], a[8:11], v[164:167], v[56:59]
    ds_read_b64_tr_b16 a[6:7], v4 offset:12840
    v_mfma_f32_16x16x32_bf16 v[40:43], a[12:15], v[160:163], v[40:43]
    ds_read_b64_tr_b16 a[8:9], v4 offset:10320
    v_mfma_f32_16x16x32_bf16 v[60:63], a[12:15], v[164:167], v[60:63]
    ds_read_b64_tr_b16 a[10:11], v4 offset:12880
    s_waitcnt lgkmcnt(6)
    v_mfma_f32_16x16x32_bf16 v[44:47], a[16:19], v[160:163], v[44:47]
    ds_read_b64_tr_b16 a[12:13], v4 offset:10360
    v_mfma_f32_16x16x32_bf16 v[64:67], a[16:19], v[164:167], v[64:67]
    ds_read_b64_tr_b16 a[14:15], v4 offset:12920
    v_mfma_f32_16x16x32_bf16 v[48:51], a[20:23], v[160:163], v[48:51]
    ds_read_b64_tr_b16 a[16:17], v5 offset:10240
    v_mfma_f32_16x16x32_bf16 v[68:71], a[20:23], v[164:167], v[68:71]
    ds_read_b64_tr_b16 a[18:19], v5 offset:12800
    s_waitcnt lgkmcnt(6)
    v_mfma_f32_16x16x32_bf16 v[32:35], a[0:3], v[168:171], v[32:35]
    ds_read_b64_tr_b16 a[20:21], v4 offset:15360
    v_mfma_f32_16x16x32_bf16 v[52:55], a[0:3], v[172:175], v[52:55]
    ds_read_b64_tr_b16 a[22:23], v4 offset:17920
    v_mfma_f32_16x16x32_bf16 v[36:39], a[4:7], v[168:171], v[36:39]
    ds_read_b64_tr_b16 a[0:1], v4 offset:15400
    v_mfma_f32_16x16x32_bf16 v[56:59], a[4:7], v[172:175], v[56:59]
    ds_read_b64_tr_b16 a[2:3], v4 offset:17960
    s_waitcnt lgkmcnt(6)
    v_mfma_f32_16x16x32_bf16 v[40:43], a[8:11], v[168:171], v[40:43]
    ds_read_b64_tr_b16 a[4:5], v4 offset:15440
    v_mfma_f32_16x16x32_bf16 v[60:63], a[8:11], v[172:175], v[60:63]
    ds_read_b64_tr_b16 a[6:7], v4 offset:18000
    v_mfma_f32_16x16x32_bf16 v[44:47], a[12:15], v[168:171], v[44:47]
    ds_read_b64_tr_b16 a[8:9], v4 offset:15480
    v_mfma_f32_16x16x32_bf16 v[64:67], a[12:15], v[172:175], v[64:67]
    ds_read_b64_tr_b16 a[10:11], v4 offset:18040
    s_waitcnt lgkmcnt(6)
    v_mfma_f32_16x16x32_bf16 v[48:51], a[16:19], v[168:171], v[48:51]
    ds_read_b64_tr_b16 a[12:13], v5 offset:15360
    v_mfma_f32_16x16x32_bf16 v[68:71], a[16:19], v[172:175], v[68:71]
    ds_read_b64_tr_b16 a[14:15], v5 offset:17920
    v_mfma_f32_16x16x32_bf16 v[32:35], a[20:23], v[176:179], v[32:35]
    v_mfma_f32_16x16x32_bf16 v[52:55], a[20:23], v[180:183], v[52:55]
    s_waitcnt lgkmcnt(4)
    v_mfma_f32_16x16x32_bf16 v[36:39], a[0:3], v[176:179], v[36:39]
    v_mfma_f32_16x16x32_bf16 v[56:59], a[0:3], v[180:183], v[56:59]
    v_mfma_f32_16x16x32_bf16 v[40:43], a[4:7], v[176:179], v[40:43]
    v_mfma_f32_16x16x32_bf16 v[60:63], a[4:7], v[180:183], v[60:63]
    s_waitcnt lgkmcnt(0)
    v_mfma_f32_16x16x32_bf16 v[44:47], a[8:11], v[176:179], v[44:47]
    v_mfma_f32_16x16x32_bf16 v[64:67], a[8:11], v[180:183], v[64:67]
    v_mfma_f32_16x16x32_bf16 v[48:51], a[12:15], v[176:179], v[48:51]
    v_mfma_f32_16x16x32_bf16 v[68:71], a[12:15], v[180:183], v[68:71]
    v_mov_b32 v10, 0xb5c1a2a0
    s_nop 5
    v_pk_fma_f32 v[168:169], v[48:49], s[74:75], v[10:11] op_sel_hi:[1,0,0]
    v_pk_fma_f32 v[170:171], v[50:51], s[74:75], v[10:11] op_sel_hi:[1,0,0]
    v_exp_f32 v168, v168 clamp
    v_max_f32 v48, s75, v48
    v_exp_f32 v169, v169 clamp
    v_max_f32 v49, s75, v49
    v_exp_f32 v170, v170 clamp
    v_max_f32 v50, s75, v50
    v_exp_f32 v171, v171 clamp
    v_max_f32 v51, s75, v51
    v_pk_add_f32 v[48:49], v[48:49], v[168:169]
    v_pk_add_f32 v[50:51], v[50:51], v[170:171]
    v_cvt_pk_bf16_f32 v48, v48, v49
    v_cvt_pk_bf16_f32 v49, v50, v51
    v_pk_fma_f32 v[168:169], v[32:33], s[74:75], v[10:11] op_sel_hi:[1,0,0]
    v_pk_fma_f32 v[170:171], v[34:35], s[74:75], v[10:11] op_sel_hi:[1,0,0]
    v_pk_fma_f32 v[172:173], v[36:37], s[74:75], v[10:11] op_sel_hi:[1,0,0]
    v_pk_fma_f32 v[174:175], v[38:39], s[74:75], v[10:11] op_sel_hi:[1,0,0]
    v_exp_f32 v168, v168 clamp
    v_max_f32 v32, s75, v32
    v_exp_f32 v169, v169 clamp
    v_max_f32 v33, s75, v33
    v_exp_f32 v170, v170 clamp
    v_max_f32 v34, s75, v34
    v_exp_f32 v171, v171 clamp
    v_max_f32 v35, s75, v35
    v_exp_f32 v172, v172 clamp
    v_max_f32 v36, s75, v36
    v_exp_f32 v173, v173 clamp
    v_max_f32 v37, s75, v37
    v_exp_f32 v174, v174 clamp
    v_max_f32 v38, s75, v38
    v_exp_f32 v175, v175 clamp
    v_max_f32 v39, s75, v39
    v_pk_add_f32 v[32:33], v[32:33], v[168:169]
    v_pk_add_f32 v[34:35], v[34:35], v[170:171]
    v_pk_add_f32 v[36:37], v[36:37], v[172:173]
    v_pk_add_f32 v[38:39], v[38:39], v[174:175]
    v_cvt_pk_bf16_f32 v32, v32, v33
    v_cvt_pk_bf16_f32 v33, v34, v35
    v_cndmask_b32 v34, 0, v48, s[60:61]
    v_cndmask_b32 v35, 0, v49, s[60:61]
    v_cvt_pk_bf16_f32 v36, v36, v37
    v_cvt_pk_bf16_f32 v37, v38, v39
    v_cndmask_b32 v38, 0, v48, s[62:63]
    v_cndmask_b32 v39, 0, v49, s[62:63]
    v_pk_fma_f32 v[168:169], v[40:41], s[74:75], v[10:11] op_sel_hi:[1,0,0]
    v_pk_fma_f32 v[170:171], v[42:43], s[74:75], v[10:11] op_sel_hi:[1,0,0]
    v_pk_fma_f32 v[172:173], v[44:45], s[74:75], v[10:11] op_sel_hi:[1,0,0]
    v_pk_fma_f32 v[174:175], v[46:47], s[74:75], v[10:11] op_sel_hi:[1,0,0]
    v_exp_f32 v168, v168 clamp
    v_max_f32 v40, s75, v40
    v_exp_f32 v169, v169 clamp
    v_max_f32 v41, s75, v41
    v_exp_f32 v170, v170 clamp
    v_max_f32 v42, s75, v42
    v_exp_f32 v171, v171 clamp
    v_max_f32 v43, s75, v43
    v_exp_f32 v172, v172 clamp
    v_max_f32 v44, s75, v44
    v_exp_f32 v173, v173 clamp
    v_max_f32 v45, s75, v45
    v_exp_f32 v174, v174 clamp
    v_max_f32 v46, s75, v46
    v_exp_f32 v175, v175 clamp
    v_max_f32 v47, s75, v47
    v_pk_add_f32 v[40:41], v[40:41], v[168:169]
    v_pk_add_f32 v[42:43], v[42:43], v[170:171]
    v_pk_add_f32 v[44:45], v[44:45], v[172:173]
    v_pk_add_f32 v[46:47], v[46:47], v[174:175]
    v_cvt_pk_bf16_f32 v40, v40, v41
    v_cvt_pk_bf16_f32 v41, v42, v43
    v_cndmask_b32 v42, 0, v48, s[64:65]
    v_cndmask_b32 v43, 0, v49, s[64:65]
    v_cvt_pk_bf16_f32 v44, v44, v45
    v_cvt_pk_bf16_f32 v45, v46, v47
    v_cndmask_b32 v46, 0, v48, s[66:67]
    v_cndmask_b32 v47, 0, v49, s[66:67]
    v_pk_fma_f32 v[168:169], v[68:69], s[74:75], v[10:11] op_sel_hi:[1,0,0]
    v_pk_fma_f32 v[170:171], v[70:71], s[74:75], v[10:11] op_sel_hi:[1,0,0]
    v_exp_f32 v168, v168 clamp
    v_max_f32 v68, s75, v68
    v_exp_f32 v169, v169 clamp
    v_max_f32 v69, s75, v69
    v_exp_f32 v170, v170 clamp
    v_max_f32 v70, s75, v70
    v_exp_f32 v171, v171 clamp
    v_max_f32 v71, s75, v71
    v_pk_add_f32 v[68:69], v[68:69], v[168:169]
    v_pk_add_f32 v[70:71], v[70:71], v[170:171]
    v_cvt_pk_bf16_f32 v68, v68, v69
    v_cvt_pk_bf16_f32 v69, v70, v71
    v_pk_fma_f32 v[168:169], v[52:53], s[74:75], v[10:11] op_sel_hi:[1,0,0]
    v_pk_fma_f32 v[170:171], v[54:55], s[74:75], v[10:11] op_sel_hi:[1,0,0]
    v_pk_fma_f32 v[172:173], v[56:57], s[74:75], v[10:11] op_sel_hi:[1,0,0]
    v_pk_fma_f32 v[174:175], v[58:59], s[74:75], v[10:11] op_sel_hi:[1,0,0]
    v_exp_f32 v168, v168 clamp
    v_max_f32 v52, s75, v52
    v_exp_f32 v169, v169 clamp
    v_max_f32 v53, s75, v53
    v_exp_f32 v170, v170 clamp
    v_max_f32 v54, s75, v54
    v_exp_f32 v171, v171 clamp
    v_max_f32 v55, s75, v55
    v_exp_f32 v172, v172 clamp
    v_max_f32 v56, s75, v56
    v_exp_f32 v173, v173 clamp
    v_max_f32 v57, s75, v57
    v_exp_f32 v174, v174 clamp
    v_max_f32 v58, s75, v58
    v_exp_f32 v175, v175 clamp
    v_max_f32 v59, s75, v59
    v_pk_add_f32 v[52:53], v[52:53], v[168:169]
    v_pk_add_f32 v[54:55], v[54:55], v[170:171]
    v_pk_add_f32 v[56:57], v[56:57], v[172:173]
    v_pk_add_f32 v[58:59], v[58:59], v[174:175]
    v_cvt_pk_bf16_f32 v52, v52, v53
    v_cvt_pk_bf16_f32 v53, v54, v55
    v_cndmask_b32 v54, 0, v68, s[60:61]
    v_cndmask_b32 v55, 0, v69, s[60:61]
    v_cvt_pk_bf16_f32 v56, v56, v57
    v_cvt_pk_bf16_f32 v57, v58, v59
    v_cndmask_b32 v58, 0, v68, s[62:63]
    v_cndmask_b32 v59, 0, v69, s[62:63]
    v_pk_fma_f32 v[168:169], v[60:61], s[74:75], v[10:11] op_sel_hi:[1,0,0]
    v_pk_fma_f32 v[170:171], v[62:63], s[74:75], v[10:11] op_sel_hi:[1,0,0]
    v_pk_fma_f32 v[172:173], v[64:65], s[74:75], v[10:11] op_sel_hi:[1,0,0]
    v_pk_fma_f32 v[174:175], v[66:67], s[74:75], v[10:11] op_sel_hi:[1,0,0]
    v_exp_f32 v168, v168 clamp
    v_max_f32 v60, s75, v60
    v_exp_f32 v169, v169 clamp
    v_max_f32 v61, s75, v61
    v_exp_f32 v170, v170 clamp
    v_max_f32 v62, s75, v62
    v_exp_f32 v171, v171 clamp
    v_max_f32 v63, s75, v63
    v_exp_f32 v172, v172 clamp
    v_max_f32 v64, s75, v64
    v_exp_f32 v173, v173 clamp
    v_max_f32 v65, s75, v65
    v_exp_f32 v174, v174 clamp
    v_max_f32 v66, s75, v66
    v_exp_f32 v175, v175 clamp
    v_max_f32 v67, s75, v67
    v_pk_add_f32 v[60:61], v[60:61], v[168:169]
    v_pk_add_f32 v[62:63], v[62:63], v[170:171]
    v_pk_add_f32 v[64:65], v[64:65], v[172:173]
    v_pk_add_f32 v[66:67], v[66:67], v[174:175]
    v_cvt_pk_bf16_f32 v60, v60, v61
    v_cvt_pk_bf16_f32 v61, v62, v63
    v_cndmask_b32 v62, 0, v68, s[64:65]
    v_cndmask_b32 v63, 0, v69, s[64:65]
    v_cvt_pk_bf16_f32 v64, v64, v65
    v_cvt_pk_bf16_f32 v65, v66, v67
    v_cndmask_b32 v66, 0, v68, s[66:67]
    v_cndmask_b32 v67, 0, v69, s[66:67]
    s_setprio 3
    s_barrier
    ds_read_b64 v[72:73], v19 offset:0
    ds_read_b64 v[74:75], v20 offset:0
    ds_read_b64 v[76:77], v21 offset:0
    ds_read_b64 v[78:79], v22 offset:0
    ds_read_b64 v[80:81], v19 offset:896
    ds_read_b64 v[82:83], v20 offset:896
    ds_read_b64 v[84:85], v21 offset:896
    ds_read_b64 v[86:87], v22 offset:896
    ds_read_b64 v[88:89], v19 offset:1792
    ds_read_b64 v[90:91], v20 offset:1792
    ds_read_b64 v[92:93], v21 offset:1792
    ds_read_b64 v[94:95], v22 offset:1792
    ds_read_b64 v[96:97], v19 offset:2688
    ds_read_b64 v[98:99], v20 offset:2688
    ds_read_b64 v[100:101], v21 offset:2688
    ds_read_b64 v[102:103], v22 offset:2688
    s_waitcnt lgkmcnt(12)
    v_mfma_f32_16x16x32_bf16 v[108:111], v[76:79], v[32:35], 0
    v_mfma_f32_16x16x32_bf16 v[104:107], v[72:75], v[32:35], 0
    s_waitcnt lgkmcnt(8)
    v_mfma_f32_16x16x32_bf16 v[116:119], v[84:87], v[36:39], 0
    v_mfma_f32_16x16x32_bf16 v[112:115], v[80:83], v[36:39], 0
    s_waitcnt lgkmcnt(4)
    v_mfma_f32_16x16x32_bf16 v[124:127], v[92:95], v[40:43], 0
    v_mfma_f32_16x16x32_bf16 v[120:123], v[88:91], v[40:43], 0
    s_waitcnt lgkmcnt(0)
    v_mfma_f32_16x16x32_bf16 v[132:135], v[100:103], v[44:47], 0
    v_mfma_f32_16x16x32_bf16 v[128:131], v[96:99], v[44:47], 0
    v_mfma_f32_16x16x32_bf16 v[140:143], v[76:79], v[52:55], 0
    v_add_f32 v109, s75, v109
    v_add_f32 v117, s75, v117
    v_mfma_f32_16x16x32_bf16 v[136:139], v[72:75], v[52:55], 0
    v_add_f32 v125, s75, v125
    s_nop 1
    v_add_f32 v133, s75, v133
    v_mfma_f32_16x16x32_bf16 v[148:151], v[84:87], v[56:59], 0
    v_rcp_f32 v109, v109
    v_rcp_f32 v117, v117
    v_mfma_f32_16x16x32_bf16 v[144:147], v[80:83], v[56:59], 0
    v_rcp_f32 v125, v125
    v_rcp_f32 v133, v133
    v_mfma_f32_16x16x32_bf16 v[156:159], v[92:95], v[60:63], 0
    v_mul_f32 v104, v104, v109
    v_mul_f32 v105, v105, v109
    v_mfma_f32_16x16x32_bf16 v[152:155], v[88:91], v[60:63], 0
    v_mul_f32 v106, v106, v109
    v_mul_f32 v107, v107, v109
    v_mfma_f32_16x16x32_bf16 v[164:167], v[100:103], v[64:67], 0
    v_mul_f32 v108, v108, v109
    v_cvt_pk_bf16_f32 v40, v104, v105
    v_mfma_f32_16x16x32_bf16 v[160:163], v[96:99], v[64:67], 0
    v_cvt_pk_bf16_f32 v41, v106, v107
    v_mul_f32 v112, v112, v117
    v_mul_f32 v113, v113, v117
    v_mul_f32 v114, v114, v117
    v_mul_f32 v115, v115, v117
    v_mul_f32 v116, v116, v117
    v_cvt_pk_bf16_f32 v42, v112, v113
    v_cvt_pk_bf16_f32 v43, v114, v115
    v_mul_f32 v120, v120, v125
    v_mul_f32 v121, v121, v125
    v_mul_f32 v122, v122, v125
    v_mul_f32 v123, v123, v125
    v_mul_f32 v124, v124, v125
    v_cvt_pk_bf16_f32 v48, v120, v121
    v_cvt_pk_bf16_f32 v49, v122, v123
    v_mul_f32 v128, v128, v133
    v_mul_f32 v129, v129, v133
    v_mul_f32 v130, v130, v133
    v_mul_f32 v131, v131, v133
    v_mul_f32 v132, v132, v133
    v_cvt_pk_bf16_f32 v50, v128, v129
    v_cvt_pk_bf16_f32 v51, v130, v131
    v_cvt_pk_bf16_f32 v168, v108, v116
    v_cvt_pk_bf16_f32 v169, v124, v132
    s_cmp_eq_u32 s80, s98
    s_cbranch_scc1 LA_st0_l2
    buffer_store_dwordx4 v[40:43], v23, s[48:51], 0 offen sc1
    buffer_store_dwordx4 v[48:51], v23, s[48:51], 0 offen offset:2560 sc1
    buffer_store_dwordx2 v[168:169], v24, s[48:51], 0 offen sc1
    s_branch LA_st0_e
LA_st0_l2:
    buffer_store_dwordx4 v[40:43], v23, s[48:51], 0 offen
    buffer_store_dwordx4 v[48:51], v23, s[48:51], 0 offen offset:2560
    buffer_store_dwordx2 v[168:169], v24, s[48:51], 0 offen
LA_st0_e:
    v_add_f32 v141, s75, v141
    v_add_f32 v149, s75, v149
    v_add_f32 v157, s75, v157
    v_add_f32 v165, s75, v165
    v_rcp_f32 v141, v141
    v_rcp_f32 v149, v149
    v_rcp_f32 v157, v157
    v_rcp_f32 v165, v165
    v_mul_f32 v136, v136, v141
    v_mul_f32 v137, v137, v141
    v_mul_f32 v138, v138, v141
    v_mul_f32 v139, v139, v141
    v_mul_f32 v140, v140, v141
    v_cvt_pk_bf16_f32 v44, v136, v137
    v_cvt_pk_bf16_f32 v45, v138, v139
    v_mul_f32 v144, v144, v149
    v_mul_f32 v145, v145, v149
    v_mul_f32 v146, v146, v149
    v_mul_f32 v147, v147, v149
    v_mul_f32 v148, v148, v149
    v_cvt_pk_bf16_f32 v46, v144, v145
    v_cvt_pk_bf16_f32 v47, v146, v147
    v_mul_f32 v152, v152, v157
    v_mul_f32 v153, v153, v157
    v_mul_f32 v154, v154, v157
    v_mul_f32 v155, v155, v157
    v_mul_f32 v156, v156, v157
    v_cvt_pk_bf16_f32 v52, v152, v153
    v_cvt_pk_bf16_f32 v53, v154, v155
    v_mul_f32 v160, v160, v165
    v_mul_f32 v161, v161, v165
    v_mul_f32 v162, v162, v165
    v_mul_f32 v163, v163, v165
    v_mul_f32 v164, v164, v165
    v_cvt_pk_bf16_f32 v54, v160, v161
    v_cvt_pk_bf16_f32 v55, v162, v163
    v_cvt_pk_bf16_f32 v170, v140, v148
    v_cvt_pk_bf16_f32 v171, v156, v164
    s_cmp_eq_u32 s80, s98
    s_cbranch_scc1 LA_st1_l2
    buffer_store_dwordx4 v[44:47], v23, s[48:51], s23 offen sc1
    buffer_store_dwordx4 v[52:55], v23, s[48:51], s23 offen offset:2560 sc1
    buffer_store_dwordx2 v[170:171], v24, s[48:51], s23 offen sc1
    s_branch LA_st1_e
LA_st1_l2:
    buffer_store_dwordx4 v[44:47], v23, s[48:51], s23 offen
    buffer_store_dwordx4 v[52:55], v23, s[48:51], s23 offen offset:2560
    buffer_store_dwordx2 v[170:171], v24, s[48:51], s23 offen
LA_st1_e:
    s_barrier
    s_waitcnt vmcnt(0)
    s_lshl_b32 s76, s55, 2
    s_add_u32 s76, s76, s19
    v_mov_b32 v1, 1
    s_mov_b64 exec, 1
    s_cmp_eq_u32 s80, s98
    s_cbranch_scc1 LA_fl_l2
    buffer_store_dword v1, off, s[36:39], s76 sc1
    s_branch LA_fl_e
LA_fl_l2:
    buffer_store_dword v1, off, s[36:39], s76
LA_fl_e:
    s_mov_b64 exec, -1
    s_mov_b32 s13, 0
    s_branch LP2
L_AC:
    v_mov_b32 v176, 0
    v_mov_b32 v177, 0
    v_mov_b32 v178, 0
    v_mov_b32 v179, 0
    v_mov_b32 v20, 158720
    v_mov_b32 v21, 1
    ds_write_b128 v20, v[176:179]
    ds_write_b128 v20, v[176:179] offset:16
    s_mul_i32 s80, s53, 12288
    s_add_u32 s80, s80, 102400
    v_and_b32 v1, 15, v0
    v_lshrrev_b32 v2, 4, v0
    v_and_b32 v3, 7, v0
    v_xor_b32 v2, v2, v3
    v_lshlrev_b32 v1, 7, v1
    v_lshl_add_u32 v1, v2, 4, v1
    v_add_u32 v4, s80, v1
    v_xor_b32 v5, 64, v4
    v_lshrrev_b32 v1, 2, v0
    v_mul_u32_u24 v1, 160, v1
    v_and_b32 v2, 3, v0
    v_lshl_add_u32 v6, v2, 3, v1
    v_mul_u32_u24 v2, 40, v2
    v_add3_u32 v8, v1, v2, 32
    v_add_u32 v7, 61440, v6
    v_add_u32 v9, 61440, v8
    v_mov_b32 v32, 0x358637bd
    v_mov_b32 v33, 0x358637bd
    v_mov_b32 v34, 0x358637bd
    v_mov_b32 v35, 0x358637bd
    s_waitcnt lgkmcnt(0)
    s_barrier
    ds_read_b128 a[24:27], v4 offset:0
    ds_read_b128 a[28:31], v4 offset:2048
    ds_read_b128 a[32:35], v5 offset:0
    ds_read_b128 a[36:39], v5 offset:2048
    ds_read_b64_tr_b16 a[0:1], v6 offset:20480
    ds_read_b64_tr_b16 a[2:3], v6 offset:23040
    ds_read_b64_tr_b16 a[4:5], v6 offset:20520
    ds_read_b64_tr_b16 a[6:7], v6 offset:23080
    ds_read_b64_tr_b16 a[8:9], v6 offset:20560
    ds_read_b64_tr_b16 a[10:11], v6 offset:23120
    ds_read_b64_tr_b16 a[12:13], v6 offset:20600
    ds_read_b64_tr_b16 a[14:15], v6 offset:23160
    ds_read_b64_tr_b16 a[16:17], v8 offset:20480
    ds_read_b64_tr_b16 a[18:19], v8 offset:23040
    s_waitcnt lgkmcnt(6)
    v_mfma_f32_16x16x32_bf16 v[60:63], a[24:27], a[0:3], v[32:35]
    ds_read_b64_tr_b16 a[20:21], v6 offset:25600
    s_mov_b32 s32, s8
    v_mfma_f32_16x16x32_bf16 v[64:67], a[28:31], a[0:3], v[32:35]
    ds_read_b64_tr_b16 a[22:23], v6 offset:28160
    s_mov_b32 s33, s9
    v_mfma_f32_16x16x32_bf16 v[68:71], a[24:27], a[4:7], v[32:35]
    ds_read_b64_tr_b16 a[0:1], v6 offset:25640
    s_mov_b32 s34, 819200
    v_mfma_f32_16x16x32_bf16 v[72:75], a[28:31], a[4:7], v[32:35]
    ds_read_b64_tr_b16 a[2:3], v6 offset:28200
    s_mov_b32 s35, 0x20000
    s_waitcnt lgkmcnt(6)
    v_mfma_f32_16x16x32_bf16 v[76:79], a[24:27], a[8:11], v[32:35]
    ds_read_b64_tr_b16 a[4:5], v6 offset:25680
    s_mov_b32 s48, s16
    v_mfma_f32_16x16x32_bf16 v[80:83], a[28:31], a[8:11], v[32:35]
    ds_read_b64_tr_b16 a[6:7], v6 offset:28240
    s_mov_b32 s49, s17
    v_mfma_f32_16x16x32_bf16 v[84:87], a[24:27], a[12:15], v[32:35]
    ds_read_b64_tr_b16 a[8:9], v6 offset:25720
    s_mov_b32 s50, 5242880
    v_mfma_f32_16x16x32_bf16 v[88:91], a[28:31], a[12:15], v[32:35]
    ds_read_b64_tr_b16 a[10:11], v6 offset:28280
    s_mov_b32 s51, 0x20000
    s_waitcnt lgkmcnt(6)
    v_mfma_f32_16x16x32_bf16 v[92:95], a[24:27], a[16:19], v[32:35]
    ds_read_b64_tr_b16 a[12:13], v8 offset:25600
    s_mov_b32 s44, s18
    v_mfma_f32_16x16x32_bf16 v[96:99], a[28:31], a[16:19], v[32:35]
    ds_read_b64_tr_b16 a[14:15], v8 offset:28160
    s_mov_b32 s45, s19
    s_barrier
    v_mfma_f32_16x16x32_bf16 v[60:63], a[32:35], a[20:23], v[60:63]
    ds_read_b64_tr_b16 a[16:17], v6 offset:40960
    ds_read_b128 a[40:43], v4 offset:4096
    v_mfma_f32_16x16x32_bf16 v[64:67], a[36:39], a[20:23], v[64:67]
    ds_read_b64_tr_b16 a[18:19], v6 offset:43520
    ds_read_b128 a[44:47], v4 offset:6144
    s_waitcnt lgkmcnt(8)
    v_mfma_f32_16x16x32_bf16 v[68:71], a[32:35], a[0:3], v[68:71]
    ds_read_b64_tr_b16 a[20:21], v6 offset:41000
    ds_read_b128 a[48:51], v5 offset:4096
    v_mfma_f32_16x16x32_bf16 v[72:75], a[36:39], a[0:3], v[72:75]
    ds_read_b64_tr_b16 a[22:23], v6 offset:43560
    ds_read_b128 a[52:55], v5 offset:6144
    v_mfma_f32_16x16x32_bf16 v[76:79], a[32:35], a[4:7], v[76:79]
    ds_read_b64_tr_b16 a[0:1], v6 offset:41040
    s_mov_b32 s46, 256
    v_mfma_f32_16x16x32_bf16 v[80:83], a[36:39], a[4:7], v[80:83]
    ds_read_b64_tr_b16 a[2:3], v6 offset:43600
    s_mov_b32 s47, 0x20000
    s_waitcnt lgkmcnt(10)
    v_mfma_f32_16x16x32_bf16 v[84:87], a[32:35], a[8:11], v[84:87]
    ds_read_b64_tr_b16 a[4:5], v6 offset:41080
    s_mov_b32 s36, s20
    v_mfma_f32_16x16x32_bf16 v[88:91], a[36:39], a[8:11], v[88:91]
    ds_read_b64_tr_b16 a[6:7], v6 offset:43640
    s_mov_b32 s37, s21
    v_mfma_f32_16x16x32_bf16 v[92:95], a[32:35], a[12:15], v[92:95]
    ds_read_b64_tr_b16 a[8:9], v8 offset:40960
    s_mov_b32 s38, 8388608
    v_mfma_f32_16x16x32_bf16 v[96:99], a[36:39], a[12:15], v[96:99]
    ds_read_b64_tr_b16 a[10:11], v8 offset:43520
    s_mov_b32 s39, 0x20000
    s_waitcnt lgkmcnt(6)
    v_mfma_f32_16x16x32_bf16 v[60:63], a[40:43], a[16:19], v[60:63]
    ds_read_b64_tr_b16 a[12:13], v6 offset:46080
    s_mov_b32 s23, 40960
    v_mfma_f32_16x16x32_bf16 v[64:67], a[44:47], a[16:19], v[64:67]
    ds_read_b64_tr_b16 a[14:15], v6 offset:48640
    s_mul_i32 s20, s53, 5120
    v_mfma_f32_16x16x32_bf16 v[68:71], a[40:43], a[20:23], v[68:71]
    ds_read_b64_tr_b16 a[16:17], v6 offset:46120
    s_mul_i32 s21, s53, 51200
    v_mfma_f32_16x16x32_bf16 v[72:75], a[44:47], a[20:23], v[72:75]
    ds_read_b64_tr_b16 a[18:19], v6 offset:48680
    s_mul_i32 s22, s53, 204800
    s_waitcnt lgkmcnt(6)
    v_mfma_f32_16x16x32_bf16 v[76:79], a[40:43], a[0:3], v[76:79]
    ds_read_b64_tr_b16 a[20:21], v6 offset:46160
    s_getreg_b32 s76, hwreg(HW_REG_XCC_ID, 0, 3)
    v_mfma_f32_16x16x32_bf16 v[80:83], a[44:47], a[0:3], v[80:83]
    ds_read_b64_tr_b16 a[22:23], v6 offset:48720
    s_lshl_b32 s76, s76, 2
    v_mfma_f32_16x16x32_bf16 v[84:87], a[40:43], a[4:7], v[84:87]
    ds_read_b64_tr_b16 a[0:1], v6 offset:46200
    s_lshl_b32 s99, 1, s76
    v_mfma_f32_16x16x32_bf16 v[88:91], a[44:47], a[4:7], v[88:91]
    ds_read_b64_tr_b16 a[2:3], v6 offset:48760
    s_lshl_b32 s98, 8, s76
    s_waitcnt lgkmcnt(6)
    v_mfma_f32_16x16x32_bf16 v[92:95], a[40:43], a[8:11], v[92:95]
    ds_read_b64_tr_b16 a[4:5], v8 offset:46080
    s_lshr_b32 s93, s55, 2
    v_mfma_f32_16x16x32_bf16 v[96:99], a[44:47], a[8:11], v[96:99]
    ds_read_b64_tr_b16 a[6:7], v8 offset:48640
    s_xor_b32 s93, s93, 1
    s_barrier
    v_mfma_f32_16x16x32_bf16 v[60:63], a[48:51], a[12:15], v[60:63]
    ds_read_b64_tr_b16 a[8:9], v7 offset:20480
    ds_read_b128 a[56:59], v4 offset:8192
    v_mfma_f32_16x16x32_bf16 v[64:67], a[52:55], a[12:15], v[64:67]
    ds_read_b64_tr_b16 a[10:11], v7 offset:23040
    ds_read_b128 a[60:63], v4 offset:10240
    s_waitcnt lgkmcnt(8)
    v_mfma_f32_16x16x32_bf16 v[68:71], a[48:51], a[16:19], v[68:71]
    ds_read_b64_tr_b16 a[12:13], v7 offset:20520
    ds_read_b128 a[64:67], v5 offset:8192
    v_mfma_f32_16x16x32_bf16 v[72:75], a[52:55], a[16:19], v[72:75]
    ds_read_b64_tr_b16 a[14:15], v7 offset:23080
    ds_read_b128 a[68:71], v5 offset:10240
    v_mfma_f32_16x16x32_bf16 v[76:79], a[48:51], a[20:23], v[76:79]
    ds_read_b64_tr_b16 a[16:17], v7 offset:20560
    s_lshl_b32 s92, s54, 3
    v_mfma_f32_16x16x32_bf16 v[80:83], a[52:55], a[20:23], v[80:83]
    ds_read_b64_tr_b16 a[18:19], v7 offset:23120
    s_lshl_b32 s76, s53, 1
    s_waitcnt lgkmcnt(10)
    v_mfma_f32_16x16x32_bf16 v[84:87], a[48:51], a[0:3], v[84:87]
    ds_read_b64_tr_b16 a[20:21], v7 offset:20600
    s_add_u32 s92, s92, s76
    v_mfma_f32_16x16x32_bf16 v[88:91], a[52:55], a[0:3], v[88:91]
    ds_read_b64_tr_b16 a[22:23], v7 offset:23160
    s_mul_i32 s92, s92, 40960
    v_mfma_f32_16x16x32_bf16 v[92:95], a[48:51], a[4:7], v[92:95]
    ds_read_b64_tr_b16 a[0:1], v9 offset:20480
    s_add_u32 s92, s92, 0
    v_mfma_f32_16x16x32_bf16 v[96:99], a[52:55], a[4:7], v[96:99]
    ds_read_b64_tr_b16 a[2:3], v9 offset:23040
    s_lshl_b32 s97, s54, 2
    s_waitcnt lgkmcnt(7)
    v_mfma_f32_16x16x32_bf16 v[100:103], a[24:27], a[8:11], 0
    ds_read_b64_tr_b16 a[4:5], v7 offset:25600
    s_add_u32 s19, s97, s53
    v_mfma_f32_16x16x32_bf16 v[104:107], a[28:31], a[8:11], 0
    ds_read_b64_tr_b16 a[6:7], v7 offset:28160
    s_lshl_b32 s19, s19, 7
    v_mfma_f32_16x16x32_bf16 v[108:111], a[24:27], a[12:15], 0
    ds_read_b64_tr_b16 a[8:9], v7 offset:25640
    s_add_u32 s19, s19, 6815744
    v_mfma_f32_16x16x32_bf16 v[112:115], a[28:31], a[12:15], 0
    ds_read_b64_tr_b16 a[10:11], v7 offset:28200
    s_add_u32 s97, s97, 32
    s_waitcnt lgkmcnt(6)
    v_mfma_f32_16x16x32_bf16 v[116:119], a[24:27], a[16:19], 0
    ds_read_b64_tr_b16 a[12:13], v7 offset:25680
    s_mov_b32 s76, 40960
    v_mfma_f32_16x16x32_bf16 v[120:123], a[28:31], a[16:19], 0
    ds_read_b64_tr_b16 a[14:15], v7 offset:28240
    s_mov_b32 s77, 61440
    v_mfma_f32_16x16x32_bf16 v[124:127], a[24:27], a[20:23], 0
    ds_read_b64_tr_b16 a[16:17], v7 offset:25720
    s_cmp_eq_u32 s93, 0
    v_mfma_f32_16x16x32_bf16 v[128:131], a[28:31], a[20:23], 0
    ds_read_b64_tr_b16 a[18:19], v7 offset:28280
    s_cselect_b32 s78, 0, s76
    s_waitcnt lgkmcnt(6)
    v_mfma_f32_16x16x32_bf16 v[132:135], a[24:27], a[0:3], 0
    ds_read_b64_tr_b16 a[20:21], v9 offset:25600
    s_cselect_b32 s79, 20480, s77
    v_mfma_f32_16x16x32_bf16 v[136:139], a[28:31], a[0:3], 0
    ds_read_b64_tr_b16 a[22:23], v9 offset:28160
    s_add_u32 s76, s55, 0
    v_mfma_f32_16x16x32_bf16 v[100:103], a[32:35], a[4:7], v[100:103]
    ds_read_b64_tr_b16 a[0:1], v6 offset:0
    s_and_b32 s76, s76, 3
    v_mfma_f32_16x16x32_bf16 v[104:107], a[36:39], a[4:7], v[104:107]
    ds_read_b64_tr_b16 a[2:3], v6 offset:2560
    s_lshl_b32 s77, s93, 2
    s_waitcnt lgkmcnt(6)
    v_mfma_f32_16x16x32_bf16 v[108:111], a[32:35], a[8:11], v[108:111]
    ds_read_b64_tr_b16 a[4:5], v6 offset:40
    s_add_u32 s77, s77, s76
    v_mfma_f32_16x16x32_bf16 v[112:115], a[36:39], a[8:11], v[112:115]
    ds_read_b64_tr_b16 a[6:7], v6 offset:2600
    s_mul_i32 s82, s77, 5120
    v_mfma_f32_16x16x32_bf16 v[116:119], a[32:35], a[12:15], v[116:119]
    ds_read_b64_tr_b16 a[8:9], v6 offset:80
    s_cmp_ge_u32 s76, 2
    v_mfma_f32_16x16x32_bf16 v[120:123], a[36:39], a[12:15], v[120:123]
    ds_read_b64_tr_b16 a[10:11], v6 offset:2640
    s_cselect_b32 s77, s79, s78
    s_waitcnt lgkmcnt(6)
    v_mfma_f32_16x16x32_bf16 v[124:127], a[32:35], a[16:19], v[124:127]
    ds_read_b64_tr_b16 a[12:13], v6 offset:120
    s_and_b32 s76, s76, 1
    v_mfma_f32_16x16x32_bf16 v[128:131], a[36:39], a[16:19], v[128:131]
    ds_read_b64_tr_b16 a[14:15], v6 offset:2680
    s_mul_i32 s76, s76, 10240
    v_mfma_f32_16x16x32_bf16 v[132:135], a[32:35], a[20:23], v[132:135]
    ds_read_b64_tr_b16 a[16:17], v8 offset:0
    s_add_u32 s87, s77, s76
    v_mfma_f32_16x16x32_bf16 v[136:139], a[36:39], a[20:23], v[136:139]
    ds_read_b64_tr_b16 a[18:19], v8 offset:2560
    s_add_u32 s76, s55, 1
    s_waitcnt lgkmcnt(6)
    v_mfma_f32_16x16x32_bf16 v[60:63], a[56:59], a[0:3], v[60:63]
    ds_read_b64_tr_b16 a[20:21], v6 offset:5120
    s_and_b32 s76, s76, 3
    v_mfma_f32_16x16x32_bf16 v[64:67], a[60:63], a[0:3], v[64:67]
    ds_read_b64_tr_b16 a[22:23], v6 offset:7680
    s_lshl_b32 s77, s93, 2
    v_mfma_f32_16x16x32_bf16 v[68:71], a[56:59], a[4:7], v[68:71]
    ds_read_b64_tr_b16 a[0:1], v6 offset:5160
    s_add_u32 s77, s77, s76
    v_mfma_f32_16x16x32_bf16 v[72:75], a[60:63], a[4:7], v[72:75]
    ds_read_b64_tr_b16 a[2:3], v6 offset:7720
    s_mul_i32 s83, s77, 5120
    s_waitcnt lgkmcnt(6)
    v_mfma_f32_16x16x32_bf16 v[76:79], a[56:59], a[8:11], v[76:79]
    ds_read_b64_tr_b16 a[4:5], v6 offset:5200
    s_cmp_ge_u32 s76, 2
    v_mfma_f32_16x16x32_bf16 v[80:83], a[60:63], a[8:11], v[80:83]
    ds_read_b64_tr_b16 a[6:7], v6 offset:7760
    s_cselect_b32 s77, s79, s78
    v_mfma_f32_16x16x32_bf16 v[84:87], a[56:59], a[12:15], v[84:87]
    ds_read_b64_tr_b16 a[8:9], v6 offset:5240
    s_and_b32 s76, s76, 1
    v_mfma_f32_16x16x32_bf16 v[88:91], a[60:63], a[12:15], v[88:91]
    ds_read_b64_tr_b16 a[10:11], v6 offset:7800
    s_mul_i32 s76, s76, 10240
    s_waitcnt lgkmcnt(6)
    v_mfma_f32_16x16x32_bf16 v[92:95], a[56:59], a[16:19], v[92:95]
    ds_read_b64_tr_b16 a[12:13], v8 offset:5120
    s_add_u32 s88, s77, s76
    v_mfma_f32_16x16x32_bf16 v[96:99], a[60:63], a[16:19], v[96:99]
    ds_read_b64_tr_b16 a[14:15], v8 offset:7680
    s_add_u32 s76, s55, 2
    s_barrier
    v_mfma_f32_16x16x32_bf16 v[60:63], a[64:67], a[20:23], v[60:63]
    ds_read_b64_tr_b16 a[16:17], v7 offset:30720
    ds_read_b128 a[24:27], v4 offset:0
    v_mfma_f32_16x16x32_bf16 v[64:67], a[68:71], a[20:23], v[64:67]
    ds_read_b64_tr_b16 a[18:19], v7 offset:33280
    ds_read_b128 a[28:31], v4 offset:2048
    s_waitcnt lgkmcnt(8)
    v_mfma_f32_16x16x32_bf16 v[68:71], a[64:67], a[0:3], v[68:71]
    ds_read_b64_tr_b16 a[20:21], v7 offset:30760
    ds_read_b128 a[32:35], v5 offset:0
    v_mfma_f32_16x16x32_bf16 v[72:75], a[68:71], a[0:3], v[72:75]
    ds_read_b64_tr_b16 a[22:23], v7 offset:33320
    ds_read_b128 a[36:39], v5 offset:2048
    v_mfma_f32_16x16x32_bf16 v[76:79], a[64:67], a[4:7], v[76:79]
    ds_read_b64_tr_b16 a[0:1], v7 offset:30800
    s_and_b32 s76, s76, 3
    v_mfma_f32_16x16x32_bf16 v[80:83], a[68:71], a[4:7], v[80:83]
    ds_read_b64_tr_b16 a[2:3], v7 offset:33360
    s_lshl_b32 s77, s93, 2
    s_waitcnt lgkmcnt(10)
    v_mfma_f32_16x16x32_bf16 v[84:87], a[64:67], a[8:11], v[84:87]
    ds_read_b64_tr_b16 a[4:5], v7 offset:30840
    s_add_u32 s77, s77, s76
    v_mfma_f32_16x16x32_bf16 v[88:91], a[68:71], a[8:11], v[88:91]
    ds_read_b64_tr_b16 a[6:7], v7 offset:33400
    s_mul_i32 s84, s77, 5120
    v_mfma_f32_16x16x32_bf16 v[92:95], a[64:67], a[12:15], v[92:95]
    ds_read_b64_tr_b16 a[8:9], v9 offset:30720
    s_cmp_ge_u32 s76, 2
    v_mfma_f32_16x16x32_bf16 v[96:99], a[68:71], a[12:15], v[96:99]
    ds_read_b64_tr_b16 a[10:11], v9 offset:33280
    s_cselect_b32 s77, s79, s78
    s_waitcnt lgkmcnt(7)
    v_mfma_f32_16x16x32_bf16 v[100:103], a[40:43], a[16:19], v[100:103]
    ds_read_b64_tr_b16 a[12:13], v7 offset:35840
    s_and_b32 s76, s76, 1
    v_mfma_f32_16x16x32_bf16 v[104:107], a[44:47], a[16:19], v[104:107]
    ds_read_b64_tr_b16 a[14:15], v7 offset:38400
    s_mul_i32 s76, s76, 10240
    v_mfma_f32_16x16x32_bf16 v[108:111], a[40:43], a[20:23], v[108:111]
    ds_read_b64_tr_b16 a[16:17], v7 offset:35880
    s_add_u32 s89, s77, s76
    v_mfma_f32_16x16x32_bf16 v[112:115], a[44:47], a[20:23], v[112:115]
    ds_read_b64_tr_b16 a[18:19], v7 offset:38440
    s_add_u32 s76, s55, 3
    s_waitcnt lgkmcnt(6)
    v_mfma_f32_16x16x32_bf16 v[116:119], a[40:43], a[0:3], v[116:119]
    ds_read_b64_tr_b16 a[20:21], v7 offset:35920
    s_and_b32 s76, s76, 3
    v_mfma_f32_16x16x32_bf16 v[120:123], a[44:47], a[0:3], v[120:123]
    ds_read_b64_tr_b16 a[22:23], v7 offset:38480
    s_lshl_b32 s77, s93, 2
    v_mfma_f32_16x16x32_bf16 v[124:127], a[40:43], a[4:7], v[124:127]
    ds_read_b64_tr_b16 a[0:1], v7 offset:35960
    s_add_u32 s77, s77, s76
    v_mfma_f32_16x16x32_bf16 v[128:131], a[44:47], a[4:7], v[128:131]
    ds_read_b64_tr_b16 a[2:3], v7 offset:38520
    s_mul_i32 s85, s77, 5120
    s_waitcnt lgkmcnt(6)
    v_mfma_f32_16x16x32_bf16 v[132:135], a[40:43], a[8:11], v[132:135]
    ds_read_b64_tr_b16 a[4:5], v9 offset:35840
    s_cmp_ge_u32 s76, 2
    v_mfma_f32_16x16x32_bf16 v[136:139], a[44:47], a[8:11], v[136:139]
    ds_read_b64_tr_b16 a[6:7], v9 offset:38400
    s_cselect_b32 s77, s79, s78
    v_mfma_f32_16x16x32_bf16 v[100:103], a[48:51], a[12:15], v[100:103]
    ds_read_b64_tr_b16 a[8:9], v6 offset:10240
    s_and_b32 s76, s76, 1
    v_mfma_f32_16x16x32_bf16 v[104:107], a[52:55], a[12:15], v[104:107]
    ds_read_b64_tr_b16 a[10:11], v6 offset:12800
    s_mul_i32 s76, s76, 10240
    s_waitcnt lgkmcnt(6)
    v_mfma_f32_16x16x32_bf16 v[108:111], a[48:51], a[16:19], v[108:111]
    ds_read_b64_tr_b16 a[12:13], v6 offset:10280
    s_add_u32 s90, s77, s76
    v_mfma_f32_16x16x32_bf16 v[112:115], a[52:55], a[16:19], v[112:115]
    ds_read_b64_tr_b16 a[14:15], v6 offset:12840
    s_mul_i32 s76, s93, 10240
    v_mfma_f32_16x16x32_bf16 v[116:119], a[48:51], a[20:23], v[116:119]
    ds_read_b64_tr_b16 a[16:17], v6 offset:10320
    s_add_u32 s91, s76, 81920
    v_mfma_f32_16x16x32_bf16 v[120:123], a[52:55], a[20:23], v[120:123]
    ds_read_b64_tr_b16 a[18:19], v6 offset:12880
    s_mul_i32 s86, s93, 20480
    s_waitcnt lgkmcnt(6)
    v_mfma_f32_16x16x32_bf16 v[124:127], a[48:51], a[0:3], v[124:127]
    ds_read_b64_tr_b16 a[20:21], v6 offset:10360
    s_xor_b32 s79, s52, 4
    v_mfma_f32_16x16x32_bf16 v[128:131], a[52:55], a[0:3], v[128:131]
    ds_read_b64_tr_b16 a[22:23], v6 offset:12920
    s_mul_i32 s94, s52, 5120
    v_mfma_f32_16x16x32_bf16 v[132:135], a[48:51], a[4:7], v[132:135]
    ds_read_b64_tr_b16 a[0:1], v8 offset:10240
    s_add_u32 s94, s94, 102400
    v_mfma_f32_16x16x32_bf16 v[136:139], a[52:55], a[4:7], v[136:139]
    ds_read_b64_tr_b16 a[2:3], v8 offset:12800
    s_mul_i32 s95, s79, 5120
    s_waitcnt lgkmcnt(6)
    v_mfma_f32_16x16x32_bf16 v[60:63], a[24:27], a[8:11], v[60:63]
    ds_read_b64_tr_b16 a[4:5], v6 offset:15360
    s_add_u32 s95, s95, 102400
    v_mfma_f32_16x16x32_bf16 v[64:67], a[28:31], a[8:11], v[64:67]
    ds_read_b64_tr_b16 a[6:7], v6 offset:17920
    s_lshl_b32 s76, s54, 7
    v_mfma_f32_16x16x32_bf16 v[68:71], a[24:27], a[12:15], v[68:71]
    ds_read_b64_tr_b16 a[8:9], v6 offset:15400
    s_lshl_b32 s78, s53, 5
    v_mfma_f32_16x16x32_bf16 v[72:75], a[28:31], a[12:15], v[72:75]
    ds_read_b64_tr_b16 a[10:11], v6 offset:17960
    s_add_u32 s76, s76, s78
    s_waitcnt lgkmcnt(6)
    v_mfma_f32_16x16x32_bf16 v[76:79], a[24:27], a[16:19], v[76:79]
    ds_read_b64_tr_b16 a[12:13], v6 offset:15440
    s_add_u32 s76, s76, 0
    v_mfma_f32_16x16x32_bf16 v[80:83], a[28:31], a[16:19], v[80:83]
    ds_read_b64_tr_b16 a[14:15], v6 offset:18000
    s_mul_i32 s76, s76, 2560
    v_mfma_f32_16x16x32_bf16 v[84:87], a[24:27], a[20:23], v[84:87]
    ds_read_b64_tr_b16 a[16:17], v6 offset:15480
    s_mul_i32 s78, s55, 160
    v_mfma_f32_16x16x32_bf16 v[88:91], a[28:31], a[20:23], v[88:91]
    ds_read_b64_tr_b16 a[18:19], v6 offset:18040
    s_add_u32 s76, s76, s78
    s_waitcnt lgkmcnt(6)
    v_mfma_f32_16x16x32_bf16 v[92:95], a[24:27], a[0:3], v[92:95]
    ds_read_b64_tr_b16 a[20:21], v8 offset:15360
    s_add_u32 s96, s76, 0
    v_mfma_f32_16x16x32_bf16 v[96:99], a[28:31], a[0:3], v[96:99]
    ds_read_b64_tr_b16 a[22:23], v8 offset:17920
    s_movk_i32 s59, -160
    s_barrier
    v_mfma_f32_16x16x32_bf16 v[60:63], a[32:35], a[4:7], v[60:63]
    ds_read_b64_tr_b16 a[0:1], v6 offset:30720
    ds_read_b128 a[40:43], v4 offset:4096
    v_mfma_f32_16x16x32_bf16 v[64:67], a[36:39], a[4:7], v[64:67]
    ds_read_b64_tr_b16 a[2:3], v6 offset:33280
    ds_read_b128 a[44:47], v4 offset:6144
    s_waitcnt lgkmcnt(8)
    v_mfma_f32_16x16x32_bf16 v[68:71], a[32:35], a[8:11], v[68:71]
    ds_read_b64_tr_b16 a[4:5], v6 offset:30760
    ds_read_b128 a[48:51], v5 offset:4096
    v_mfma_f32_16x16x32_bf16 v[72:75], a[36:39], a[8:11], v[72:75]
    ds_read_b64_tr_b16 a[6:7], v6 offset:33320
    ds_read_b128 a[52:55], v5 offset:6144
    v_mfma_f32_16x16x32_bf16 v[76:79], a[32:35], a[12:15], v[76:79]
    ds_read_b64_tr_b16 a[8:9], v6 offset:30800
    s_mul_i32 s78, s55, 160
    v_mfma_f32_16x16x32_bf16 v[80:83], a[36:39], a[12:15], v[80:83]
    ds_read_b64_tr_b16 a[10:11], v6 offset:33360
    s_movk_i32 s58, 1280
    s_waitcnt lgkmcnt(10)
    v_mfma_f32_16x16x32_bf16 v[84:87], a[32:35], a[16:19], v[84:87]
    ds_read_b64_tr_b16 a[12:13], v6 offset:30840
    v_add_u32 v1, 0, v0
    v_mfma_f32_16x16x32_bf16 v[88:91], a[36:39], a[16:19], v[88:91]
    ds_read_b64_tr_b16 a[14:15], v6 offset:33400
    v_mul_u32_u24 v2, 6554, v1
    v_mfma_f32_16x16x32_bf16 v[92:95], a[32:35], a[20:23], v[92:95]
    ds_read_b64_tr_b16 a[16:17], v8 offset:30720
    v_lshrrev_b32 v2, 16, v2
    v_mfma_f32_16x16x32_bf16 v[96:99], a[36:39], a[20:23], v[96:99]
    ds_read_b64_tr_b16 a[18:19], v8 offset:33280
    v_lshl_add_u32 v1, v1, 4, s78
    s_waitcnt lgkmcnt(7)
    v_mfma_f32_16x16x32_bf16 v[100:103], a[56:59], a[0:3], v[100:103]
    ds_read_b64_tr_b16 a[20:21], v6 offset:35840
    v_mad_i32_i24 v1, v2, s59, v1
    v_mfma_f32_16x16x32_bf16 v[104:107], a[60:63], a[0:3], v[104:107]
    ds_read_b64_tr_b16 a[22:23], v6 offset:38400
    v_and_b32 v3, 3, v2
    v_mfma_f32_16x16x32_bf16 v[108:111], a[56:59], a[4:7], v[108:111]
    ds_read_b64_tr_b16 a[0:1], v6 offset:35880
    v_mul_u32_u24 v3, 20, v3
    v_mfma_f32_16x16x32_bf16 v[112:115], a[60:63], a[4:7], v[112:115]
    ds_read_b64_tr_b16 a[2:3], v6 offset:38440
    v_bfe_u32 v23, v2, 2, 2
    s_waitcnt lgkmcnt(6)
    v_mfma_f32_16x16x32_bf16 v[116:119], a[56:59], a[8:11], v[116:119]
    ds_read_b64_tr_b16 a[4:5], v6 offset:35920
    v_add3_u32 v3, v3, v23, 16
    v_mfma_f32_16x16x32_bf16 v[120:123], a[60:63], a[8:11], v[120:123]
    ds_read_b64_tr_b16 a[6:7], v6 offset:38480
    v_lshrrev_b32 v2, 4, v2
    v_mfma_f32_16x16x32_bf16 v[124:127], a[56:59], a[12:15], v[124:127]
    ds_read_b64_tr_b16 a[8:9], v6 offset:35960
    v_mul_u32_u24 v2, 80, v2
    v_mfma_f32_16x16x32_bf16 v[128:131], a[60:63], a[12:15], v[128:131]
    ds_read_b64_tr_b16 a[10:11], v6 offset:38520
    v_add_u32 v3, v3, v2
    s_waitcnt lgkmcnt(6)
    v_mfma_f32_16x16x32_bf16 v[132:135], a[56:59], a[16:19], v[132:135]
    ds_read_b64_tr_b16 a[12:13], v8 offset:35840
    v_mad_u32_u24 v23, v3, s58, v1
    v_mfma_f32_16x16x32_bf16 v[136:139], a[60:63], a[16:19], v[136:139]
    ds_read_b64_tr_b16 a[14:15], v8 offset:38400
    v_add_u32 v1, 64, v0
    v_mfma_f32_16x16x32_bf16 v[100:103], a[64:67], a[20:23], v[100:103]
    ds_read_b64_tr_b16 a[16:17], v6 offset:20480
    v_mul_u32_u24 v2, 6554, v1
    v_mfma_f32_16x16x32_bf16 v[104:107], a[68:71], a[20:23], v[104:107]
    ds_read_b64_tr_b16 a[18:19], v6 offset:23040
    v_lshrrev_b32 v2, 16, v2
    s_waitcnt lgkmcnt(6)
    v_mfma_f32_16x16x32_bf16 v[108:111], a[64:67], a[0:3], v[108:111]
    ds_read_b64_tr_b16 a[20:21], v6 offset:20520
    v_lshl_add_u32 v1, v1, 4, s78
    v_mfma_f32_16x16x32_bf16 v[112:115], a[68:71], a[0:3], v[112:115]
    ds_read_b64_tr_b16 a[22:23], v6 offset:23080
    v_mad_i32_i24 v1, v2, s59, v1
    v_mfma_f32_16x16x32_bf16 v[116:119], a[64:67], a[4:7], v[116:119]
    ds_read_b64_tr_b16 a[0:1], v6 offset:20560
    v_and_b32 v3, 3, v2
    v_mfma_f32_16x16x32_bf16 v[120:123], a[68:71], a[4:7], v[120:123]
    ds_read_b64_tr_b16 a[2:3], v6 offset:23120
    v_mul_u32_u24 v3, 20, v3
    s_waitcnt lgkmcnt(6)
    v_mfma_f32_16x16x32_bf16 v[124:127], a[64:67], a[8:11], v[124:127]
    ds_read_b64_tr_b16 a[4:5], v6 offset:20600
    v_bfe_u32 v24, v2, 2, 2
    v_mfma_f32_16x16x32_bf16 v[128:131], a[68:71], a[8:11], v[128:131]
    ds_read_b64_tr_b16 a[6:7], v6 offset:23160
    v_add3_u32 v3, v3, v24, 16
    v_mfma_f32_16x16x32_bf16 v[132:135], a[64:67], a[12:15], v[132:135]
    ds_read_b64_tr_b16 a[8:9], v8 offset:20480
    v_lshrrev_b32 v2, 4, v2
    v_mfma_f32_16x16x32_bf16 v[136:139], a[68:71], a[12:15], v[136:139]
    ds_read_b64_tr_b16 a[10:11], v8 offset:23040
    v_mul_u32_u24 v2, 80, v2
    s_waitcnt lgkmcnt(6)
    v_mfma_f32_16x16x32_bf16 v[60:63], a[40:43], a[16:19], v[60:63]
    ds_read_b64_tr_b16 a[12:13], v6 offset:25600
    v_add_u32 v3, v3, v2
    v_mfma_f32_16x16x32_bf16 v[64:67], a[44:47], a[16:19], v[64:67]
    ds_read_b64_tr_b16 a[14:15], v6 offset:28160
    v_mad_u32_u24 v24, v3, s58, v1
    v_mfma_f32_16x16x32_bf16 v[68:71], a[40:43], a[20:23], v[68:71]
    ds_read_b64_tr_b16 a[16:17], v6 offset:25640
    v_add_u32 v1, 128, v0
    v_mfma_f32_16x16x32_bf16 v[72:75], a[44:47], a[20:23], v[72:75]
    ds_read_b64_tr_b16 a[18:19], v6 offset:28200
    v_mul_u32_u24 v2, 6554, v1
    s_waitcnt lgkmcnt(6)
    v_mfma_f32_16x16x32_bf16 v[76:79], a[40:43], a[0:3], v[76:79]
    ds_read_b64_tr_b16 a[20:21], v6 offset:25680
    v_lshrrev_b32 v2, 16, v2
    v_mfma_f32_16x16x32_bf16 v[80:83], a[44:47], a[0:3], v[80:83]
    ds_read_b64_tr_b16 a[22:23], v6 offset:28240
    v_lshl_add_u32 v1, v1, 4, s78
    v_mfma_f32_16x16x32_bf16 v[84:87], a[40:43], a[4:7], v[84:87]
    ds_read_b64_tr_b16 a[0:1], v6 offset:25720
    v_mad_i32_i24 v1, v2, s59, v1
    v_mfma_f32_16x16x32_bf16 v[88:91], a[44:47], a[4:7], v[88:91]
    ds_read_b64_tr_b16 a[2:3], v6 offset:28280
    v_and_b32 v3, 3, v2
    s_waitcnt lgkmcnt(6)
    v_mfma_f32_16x16x32_bf16 v[92:95], a[40:43], a[8:11], v[92:95]
    ds_read_b64_tr_b16 a[4:5], v8 offset:25600
    v_mul_u32_u24 v3, 20, v3
    v_mfma_f32_16x16x32_bf16 v[96:99], a[44:47], a[8:11], v[96:99]
    ds_read_b64_tr_b16 a[6:7], v8 offset:28160
    v_bfe_u32 v25, v2, 2, 2
    s_barrier
    v_mfma_f32_16x16x32_bf16 v[60:63], a[48:51], a[12:15], v[60:63]
    ds_read_b64_tr_b16 a[8:9], v6 offset:51200
    ds_read_b128 a[56:59], v4 offset:8192
    v_mfma_f32_16x16x32_bf16 v[64:67], a[52:55], a[12:15], v[64:67]
    ds_read_b64_tr_b16 a[10:11], v6 offset:53760
    ds_read_b128 a[60:63], v4 offset:10240
    s_waitcnt lgkmcnt(8)
    v_mfma_f32_16x16x32_bf16 v[68:71], a[48:51], a[16:19], v[68:71]
    ds_read_b64_tr_b16 a[12:13], v6 offset:51240
    ds_read_b128 a[64:67], v5 offset:8192
    v_mfma_f32_16x16x32_bf16 v[72:75], a[52:55], a[16:19], v[72:75]
    ds_read_b64_tr_b16 a[14:15], v6 offset:53800
    ds_read_b128 a[68:71], v5 offset:10240
    v_mfma_f32_16x16x32_bf16 v[76:79], a[48:51], a[20:23], v[76:79]
    ds_read_b64_tr_b16 a[16:17], v6 offset:51280
    v_add3_u32 v3, v3, v25, 16
    v_mfma_f32_16x16x32_bf16 v[80:83], a[52:55], a[20:23], v[80:83]
    ds_read_b64_tr_b16 a[18:19], v6 offset:53840
    v_lshrrev_b32 v2, 4, v2
    s_waitcnt lgkmcnt(10)
    v_mfma_f32_16x16x32_bf16 v[84:87], a[48:51], a[0:3], v[84:87]
    ds_read_b64_tr_b16 a[20:21], v6 offset:51320
    v_mul_u32_u24 v2, 80, v2
    v_mfma_f32_16x16x32_bf16 v[88:91], a[52:55], a[0:3], v[88:91]
    ds_read_b64_tr_b16 a[22:23], v6 offset:53880
    v_add_u32 v3, v3, v2
    v_mfma_f32_16x16x32_bf16 v[92:95], a[48:51], a[4:7], v[92:95]
    ds_read_b64_tr_b16 a[0:1], v8 offset:51200
    v_mad_u32_u24 v25, v3, s58, v1
    v_mfma_f32_16x16x32_bf16 v[96:99], a[52:55], a[4:7], v[96:99]
    ds_read_b64_tr_b16 a[2:3], v8 offset:53760
    v_add_u32 v1, 192, v0
    s_waitcnt lgkmcnt(7)
    v_mfma_f32_16x16x32_bf16 v[100:103], a[24:27], a[8:11], v[100:103]
    ds_read_b64_tr_b16 a[4:5], v6 offset:56320
    v_mul_u32_u24 v2, 6554, v1
    v_mfma_f32_16x16x32_bf16 v[104:107], a[28:31], a[8:11], v[104:107]
    ds_read_b64_tr_b16 a[6:7], v6 offset:58880
    v_lshrrev_b32 v2, 16, v2
    v_mfma_f32_16x16x32_bf16 v[108:111], a[24:27], a[12:15], v[108:111]
    ds_read_b64_tr_b16 a[8:9], v6 offset:56360
    v_lshl_add_u32 v1, v1, 4, s78
    v_mfma_f32_16x16x32_bf16 v[112:115], a[28:31], a[12:15], v[112:115]
    ds_read_b64_tr_b16 a[10:11], v6 offset:58920
    v_mad_i32_i24 v1, v2, s59, v1
    s_waitcnt lgkmcnt(6)
    v_mfma_f32_16x16x32_bf16 v[116:119], a[24:27], a[16:19], v[116:119]
    ds_read_b64_tr_b16 a[12:13], v6 offset:56400
    v_and_b32 v3, 3, v2
    v_mfma_f32_16x16x32_bf16 v[120:123], a[28:31], a[16:19], v[120:123]
    ds_read_b64_tr_b16 a[14:15], v6 offset:58960
    v_mul_u32_u24 v3, 20, v3
    v_mfma_f32_16x16x32_bf16 v[124:127], a[24:27], a[20:23], v[124:127]
    ds_read_b64_tr_b16 a[16:17], v6 offset:56440
    v_bfe_u32 v26, v2, 2, 2
    v_mfma_f32_16x16x32_bf16 v[128:131], a[28:31], a[20:23], v[128:131]
    ds_read_b64_tr_b16 a[18:19], v6 offset:59000
    v_add3_u32 v3, v3, v26, 16
    s_waitcnt lgkmcnt(6)
    v_mfma_f32_16x16x32_bf16 v[132:135], a[24:27], a[0:3], v[132:135]
    ds_read_b64_tr_b16 a[20:21], v8 offset:56320
    v_lshrrev_b32 v2, 4, v2
    v_mfma_f32_16x16x32_bf16 v[136:139], a[28:31], a[0:3], v[136:139]
    ds_read_b64_tr_b16 a[22:23], v8 offset:58880
    v_mul_u32_u24 v2, 80, v2
    v_mfma_f32_16x16x32_bf16 v[100:103], a[32:35], a[4:7], v[100:103]
    ds_read_b64_tr_b16 a[0:1], v6 offset:40960
    v_add_u32 v3, v3, v2
    v_mfma_f32_16x16x32_bf16 v[104:107], a[36:39], a[4:7], v[104:107]
    ds_read_b64_tr_b16 a[2:3], v6 offset:43520
    v_mad_u32_u24 v26, v3, s58, v1
    s_waitcnt lgkmcnt(6)
    v_mfma_f32_16x16x32_bf16 v[108:111], a[32:35], a[8:11], v[108:111]
    ds_read_b64_tr_b16 a[4:5], v6 offset:41000
    v_add_u32 v1, 256, v0
    v_mfma_f32_16x16x32_bf16 v[112:115], a[36:39], a[8:11], v[112:115]
    ds_read_b64_tr_b16 a[6:7], v6 offset:43560
    v_mul_u32_u24 v2, 6554, v1
    v_mfma_f32_16x16x32_bf16 v[116:119], a[32:35], a[12:15], v[116:119]
    ds_read_b64_tr_b16 a[8:9], v6 offset:41040
    v_lshrrev_b32 v2, 16, v2
    v_mfma_f32_16x16x32_bf16 v[120:123], a[36:39], a[12:15], v[120:123]
    ds_read_b64_tr_b16 a[10:11], v6 offset:43600
    v_lshl_add_u32 v1, v1, 4, s78
    s_waitcnt lgkmcnt(6)
    v_mfma_f32_16x16x32_bf16 v[124:127], a[32:35], a[16:19], v[124:127]
    ds_read_b64_tr_b16 a[12:13], v6 offset:41080
    v_mad_i32_i24 v1, v2, s59, v1
    v_mfma_f32_16x16x32_bf16 v[128:131], a[36:39], a[16:19], v[128:131]
    ds_read_b64_tr_b16 a[14:15], v6 offset:43640
    v_and_b32 v3, 3, v2
    v_mfma_f32_16x16x32_bf16 v[132:135], a[32:35], a[20:23], v[132:135]
    ds_read_b64_tr_b16 a[16:17], v8 offset:40960
    v_mul_u32_u24 v3, 20, v3
    v_mfma_f32_16x16x32_bf16 v[136:139], a[36:39], a[20:23], v[136:139]
    ds_read_b64_tr_b16 a[18:19], v8 offset:43520
    v_bfe_u32 v27, v2, 2, 2
    s_waitcnt lgkmcnt(6)
    v_mfma_f32_16x16x32_bf16 v[60:63], a[56:59], a[0:3], v[60:63]
    ds_read_b64_tr_b16 a[20:21], v6 offset:46080
    v_add3_u32 v3, v3, v27, 16
    v_mfma_f32_16x16x32_bf16 v[64:67], a[60:63], a[0:3], v[64:67]
    ds_read_b64_tr_b16 a[22:23], v6 offset:48640
    v_lshrrev_b32 v2, 4, v2
    v_mfma_f32_16x16x32_bf16 v[68:71], a[56:59], a[4:7], v[68:71]
    ds_read_b64_tr_b16 a[0:1], v6 offset:46120
    v_mul_u32_u24 v2, 80, v2
    v_mfma_f32_16x16x32_bf16 v[72:75], a[60:63], a[4:7], v[72:75]
    ds_read_b64_tr_b16 a[2:3], v6 offset:48680
    v_add_u32 v3, v3, v2
    s_waitcnt lgkmcnt(6)
    v_mfma_f32_16x16x32_bf16 v[76:79], a[56:59], a[8:11], v[76:79]
    ds_read_b64_tr_b16 a[4:5], v6 offset:46160
    v_mad_u32_u24 v27, v3, s58, v1
    v_mfma_f32_16x16x32_bf16 v[80:83], a[60:63], a[8:11], v[80:83]
    ds_read_b64_tr_b16 a[6:7], v6 offset:48720
    v_and_b32 v1, 15, v0
    v_mfma_f32_16x16x32_bf16 v[84:87], a[56:59], a[12:15], v[84:87]
    ds_read_b64_tr_b16 a[8:9], v6 offset:46200
    v_lshrrev_b32 v2, 4, v0
    v_mfma_f32_16x16x32_bf16 v[88:91], a[60:63], a[12:15], v[88:91]
    ds_read_b64_tr_b16 a[10:11], v6 offset:48760
    v_mov_b32 v36, 0x3f803f80
    s_waitcnt lgkmcnt(6)
    v_mfma_f32_16x16x32_bf16 v[92:95], a[56:59], a[16:19], v[92:95]
    ds_read_b64_tr_b16 a[12:13], v8 offset:46080
    v_mov_b32 v37, 0x3f803f80
    v_mfma_f32_16x16x32_bf16 v[96:99], a[60:63], a[16:19], v[96:99]
    ds_read_b64_tr_b16 a[14:15], v8 offset:48640
    v_mov_b32 v38, 0x3f803f80
    s_barrier
    v_mfma_f32_16x16x32_bf16 v[60:63], a[64:67], a[20:23], v[60:63]
    ds_read_b64_tr_b16 a[16:17], v7 offset:20480
    ds_read_b128 a[24:27], v4 offset:0
    v_mfma_f32_16x16x32_bf16 v[64:67], a[68:71], a[20:23], v[64:67]
    ds_read_b64_tr_b16 a[18:19], v7 offset:23040
    ds_read_b128 a[28:31], v4 offset:2048
    s_waitcnt lgkmcnt(8)
    v_mfma_f32_16x16x32_bf16 v[68:71], a[64:67], a[0:3], v[68:71]
    ds_read_b64_tr_b16 a[20:21], v7 offset:20520
    ds_read_b128 a[32:35], v5 offset:0
    v_mfma_f32_16x16x32_bf16 v[72:75], a[68:71], a[0:3], v[72:75]
    ds_read_b64_tr_b16 a[22:23], v7 offset:23080
    ds_read_b128 a[36:39], v5 offset:2048
    v_mfma_f32_16x16x32_bf16 v[76:79], a[64:67], a[4:7], v[76:79]
    ds_read_b64_tr_b16 a[0:1], v7 offset:20560
    v_mov_b32 v39, 0x3f803f80
    v_mfma_f32_16x16x32_bf16 v[80:83], a[68:71], a[4:7], v[80:83]
    ds_read_b64_tr_b16 a[2:3], v7 offset:23120
    v_mov_b32 v3, 0x3f80
    s_waitcnt lgkmcnt(10)
    v_mfma_f32_16x16x32_bf16 v[84:87], a[64:67], a[8:11], v[84:87]
    ds_read_b64_tr_b16 a[4:5], v7 offset:20600
    v_mov_b32 v30, 0x3f800000
    v_mfma_f32_16x16x32_bf16 v[88:91], a[68:71], a[8:11], v[88:91]
    ds_read_b64_tr_b16 a[6:7], v7 offset:23160
    v_cmp_eq_u32 vcc, 0, v1
    v_mfma_f32_16x16x32_bf16 v[92:95], a[64:67], a[12:15], v[92:95]
    ds_read_b64_tr_b16 a[8:9], v9 offset:20480
    v_cndmask_b32 v56, 0, v3, vcc
    v_mfma_f32_16x16x32_bf16 v[96:99], a[68:71], a[12:15], v[96:99]
    ds_read_b64_tr_b16 a[10:11], v9 offset:23040
    v_cmp_eq_u32 vcc, 1, v1
    s_waitcnt lgkmcnt(7)
    v_mfma_f32_16x16x32_bf16 v[100:103], a[40:43], a[16:19], v[100:103]
    ds_read_b64_tr_b16 a[12:13], v7 offset:25600
    v_cndmask_b32 v56, v56, v30, vcc
    v_mfma_f32_16x16x32_bf16 v[104:107], a[44:47], a[16:19], v[104:107]
    ds_read_b64_tr_b16 a[14:15], v7 offset:28160
    v_cmp_eq_u32 vcc, 2, v1
    v_mfma_f32_16x16x32_bf16 v[108:111], a[40:43], a[20:23], v[108:111]
    ds_read_b64_tr_b16 a[16:17], v7 offset:25640
    v_cndmask_b32 v57, 0, v3, vcc
    v_mfma_f32_16x16x32_bf16 v[112:115], a[44:47], a[20:23], v[112:115]
    ds_read_b64_tr_b16 a[18:19], v7 offset:28200
    v_cmp_eq_u32 vcc, 3, v1
    s_waitcnt lgkmcnt(6)
    v_mfma_f32_16x16x32_bf16 v[116:119], a[40:43], a[0:3], v[116:119]
    ds_read_b64_tr_b16 a[20:21], v7 offset:25680
    v_cndmask_b32 v57, v57, v30, vcc
    v_mfma_f32_16x16x32_bf16 v[120:123], a[44:47], a[0:3], v[120:123]
    ds_read_b64_tr_b16 a[22:23], v7 offset:28240
    v_cmp_eq_u32 vcc, 4, v1
    v_mfma_f32_16x16x32_bf16 v[124:127], a[40:43], a[4:7], v[124:127]
    ds_read_b64_tr_b16 a[0:1], v7 offset:25720
    v_cndmask_b32 v58, 0, v3, vcc
    v_mfma_f32_16x16x32_bf16 v[128:131], a[44:47], a[4:7], v[128:131]
    ds_read_b64_tr_b16 a[2:3], v7 offset:28280
    v_cmp_eq_u32 vcc, 5, v1
    s_waitcnt lgkmcnt(6)
    v_mfma_f32_16x16x32_bf16 v[132:135], a[40:43], a[8:11], v[132:135]
    ds_read_b64_tr_b16 a[4:5], v9 offset:25600
    v_cndmask_b32 v58, v58, v30, vcc
    v_mfma_f32_16x16x32_bf16 v[136:139], a[44:47], a[8:11], v[136:139]
    ds_read_b64_tr_b16 a[6:7], v9 offset:28160
    v_cmp_eq_u32 vcc, 6, v1
    v_mfma_f32_16x16x32_bf16 v[100:103], a[48:51], a[12:15], v[100:103]
    ds_read_b64_tr_b16 a[8:9], v6 offset:0
    v_cndmask_b32 v59, 0, v3, vcc
    v_mfma_f32_16x16x32_bf16 v[104:107], a[52:55], a[12:15], v[104:107]
    ds_read_b64_tr_b16 a[10:11], v6 offset:2560
    v_cmp_eq_u32 vcc, 7, v1
    s_waitcnt lgkmcnt(6)
    v_mfma_f32_16x16x32_bf16 v[108:111], a[48:51], a[16:19], v[108:111]
    ds_read_b64_tr_b16 a[12:13], v6 offset:40
    v_cndmask_b32 v59, v59, v30, vcc
    v_mfma_f32_16x16x32_bf16 v[112:115], a[52:55], a[16:19], v[112:115]
    ds_read_b64_tr_b16 a[14:15], v6 offset:2600
    s_sub_u32 s76, s53, 1
    v_mfma_f32_16x16x32_bf16 v[116:119], a[48:51], a[20:23], v[116:119]
    ds_read_b64_tr_b16 a[16:17], v6 offset:80
    s_and_b32 s76, s76, 3
    v_mfma_f32_16x16x32_bf16 v[120:123], a[52:55], a[20:23], v[120:123]
    ds_read_b64_tr_b16 a[18:19], v6 offset:2640
    s_lshl_b32 s76, s76, 10
    s_waitcnt lgkmcnt(6)
    v_mfma_f32_16x16x32_bf16 v[124:127], a[48:51], a[0:3], v[124:127]
    ds_read_b64_tr_b16 a[20:21], v6 offset:120
    s_add_u32 s24, s76, 0
    v_mfma_f32_16x16x32_bf16 v[128:131], a[52:55], a[0:3], v[128:131]
    ds_read_b64_tr_b16 a[22:23], v6 offset:2680
    s_cmp_eq_u32 s53, 0
    v_mfma_f32_16x16x32_bf16 v[132:135], a[48:51], a[4:7], v[132:135]
    ds_read_b64_tr_b16 a[0:1], v8 offset:0
    s_cselect_b64 s[68:69], 0, -1
    v_mfma_f32_16x16x32_bf16 v[136:139], a[52:55], a[4:7], v[136:139]
    ds_read_b64_tr_b16 a[2:3], v8 offset:2560
    s_sub_u32 s76, s53, 2
    s_waitcnt lgkmcnt(6)
    v_mfma_f32_16x16x32_bf16 v[60:63], a[24:27], a[8:11], v[60:63]
    ds_read_b64_tr_b16 a[4:5], v6 offset:5120
    s_and_b32 s76, s76, 3
    v_mfma_f32_16x16x32_bf16 v[64:67], a[28:31], a[8:11], v[64:67]
    ds_read_b64_tr_b16 a[6:7], v6 offset:7680
    s_lshl_b32 s76, s76, 10
    v_mfma_f32_16x16x32_bf16 v[68:71], a[24:27], a[12:15], v[68:71]
    ds_read_b64_tr_b16 a[8:9], v6 offset:5160
    s_add_u32 s25, s76, 3072
    v_mfma_f32_16x16x32_bf16 v[72:75], a[28:31], a[12:15], v[72:75]
    ds_read_b64_tr_b16 a[10:11], v6 offset:7720
    s_cmp_eq_u32 s53, 1
    s_waitcnt lgkmcnt(6)
    v_mfma_f32_16x16x32_bf16 v[76:79], a[24:27], a[16:19], v[76:79]
    ds_read_b64_tr_b16 a[12:13], v6 offset:5200
    s_cselect_b64 s[70:71], 0, -1
    v_mfma_f32_16x16x32_bf16 v[80:83], a[28:31], a[16:19], v[80:83]
    ds_read_b64_tr_b16 a[14:15], v6 offset:7760
    s_sub_u32 s76, s53, 3
    v_mfma_f32_16x16x32_bf16 v[84:87], a[24:27], a[20:23], v[84:87]
    ds_read_b64_tr_b16 a[16:17], v6 offset:5240
    s_and_b32 s76, s76, 3
    v_mfma_f32_16x16x32_bf16 v[88:91], a[28:31], a[20:23], v[88:91]
    ds_read_b64_tr_b16 a[18:19], v6 offset:7800
    s_lshl_b32 s76, s76, 10
    s_waitcnt lgkmcnt(6)
    v_mfma_f32_16x16x32_bf16 v[92:95], a[24:27], a[0:3], v[92:95]
    ds_read_b64_tr_b16 a[20:21], v8 offset:5120
    s_add_u32 s26, s76, 6144
    v_mfma_f32_16x16x32_bf16 v[96:99], a[28:31], a[0:3], v[96:99]
    ds_read_b64_tr_b16 a[22:23], v8 offset:7680
    s_cmp_eq_u32 s53, 2
    s_barrier
    v_mfma_f32_16x16x32_bf16 v[60:63], a[32:35], a[4:7], v[60:63]
    ds_read_b64_tr_b16 a[0:1], v7 offset:30720
    ds_read_b128 a[40:43], v4 offset:4096
    v_mfma_f32_16x16x32_bf16 v[64:67], a[36:39], a[4:7], v[64:67]
    ds_read_b64_tr_b16 a[2:3], v7 offset:33280
    ds_read_b128 a[44:47], v4 offset:6144
    s_waitcnt lgkmcnt(8)
    v_mfma_f32_16x16x32_bf16 v[68:71], a[32:35], a[8:11], v[68:71]
    ds_read_b64_tr_b16 a[4:5], v7 offset:30760
    ds_read_b128 a[48:51], v5 offset:4096
    v_mfma_f32_16x16x32_bf16 v[72:75], a[36:39], a[8:11], v[72:75]
    ds_read_b64_tr_b16 a[6:7], v7 offset:33320
    ds_read_b128 a[52:55], v5 offset:6144
    v_mfma_f32_16x16x32_bf16 v[76:79], a[32:35], a[12:15], v[76:79]
    ds_read_b64_tr_b16 a[8:9], v7 offset:30800
    s_cselect_b64 s[72:73], 0, -1
    v_mfma_f32_16x16x32_bf16 v[80:83], a[36:39], a[12:15], v[80:83]
    ds_read_b64_tr_b16 a[10:11], v7 offset:33360
    s_sub_u32 s76, s53, 4
    s_waitcnt lgkmcnt(10)
    v_mfma_f32_16x16x32_bf16 v[84:87], a[32:35], a[16:19], v[84:87]
    ds_read_b64_tr_b16 a[12:13], v7 offset:30840
    s_and_b32 s76, s76, 3
    v_mfma_f32_16x16x32_bf16 v[88:91], a[36:39], a[16:19], v[88:91]
    ds_read_b64_tr_b16 a[14:15], v7 offset:33400
    s_lshl_b32 s76, s76, 10
    v_mfma_f32_16x16x32_bf16 v[92:95], a[32:35], a[20:23], v[92:95]
    ds_read_b64_tr_b16 a[16:17], v9 offset:30720
    s_add_u32 s27, s76, 9216
    v_mfma_f32_16x16x32_bf16 v[96:99], a[36:39], a[20:23], v[96:99]
    ds_read_b64_tr_b16 a[18:19], v9 offset:33280
    s_cmp_eq_u32 s53, 3
    s_waitcnt lgkmcnt(7)
    v_mfma_f32_16x16x32_bf16 v[100:103], a[56:59], a[0:3], v[100:103]
    ds_read_b64_tr_b16 a[20:21], v7 offset:35840
    s_cselect_b64 s[74:75], 0, -1
    v_mfma_f32_16x16x32_bf16 v[104:107], a[60:63], a[0:3], v[104:107]
    ds_read_b64_tr_b16 a[22:23], v7 offset:38400
    s_lshl_b32 s76, s53, 10
    v_mfma_f32_16x16x32_bf16 v[108:111], a[56:59], a[4:7], v[108:111]
    ds_read_b64_tr_b16 a[0:1], v7 offset:35880
    s_add_u32 s28, s76, 12288
    v_mfma_f32_16x16x32_bf16 v[112:115], a[60:63], a[4:7], v[112:115]
    ds_read_b64_tr_b16 a[2:3], v7 offset:38440
    v_lshlrev_b32 v10, 4, v0
    s_waitcnt lgkmcnt(6)
    v_mfma_f32_16x16x32_bf16 v[116:119], a[56:59], a[8:11], v[116:119]
    ds_read_b64_tr_b16 a[4:5], v7 offset:35920
    v_add_u32 v10, 102400, v10
    v_mfma_f32_16x16x32_bf16 v[120:123], a[60:63], a[8:11], v[120:123]
    ds_read_b64_tr_b16 a[6:7], v7 offset:38480
    s_mul_i32 s76, s53, 3072
    v_mfma_f32_16x16x32_bf16 v[124:127], a[56:59], a[12:15], v[124:127]
    ds_read_b64_tr_b16 a[8:9], v7 offset:35960
    v_add_u32 v11, s76, v10
    v_mfma_f32_16x16x32_bf16 v[128:131], a[60:63], a[12:15], v[128:131]
    ds_read_b64_tr_b16 a[10:11], v7 offset:38520
    s_add_u32 s76, s53, 1
    s_waitcnt lgkmcnt(6)
    v_mfma_f32_16x16x32_bf16 v[132:135], a[56:59], a[16:19], v[132:135]
    ds_read_b64_tr_b16 a[12:13], v9 offset:35840
    s_and_b32 s76, s76, 3
    v_mfma_f32_16x16x32_bf16 v[136:139], a[60:63], a[16:19], v[136:139]
    ds_read_b64_tr_b16 a[14:15], v9 offset:38400
    s_lshl_b32 s76, s76, 10
    v_mfma_f32_16x16x32_bf16 v[100:103], a[64:67], a[20:23], v[100:103]
    ds_read_b64_tr_b16 a[16:17], v6 offset:10240
    s_add_u32 s76, s76, 12288
    v_mfma_f32_16x16x32_bf16 v[104:107], a[68:71], a[20:23], v[104:107]
    ds_read_b64_tr_b16 a[18:19], v6 offset:12800
    v_add_u32 v12, s76, v10
    s_waitcnt lgkmcnt(6)
    v_mfma_f32_16x16x32_bf16 v[108:111], a[64:67], a[0:3], v[108:111]
    ds_read_b64_tr_b16 a[20:21], v6 offset:10280
    s_add_u32 s76, s53, 2
    v_mfma_f32_16x16x32_bf16 v[112:115], a[68:71], a[0:3], v[112:115]
    ds_read_b64_tr_b16 a[22:23], v6 offset:12840
    s_and_b32 s76, s76, 3
    v_mfma_f32_16x16x32_bf16 v[116:119], a[64:67], a[4:7], v[116:119]
    ds_read_b64_tr_b16 a[0:1], v6 offset:10320
    s_lshl_b32 s76, s76, 10
    v_mfma_f32_16x16x32_bf16 v[120:123], a[68:71], a[4:7], v[120:123]
    ds_read_b64_tr_b16 a[2:3], v6 offset:12880
    s_add_u32 s76, s76, 12288
    s_waitcnt lgkmcnt(6)
    v_mfma_f32_16x16x32_bf16 v[124:127], a[64:67], a[8:11], v[124:127]
    ds_read_b64_tr_b16 a[4:5], v6 offset:10360
    v_add_u32 v13, s76, v10
    v_mfma_f32_16x16x32_bf16 v[128:131], a[68:71], a[8:11], v[128:131]
    ds_read_b64_tr_b16 a[6:7], v6 offset:12920
    s_add_u32 s76, s53, 3
    v_mfma_f32_16x16x32_bf16 v[132:135], a[64:67], a[12:15], v[132:135]
    ds_read_b64_tr_b16 a[8:9], v8 offset:10240
    s_and_b32 s76, s76, 3
    v_mfma_f32_16x16x32_bf16 v[136:139], a[68:71], a[12:15], v[136:139]
    ds_read_b64_tr_b16 a[10:11], v8 offset:12800
    s_lshl_b32 s76, s76, 10
    s_waitcnt lgkmcnt(6)
    v_mfma_f32_16x16x32_bf16 v[60:63], a[40:43], a[16:19], v[60:63]
    ds_read_b64_tr_b16 a[12:13], v6 offset:15360
    s_add_u32 s76, s76, 12288
    v_mfma_f32_16x16x32_bf16 v[64:67], a[44:47], a[16:19], v[64:67]
    ds_read_b64_tr_b16 a[14:15], v6 offset:17920
    v_add_u32 v14, s76, v10
    v_mfma_f32_16x16x32_bf16 v[68:71], a[40:43], a[20:23], v[68:71]
    ds_read_b64_tr_b16 a[16:17], v6 offset:15400
    v_add_u32 v44, s24, v10
    v_mfma_f32_16x16x32_bf16 v[72:75], a[44:47], a[20:23], v[72:75]
    ds_read_b64_tr_b16 a[18:19], v6 offset:17960
    v_add_u32 v45, s25, v10
    s_waitcnt lgkmcnt(6)
    v_mfma_f32_16x16x32_bf16 v[76:79], a[40:43], a[0:3], v[76:79]
    ds_read_b64_tr_b16 a[20:21], v6 offset:15440
    v_add_u32 v46, s26, v10
    v_mfma_f32_16x16x32_bf16 v[80:83], a[44:47], a[0:3], v[80:83]
    ds_read_b64_tr_b16 a[22:23], v6 offset:18000
    v_add_u32 v47, s27, v10
    v_mfma_f32_16x16x32_bf16 v[84:87], a[40:43], a[4:7], v[84:87]
    ds_read_b64_tr_b16 a[0:1], v6 offset:15480
    v_add_u32 v48, s28, v10
    v_mfma_f32_16x16x32_bf16 v[88:91], a[44:47], a[4:7], v[88:91]
    ds_read_b64_tr_b16 a[2:3], v6 offset:18040
    s_lshl_b32 s76, s55, 4
    s_waitcnt lgkmcnt(6)
    v_mfma_f32_16x16x32_bf16 v[92:95], a[40:43], a[8:11], v[92:95]
    ds_read_b64_tr_b16 a[4:5], v8 offset:15360
    s_add_u32 s77, s76, s54
    v_mfma_f32_16x16x32_bf16 v[96:99], a[44:47], a[8:11], v[96:99]
    ds_read_b64_tr_b16 a[6:7], v8 offset:17920
    s_lshl_b32 s77, s77, 12
    s_barrier
    v_mfma_f32_16x16x32_bf16 v[60:63], a[48:51], a[12:15], v[60:63]
    ds_read_b64_tr_b16 a[8:9], v6 offset:30720
    ds_read_b128 a[56:59], v4 offset:8192
    v_mfma_f32_16x16x32_bf16 v[64:67], a[52:55], a[12:15], v[64:67]
    ds_read_b64_tr_b16 a[10:11], v6 offset:33280
    ds_read_b128 a[60:63], v4 offset:10240
    s_waitcnt lgkmcnt(8)
    v_mfma_f32_16x16x32_bf16 v[68:71], a[48:51], a[16:19], v[68:71]
    ds_read_b64_tr_b16 a[12:13], v6 offset:30760
    ds_read_b128 a[64:67], v5 offset:8192
    v_mfma_f32_16x16x32_bf16 v[72:75], a[52:55], a[16:19], v[72:75]
    ds_read_b64_tr_b16 a[14:15], v6 offset:33320
    ds_read_b128 a[68:71], v5 offset:10240
    v_mfma_f32_16x16x32_bf16 v[76:79], a[48:51], a[20:23], v[76:79]
    ds_read_b64_tr_b16 a[16:17], v6 offset:30800
    s_add_u32 s16, s77, 6291456
    v_mfma_f32_16x16x32_bf16 v[80:83], a[52:55], a[20:23], v[80:83]
    ds_read_b64_tr_b16 a[18:19], v6 offset:33360
    s_mul_i32 s77, s53, 896
    s_waitcnt lgkmcnt(10)
    v_mfma_f32_16x16x32_bf16 v[84:87], a[48:51], a[0:3], v[84:87]
    ds_read_b64_tr_b16 a[20:21], v6 offset:30840
    s_add_u32 s17, s16, s77
    v_mfma_f32_16x16x32_bf16 v[88:91], a[52:55], a[0:3], v[88:91]
    ds_read_b64_tr_b16 a[22:23], v6 offset:33400
    v_lshlrev_b32 v15, 3, v0
    v_mfma_f32_16x16x32_bf16 v[92:95], a[48:51], a[4:7], v[92:95]
    ds_read_b64_tr_b16 a[0:1], v8 offset:30720
    v_lshlrev_b32 v19, 3, v1
    v_mfma_f32_16x16x32_bf16 v[96:99], a[52:55], a[4:7], v[96:99]
    ds_read_b64_tr_b16 a[2:3], v8 offset:33280
    v_add_u32 v19, 512, v19
    s_waitcnt lgkmcnt(7)
    v_mfma_f32_16x16x32_bf16 v[100:103], a[24:27], a[8:11], v[100:103]
    ds_read_b64_tr_b16 a[4:5], v6 offset:35840
    s_lshl_b32 s77, s53, 2
    v_mfma_f32_16x16x32_bf16 v[104:107], a[28:31], a[8:11], v[104:107]
    ds_read_b64_tr_b16 a[6:7], v6 offset:38400
    s_add_u32 s78, s77, 4
    v_mfma_f32_16x16x32_bf16 v[108:111], a[24:27], a[12:15], v[108:111]
    ds_read_b64_tr_b16 a[8:9], v6 offset:35880
    s_and_b32 s78, s78, 15
    v_mfma_f32_16x16x32_bf16 v[112:115], a[28:31], a[12:15], v[112:115]
    ds_read_b64_tr_b16 a[10:11], v6 offset:38440
    v_cmp_eq_u32 s[6:7], s78, v1
    s_waitcnt lgkmcnt(6)
    v_mfma_f32_16x16x32_bf16 v[116:119], a[24:27], a[16:19], v[116:119]
    ds_read_b64_tr_b16 a[12:13], v6 offset:35920
    v_and_b32 v3, 3, v1
    v_mfma_f32_16x16x32_bf16 v[120:123], a[28:31], a[16:19], v[120:123]
    ds_read_b64_tr_b16 a[14:15], v6 offset:38480
    v_cndmask_b32 v3, v3, 4, s[6:7]
    v_mfma_f32_16x16x32_bf16 v[124:127], a[24:27], a[20:23], v[124:127]
    ds_read_b64_tr_b16 a[16:17], v6 offset:35960
    v_lshlrev_b32 v3, 3, v3
    v_mfma_f32_16x16x32_bf16 v[128:131], a[28:31], a[20:23], v[128:131]
    ds_read_b64_tr_b16 a[18:19], v6 offset:38520
    v_add_u32 v29, 800, v3
    s_waitcnt lgkmcnt(6)
    v_mfma_f32_16x16x32_bf16 v[132:135], a[24:27], a[0:3], v[132:135]
    ds_read_b64_tr_b16 a[20:21], v8 offset:35840
    v_mul_u32_u24 v16, 40, v2
    v_mfma_f32_16x16x32_bf16 v[136:139], a[28:31], a[0:3], v[136:139]
    ds_read_b64_tr_b16 a[22:23], v8 offset:38400
    v_add_u32 v16, v16, v3
    v_mfma_f32_16x16x32_bf16 v[100:103], a[32:35], a[4:7], v[100:103]
    ds_read_b64_tr_b16 a[0:1], v6 offset:20480
    v_add_u32 v16, 640, v16
    v_mfma_f32_16x16x32_bf16 v[104:107], a[36:39], a[4:7], v[104:107]
    ds_read_b64_tr_b16 a[2:3], v6 offset:23040
    v_lshrrev_b32 v3, 2, v1
    s_waitcnt lgkmcnt(6)
    v_mfma_f32_16x16x32_bf16 v[108:111], a[32:35], a[8:11], v[108:111]
    ds_read_b64_tr_b16 a[4:5], v6 offset:20520
    v_cmp_eq_u32 s[4:5], s53, v3
    v_mfma_f32_16x16x32_bf16 v[112:115], a[36:39], a[8:11], v[112:115]
    ds_read_b64_tr_b16 a[6:7], v6 offset:23080
    v_cmp_eq_u32 s[30:31], s53, v2
    v_mfma_f32_16x16x32_bf16 v[116:119], a[32:35], a[12:15], v[116:119]
    ds_read_b64_tr_b16 a[8:9], v6 offset:20560
    s_or_b64 s[4:5], s[4:5], s[6:7]
    v_mfma_f32_16x16x32_bf16 v[120:123], a[36:39], a[12:15], v[120:123]
    ds_read_b64_tr_b16 a[10:11], v6 offset:23120
    s_and_b64 s[40:41], s[4:5], s[30:31]
    s_waitcnt lgkmcnt(6)
    v_mfma_f32_16x16x32_bf16 v[124:127], a[32:35], a[16:19], v[124:127]
    ds_read_b64_tr_b16 a[12:13], v6 offset:20600
    s_lshl_b32 s76, s76, 12
    v_mfma_f32_16x16x32_bf16 v[128:131], a[36:39], a[16:19], v[128:131]
    ds_read_b64_tr_b16 a[14:15], v6 offset:23160
    s_lshl_b32 s77, s53, 8
    v_mfma_f32_16x16x32_bf16 v[132:135], a[32:35], a[20:23], v[132:135]
    ds_read_b64_tr_b16 a[16:17], v8 offset:20480
    s_add_u32 s76, s76, s77
    v_mfma_f32_16x16x32_bf16 v[136:139], a[36:39], a[20:23], v[136:139]
    ds_read_b64_tr_b16 a[18:19], v8 offset:23040
    s_add_u32 s76, s76, 6291456
    s_waitcnt lgkmcnt(6)
    v_mfma_f32_16x16x32_bf16 v[60:63], a[56:59], a[0:3], v[60:63]
    ds_read_b64_tr_b16 a[20:21], v6 offset:25600
    v_lshlrev_b32 v17, 12, v2
    v_mfma_f32_16x16x32_bf16 v[64:67], a[60:63], a[0:3], v[64:67]
    ds_read_b64_tr_b16 a[22:23], v6 offset:28160
    v_lshl_add_u32 v17, v1, 4, v17
    v_mfma_f32_16x16x32_bf16 v[68:71], a[56:59], a[4:7], v[68:71]
    ds_read_b64_tr_b16 a[0:1], v6 offset:25640
    v_add_u32 v17, s76, v17
    v_mfma_f32_16x16x32_bf16 v[72:75], a[60:63], a[4:7], v[72:75]
    ds_read_b64_tr_b16 a[2:3], v6 offset:28200
    s_add_u32 s77, s77, 102400
    s_waitcnt lgkmcnt(6)
    v_mfma_f32_16x16x32_bf16 v[76:79], a[56:59], a[8:11], v[76:79]
    ds_read_b64_tr_b16 a[4:5], v6 offset:25680
    v_lshlrev_b32 v18, 4, v1
    v_mfma_f32_16x16x32_bf16 v[80:83], a[60:63], a[8:11], v[80:83]
    ds_read_b64_tr_b16 a[6:7], v6 offset:28240
    v_lshl_add_u32 v18, v2, 3, v18
    v_mfma_f32_16x16x32_bf16 v[84:87], a[56:59], a[12:15], v[84:87]
    ds_read_b64_tr_b16 a[8:9], v6 offset:25720
    v_add_u32 v18, s77, v18
    v_mfma_f32_16x16x32_bf16 v[88:91], a[60:63], a[12:15], v[88:91]
    ds_read_b64_tr_b16 a[10:11], v6 offset:28280
    v_mov_b32 v30, 0xb5c1a2a0
    s_waitcnt lgkmcnt(6)
    v_mfma_f32_16x16x32_bf16 v[92:95], a[56:59], a[16:19], v[92:95]
    ds_read_b64_tr_b16 a[12:13], v8 offset:25600
    s_mov_b32 s8, 0x3fb8aa3b
    v_mfma_f32_16x16x32_bf16 v[96:99], a[60:63], a[16:19], v[96:99]
    ds_read_b64_tr_b16 a[14:15], v8 offset:28160
    s_mov_b32 s9, 0x358637bd
    s_barrier
    v_mfma_f32_16x16x32_bf16 v[60:63], a[64:67], a[20:23], v[60:63]
    ds_read_b64_tr_b16 a[16:17], v6 offset:51200
    ds_read_b128 a[24:27], v4 offset:0
    v_mfma_f32_16x16x32_bf16 v[64:67], a[68:71], a[20:23], v[64:67]
    ds_read_b64_tr_b16 a[18:19], v6 offset:53760
    ds_read_b128 a[28:31], v4 offset:2048
    s_waitcnt lgkmcnt(8)
    v_mfma_f32_16x16x32_bf16 v[68:71], a[64:67], a[0:3], v[68:71]
    ds_read_b64_tr_b16 a[20:21], v6 offset:51240
    ds_read_b128 a[32:35], v5 offset:0
    v_mfma_f32_16x16x32_bf16 v[72:75], a[68:71], a[0:3], v[72:75]
    ds_read_b64_tr_b16 a[22:23], v6 offset:53800
    ds_read_b128 a[36:39], v5 offset:2048
    v_mfma_f32_16x16x32_bf16 v[76:79], a[64:67], a[4:7], v[76:79]
    ds_read_b64_tr_b16 a[0:1], v6 offset:51280
    s_lshl_b32 s10, s55, 2
    v_mfma_f32_16x16x32_bf16 v[80:83], a[68:71], a[4:7], v[80:83]
    ds_read_b64_tr_b16 a[2:3], v6 offset:53840
    s_mov_b32 s76, 2130706432
    s_waitcnt lgkmcnt(10)
    v_mfma_f32_16x16x32_bf16 v[84:87], a[64:67], a[8:11], v[84:87]
    ds_read_b64_tr_b16 a[4:5], v6 offset:51320
    s_cmp_lt_u32 s53, 2
    v_mfma_f32_16x16x32_bf16 v[88:91], a[68:71], a[8:11], v[88:91]
    ds_read_b64_tr_b16 a[6:7], v6 offset:53880
    s_cselect_b32 s15, 0, s76
    v_mfma_f32_16x16x32_bf16 v[92:95], a[64:67], a[12:15], v[92:95]
    ds_read_b64_tr_b16 a[8:9], v8 offset:51200
    v_mfma_f32_16x16x32_bf16 v[96:99], a[68:71], a[12:15], v[96:99]
    ds_read_b64_tr_b16 a[10:11], v8 offset:53760
    s_waitcnt lgkmcnt(7)
    v_mfma_f32_16x16x32_bf16 v[100:103], a[40:43], a[16:19], v[100:103]
    ds_read_b64_tr_b16 a[12:13], v6 offset:56320
    v_mfma_f32_16x16x32_bf16 v[104:107], a[44:47], a[16:19], v[104:107]
    ds_read_b64_tr_b16 a[14:15], v6 offset:58880
    v_mfma_f32_16x16x32_bf16 v[108:111], a[40:43], a[20:23], v[108:111]
    ds_read_b64_tr_b16 a[16:17], v6 offset:56360
    v_mfma_f32_16x16x32_bf16 v[112:115], a[44:47], a[20:23], v[112:115]
    ds_read_b64_tr_b16 a[18:19], v6 offset:58920
    s_waitcnt lgkmcnt(6)
    v_mfma_f32_16x16x32_bf16 v[116:119], a[40:43], a[0:3], v[116:119]
    ds_read_b64_tr_b16 a[20:21], v6 offset:56400
    v_mfma_f32_16x16x32_bf16 v[120:123], a[44:47], a[0:3], v[120:123]
    ds_read_b64_tr_b16 a[22:23], v6 offset:58960
    v_mfma_f32_16x16x32_bf16 v[124:127], a[40:43], a[4:7], v[124:127]
    ds_read_b64_tr_b16 a[0:1], v6 offset:56440
    v_mfma_f32_16x16x32_bf16 v[128:131], a[44:47], a[4:7], v[128:131]
    ds_read_b64_tr_b16 a[2:3], v6 offset:59000
    s_waitcnt lgkmcnt(6)
    v_mfma_f32_16x16x32_bf16 v[132:135], a[40:43], a[8:11], v[132:135]
    ds_read_b64_tr_b16 a[4:5], v8 offset:56320
    v_mfma_f32_16x16x32_bf16 v[136:139], a[44:47], a[8:11], v[136:139]
    ds_read_b64_tr_b16 a[6:7], v8 offset:58880
    v_mfma_f32_16x16x32_bf16 v[100:103], a[48:51], a[12:15], v[100:103]
    ds_read_b64_tr_b16 a[8:9], v6 offset:40960
    v_mfma_f32_16x16x32_bf16 v[104:107], a[52:55], a[12:15], v[104:107]
    ds_read_b64_tr_b16 a[10:11], v6 offset:43520
    s_waitcnt lgkmcnt(6)
    v_mfma_f32_16x16x32_bf16 v[108:111], a[48:51], a[16:19], v[108:111]
    ds_read_b64_tr_b16 a[12:13], v6 offset:41000
    v_mfma_f32_16x16x32_bf16 v[112:115], a[52:55], a[16:19], v[112:115]
    ds_read_b64_tr_b16 a[14:15], v6 offset:43560
    v_mfma_f32_16x16x32_bf16 v[116:119], a[48:51], a[20:23], v[116:119]
    ds_read_b64_tr_b16 a[16:17], v6 offset:41040
    v_mfma_f32_16x16x32_bf16 v[120:123], a[52:55], a[20:23], v[120:123]
    ds_read_b64_tr_b16 a[18:19], v6 offset:43600
    s_waitcnt lgkmcnt(6)
    v_mfma_f32_16x16x32_bf16 v[124:127], a[48:51], a[0:3], v[124:127]
    ds_read_b64_tr_b16 a[20:21], v6 offset:41080
    v_mfma_f32_16x16x32_bf16 v[128:131], a[52:55], a[0:3], v[128:131]
    ds_read_b64_tr_b16 a[22:23], v6 offset:43640
    v_mfma_f32_16x16x32_bf16 v[132:135], a[48:51], a[4:7], v[132:135]
    ds_read_b64_tr_b16 a[0:1], v8 offset:40960
    v_mfma_f32_16x16x32_bf16 v[136:139], a[52:55], a[4:7], v[136:139]
    ds_read_b64_tr_b16 a[2:3], v8 offset:43520
    s_waitcnt lgkmcnt(6)
    v_mfma_f32_16x16x32_bf16 v[60:63], a[24:27], a[8:11], v[60:63]
    ds_read_b64_tr_b16 a[4:5], v6 offset:46080
    v_mfma_f32_16x16x32_bf16 v[64:67], a[28:31], a[8:11], v[64:67]
    ds_read_b64_tr_b16 a[6:7], v6 offset:48640
    v_mfma_f32_16x16x32_bf16 v[68:71], a[24:27], a[12:15], v[68:71]
    ds_read_b64_tr_b16 a[8:9], v6 offset:46120
    v_mfma_f32_16x16x32_bf16 v[72:75], a[28:31], a[12:15], v[72:75]
    ds_read_b64_tr_b16 a[10:11], v6 offset:48680
    s_waitcnt lgkmcnt(6)
    v_mfma_f32_16x16x32_bf16 v[76:79], a[24:27], a[16:19], v[76:79]
    ds_read_b64_tr_b16 a[12:13], v6 offset:46160
    v_mfma_f32_16x16x32_bf16 v[80:83], a[28:31], a[16:19], v[80:83]
    ds_read_b64_tr_b16 a[14:15], v6 offset:48720
    v_mfma_f32_16x16x32_bf16 v[84:87], a[24:27], a[20:23], v[84:87]
    ds_read_b64_tr_b16 a[16:17], v6 offset:46200
    v_mfma_f32_16x16x32_bf16 v[88:91], a[28:31], a[20:23], v[88:91]
    ds_read_b64_tr_b16 a[18:19], v6 offset:48760
    s_waitcnt lgkmcnt(6)
    v_mfma_f32_16x16x32_bf16 v[92:95], a[24:27], a[0:3], v[92:95]
    ds_read_b64_tr_b16 a[20:21], v8 offset:46080
    v_mfma_f32_16x16x32_bf16 v[96:99], a[28:31], a[0:3], v[96:99]
    ds_read_b64_tr_b16 a[22:23], v8 offset:48640
    s_barrier
    v_mfma_f32_16x16x32_bf16 v[60:63], a[32:35], a[4:7], v[60:63]
    ds_read_b64_tr_b16 a[0:1], v7 offset:20480
    v_mfma_f32_16x16x32_bf16 v[64:67], a[36:39], a[4:7], v[64:67]
    ds_read_b64_tr_b16 a[2:3], v7 offset:23040
    s_waitcnt lgkmcnt(6)
    v_mfma_f32_16x16x32_bf16 v[68:71], a[32:35], a[8:11], v[68:71]
    ds_read_b64_tr_b16 a[4:5], v7 offset:20520
    v_mfma_f32_16x16x32_bf16 v[72:75], a[36:39], a[8:11], v[72:75]
    ds_read_b64_tr_b16 a[6:7], v7 offset:23080
    v_mfma_f32_16x16x32_bf16 v[76:79], a[32:35], a[12:15], v[76:79]
    ds_read_b64_tr_b16 a[8:9], v7 offset:20560
    v_mfma_f32_16x16x32_bf16 v[80:83], a[36:39], a[12:15], v[80:83]
    ds_read_b64_tr_b16 a[10:11], v7 offset:23120
    s_waitcnt lgkmcnt(6)
    v_mfma_f32_16x16x32_bf16 v[84:87], a[32:35], a[16:19], v[84:87]
    ds_read_b64_tr_b16 a[12:13], v7 offset:20600
    v_mfma_f32_16x16x32_bf16 v[88:91], a[36:39], a[16:19], v[88:91]
    ds_read_b64_tr_b16 a[14:15], v7 offset:23160
    v_mfma_f32_16x16x32_bf16 v[92:95], a[32:35], a[20:23], v[92:95]
    ds_read_b64_tr_b16 a[16:17], v9 offset:20480
    v_mfma_f32_16x16x32_bf16 v[96:99], a[36:39], a[20:23], v[96:99]
    ds_read_b64_tr_b16 a[18:19], v9 offset:23040
    s_waitcnt lgkmcnt(6)
    v_mfma_f32_16x16x32_bf16 v[100:103], a[56:59], a[0:3], v[100:103]
    ds_read_b64_tr_b16 a[20:21], v7 offset:25600
    v_mfma_f32_16x16x32_bf16 v[104:107], a[60:63], a[0:3], v[104:107]
    ds_read_b64_tr_b16 a[22:23], v7 offset:28160
    s_setprio 3
    s_waitcnt vmcnt(0)
    v_mfma_f32_16x16x32_bf16 v[108:111], a[56:59], a[4:7], v[108:111]
    ds_read_b64_tr_b16 a[0:1], v7 offset:25640
    v_fma_f32 v176, v60, s8, v30
    v_mfma_f32_16x16x32_bf16 v[112:115], a[60:63], a[4:7], v[112:115]
    ds_read_b64_tr_b16 a[2:3], v7 offset:28200
    v_fma_f32 v177, v61, s8, v30
    s_waitcnt lgkmcnt(6)
    v_mfma_f32_16x16x32_bf16 v[116:119], a[56:59], a[8:11], v[116:119]
    ds_read_b64_tr_b16 a[4:5], v7 offset:25680
    v_fma_f32 v178, v62, s8, v30
    v_mfma_f32_16x16x32_bf16 v[120:123], a[60:63], a[8:11], v[120:123]
    ds_read_b64_tr_b16 a[6:7], v7 offset:28240
    v_fma_f32 v179, v63, s8, v30
    v_mfma_f32_16x16x32_bf16 v[124:127], a[56:59], a[12:15], v[124:127]
    ds_read_b64_tr_b16 a[8:9], v7 offset:25720
    v_fma_f32 v180, v64, s8, v30
    v_mfma_f32_16x16x32_bf16 v[128:131], a[60:63], a[12:15], v[128:131]
    ds_read_b64_tr_b16 a[10:11], v7 offset:28280
    v_fma_f32 v181, v65, s8, v30
    s_waitcnt lgkmcnt(6)
    v_mfma_f32_16x16x32_bf16 v[132:135], a[56:59], a[16:19], v[132:135]
    ds_read_b64_tr_b16 a[12:13], v9 offset:25600
    v_fma_f32 v182, v66, s8, v30
    v_mfma_f32_16x16x32_bf16 v[136:139], a[60:63], a[16:19], v[136:139]
    ds_read_b64_tr_b16 a[14:15], v9 offset:28160
    v_fma_f32 v183, v67, s8, v30
    v_pk_fma_f32 v[168:169], v[68:69], s[8:9], v[30:31] op_sel_hi:[1,0,0]
    v_pk_fma_f32 v[170:171], v[70:71], s[8:9], v[30:31] op_sel_hi:[1,0,0]
    v_pk_fma_f32 v[172:173], v[72:73], s[8:9], v[30:31] op_sel_hi:[1,0,0]
    v_pk_fma_f32 v[174:175], v[74:75], s[8:9], v[30:31] op_sel_hi:[1,0,0]
    v_exp_f32 v168, v168 clamp
    v_max_f32 v68, s9, v68
    v_exp_f32 v169, v169 clamp
    v_max_f32 v69, s9, v69
    v_exp_f32 v170, v170 clamp
    v_max_f32 v70, s9, v70
    v_exp_f32 v171, v171 clamp
    v_max_f32 v71, s9, v71
    v_exp_f32 v172, v172 clamp
    v_max_f32 v72, s9, v72
    v_exp_f32 v173, v173 clamp
    v_max_f32 v73, s9, v73
    v_exp_f32 v174, v174 clamp
    v_max_f32 v74, s9, v74
    v_exp_f32 v175, v175 clamp
    v_max_f32 v75, s9, v75
    v_pk_add_f32 v[68:69], v[68:69], v[168:169]
    v_pk_add_f32 v[70:71], v[70:71], v[170:171]
    v_pk_add_f32 v[72:73], v[72:73], v[172:173]
    v_pk_add_f32 v[74:75], v[74:75], v[174:175]
    v_cvt_pk_bf16_f32 v68, v68, v69
    v_cvt_pk_bf16_f32 v69, v70, v71
    v_cvt_pk_bf16_f32 v70, v72, v73
    v_cvt_pk_bf16_f32 v71, v74, v75
    v_pk_fma_f32 v[168:169], v[76:77], s[8:9], v[30:31] op_sel_hi:[1,0,0]
    v_pk_fma_f32 v[170:171], v[78:79], s[8:9], v[30:31] op_sel_hi:[1,0,0]
    v_pk_fma_f32 v[172:173], v[80:81], s[8:9], v[30:31] op_sel_hi:[1,0,0]
    v_pk_fma_f32 v[174:175], v[82:83], s[8:9], v[30:31] op_sel_hi:[1,0,0]
    v_exp_f32 v168, v168 clamp
    v_max_f32 v76, s9, v76
    v_exp_f32 v169, v169 clamp
    v_max_f32 v77, s9, v77
    v_exp_f32 v170, v170 clamp
    v_max_f32 v78, s9, v78
    v_exp_f32 v171, v171 clamp
    v_max_f32 v79, s9, v79
    v_exp_f32 v172, v172 clamp
    v_max_f32 v80, s9, v80
    v_exp_f32 v173, v173 clamp
    v_max_f32 v81, s9, v81
    v_exp_f32 v174, v174 clamp
    v_max_f32 v82, s9, v82
    v_exp_f32 v175, v175 clamp
    v_max_f32 v83, s9, v83
    v_pk_add_f32 v[76:77], v[76:77], v[168:169]
    v_pk_add_f32 v[78:79], v[78:79], v[170:171]
    v_pk_add_f32 v[80:81], v[80:81], v[172:173]
    v_pk_add_f32 v[82:83], v[82:83], v[174:175]
    v_cvt_pk_bf16_f32 v76, v76, v77
    v_cvt_pk_bf16_f32 v77, v78, v79
    v_cvt_pk_bf16_f32 v78, v80, v81
    v_cvt_pk_bf16_f32 v79, v82, v83
    s_barrier
    v_mfma_f32_16x16x32_bf16 v[100:103], a[64:67], a[20:23], v[100:103]
    ds_read_b64_tr_b16 a[16:17], v7 offset:30720
    v_exp_f32 v176, v176 clamp
    v_mfma_f32_16x16x32_bf16 v[104:107], a[68:71], a[20:23], v[104:107]
    ds_read_b64_tr_b16 a[18:19], v7 offset:33280
    v_max_f32 v60, s9, v60
    s_waitcnt lgkmcnt(6)
    v_mfma_f32_16x16x32_bf16 v[108:111], a[64:67], a[0:3], v[108:111]
    ds_read_b64_tr_b16 a[20:21], v7 offset:30760
    v_exp_f32 v177, v177 clamp
    v_mfma_f32_16x16x32_bf16 v[112:115], a[68:71], a[0:3], v[112:115]
    ds_read_b64_tr_b16 a[22:23], v7 offset:33320
    v_max_f32 v61, s9, v61
    v_mfma_f32_16x16x32_bf16 v[116:119], a[64:67], a[4:7], v[116:119]
    ds_read_b64_tr_b16 a[0:1], v7 offset:30800
    v_exp_f32 v178, v178 clamp
    v_mfma_f32_16x16x32_bf16 v[120:123], a[68:71], a[4:7], v[120:123]
    ds_read_b64_tr_b16 a[2:3], v7 offset:33360
    v_max_f32 v62, s9, v62
    s_waitcnt lgkmcnt(6)
    v_mfma_f32_16x16x32_bf16 v[124:127], a[64:67], a[8:11], v[124:127]
    ds_read_b64_tr_b16 a[4:5], v7 offset:30840
    v_exp_f32 v179, v179 clamp
    v_mfma_f32_16x16x32_bf16 v[128:131], a[68:71], a[8:11], v[128:131]
    ds_read_b64_tr_b16 a[6:7], v7 offset:33400
    v_max_f32 v63, s9, v63
    v_mfma_f32_16x16x32_bf16 v[132:135], a[64:67], a[12:15], v[132:135]
    ds_read_b64_tr_b16 a[8:9], v9 offset:30720
    v_exp_f32 v180, v180 clamp
    v_mfma_f32_16x16x32_bf16 v[136:139], a[68:71], a[12:15], v[136:139]
    ds_read_b64_tr_b16 a[10:11], v9 offset:33280
    v_max_f32 v64, s9, v64
    s_waitcnt lgkmcnt(6)
    v_mfma_f32_16x16x32_bf16 v[100:103], a[24:27], a[16:19], v[100:103]
    ds_read_b64_tr_b16 a[12:13], v7 offset:35840
    v_exp_f32 v181, v181 clamp
    v_mfma_f32_16x16x32_bf16 v[104:107], a[28:31], a[16:19], v[104:107]
    ds_read_b64_tr_b16 a[14:15], v7 offset:38400
    v_max_f32 v65, s9, v65
    v_mfma_f32_16x16x32_bf16 v[108:111], a[24:27], a[20:23], v[108:111]
    ds_read_b64_tr_b16 a[16:17], v7 offset:35880
    v_exp_f32 v182, v182 clamp
    v_mfma_f32_16x16x32_bf16 v[112:115], a[28:31], a[20:23], v[112:115]
    ds_read_b64_tr_b16 a[18:19], v7 offset:38440
    v_max_f32 v66, s9, v66
    s_waitcnt lgkmcnt(6)
    v_mfma_f32_16x16x32_bf16 v[116:119], a[24:27], a[0:3], v[116:119]
    ds_read_b64_tr_b16 a[20:21], v7 offset:35920
    v_exp_f32 v183, v183 clamp
    v_mfma_f32_16x16x32_bf16 v[120:123], a[28:31], a[0:3], v[120:123]
    ds_read_b64_tr_b16 a[22:23], v7 offset:38480
    v_max_f32 v67, s9, v67
    v_mfma_f32_16x16x32_bf16 v[124:127], a[24:27], a[4:7], v[124:127]
    ds_read_b64_tr_b16 a[0:1], v7 offset:35960
    v_add_f32 v60, v60, v176
    v_mfma_f32_16x16x32_bf16 v[128:131], a[28:31], a[4:7], v[128:131]
    ds_read_b64_tr_b16 a[2:3], v7 offset:38520
    v_add_f32 v61, v61, v177
    s_waitcnt lgkmcnt(6)
    v_mfma_f32_16x16x32_bf16 v[132:135], a[24:27], a[8:11], v[132:135]
    ds_read_b64_tr_b16 a[4:5], v9 offset:35840
    v_add_f32 v62, v62, v178
    v_mfma_f32_16x16x32_bf16 v[136:139], a[28:31], a[8:11], v[136:139]
    ds_read_b64_tr_b16 a[6:7], v9 offset:38400
    v_add_f32 v63, v63, v179
    v_mfma_f32_16x16x32_bf16 v[100:103], a[32:35], a[12:15], v[100:103]
    v_add_f32 v64, v64, v180
    v_add_f32 v65, v65, v181
    v_mfma_f32_16x16x32_bf16 v[104:107], a[36:39], a[12:15], v[104:107]
    v_add_f32 v66, v66, v182
    v_add_f32 v67, v67, v183
    s_waitcnt lgkmcnt(4)
    v_mfma_f32_16x16x32_bf16 v[108:111], a[32:35], a[16:19], v[108:111]
    v_cvt_pk_bf16_f32 v60, v60, v61
    v_cvt_pk_bf16_f32 v61, v62, v63
    v_mfma_f32_16x16x32_bf16 v[112:115], a[36:39], a[16:19], v[112:115]
    v_cvt_pk_bf16_f32 v62, v64, v65
    v_cvt_pk_bf16_f32 v63, v66, v67
    v_mfma_f32_16x16x32_bf16 v[116:119], a[32:35], a[20:23], v[116:119]
    v_mfma_f32_16x16x32_bf16 v[120:123], a[36:39], a[20:23], v[120:123]
    s_waitcnt lgkmcnt(0)
    v_mfma_f32_16x16x32_bf16 v[124:127], a[32:35], a[0:3], v[124:127]
    v_mfma_f32_16x16x32_bf16 v[128:131], a[36:39], a[0:3], v[128:131]
    v_mfma_f32_16x16x32_bf16 v[132:135], a[32:35], a[4:7], v[132:135]
    v_mfma_f32_16x16x32_bf16 v[136:139], a[36:39], a[4:7], v[136:139]
    s_mov_b64 exec, s[68:69]
    ds_write_b128 v44, v[60:63] offset:0
    s_mov_b64 exec, -1
    s_mov_b64 exec, s[70:71]
    ds_write_b128 v45, v[68:71] offset:0
    s_mov_b64 exec, -1
    s_mov_b64 exec, s[72:73]
    ds_write_b128 v46, v[76:79] offset:0
    s_mov_b64 exec, -1
    v_pk_fma_f32 v[176:177], v[84:85], s[8:9], v[30:31] op_sel_hi:[1,0,0]
    v_pk_fma_f32 v[178:179], v[86:87], s[8:9], v[30:31] op_sel_hi:[1,0,0]
    v_pk_fma_f32 v[180:181], v[88:89], s[8:9], v[30:31] op_sel_hi:[1,0,0]
    v_pk_fma_f32 v[182:183], v[90:91], s[8:9], v[30:31] op_sel_hi:[1,0,0]
    v_exp_f32 v176, v176 clamp
    v_max_f32 v84, s9, v84
    v_exp_f32 v177, v177 clamp
    v_max_f32 v85, s9, v85
    v_exp_f32 v178, v178 clamp
    v_max_f32 v86, s9, v86
    v_exp_f32 v179, v179 clamp
    v_max_f32 v87, s9, v87
    v_exp_f32 v180, v180 clamp
    v_max_f32 v88, s9, v88
    v_exp_f32 v181, v181 clamp
    v_max_f32 v89, s9, v89
    v_exp_f32 v182, v182 clamp
    v_max_f32 v90, s9, v90
    v_exp_f32 v183, v183 clamp
    v_max_f32 v91, s9, v91
    v_pk_add_f32 v[84:85], v[84:85], v[176:177]
    v_pk_add_f32 v[86:87], v[86:87], v[178:179]
    v_pk_add_f32 v[88:89], v[88:89], v[180:181]
    v_pk_add_f32 v[90:91], v[90:91], v[182:183]
    v_cvt_pk_bf16_f32 v84, v84, v85
    v_cvt_pk_bf16_f32 v85, v86, v87
    v_cvt_pk_bf16_f32 v86, v88, v89
    v_cvt_pk_bf16_f32 v87, v90, v91
    s_mov_b64 exec, s[74:75]
    ds_write_b128 v47, v[84:87] offset:0
    s_mov_b64 exec, -1
    v_pk_fma_f32 v[176:177], v[92:93], s[8:9], v[30:31] op_sel_hi:[1,0,0]
    v_pk_fma_f32 v[178:179], v[94:95], s[8:9], v[30:31] op_sel_hi:[1,0,0]
    v_pk_fma_f32 v[180:181], v[96:97], s[8:9], v[30:31] op_sel_hi:[1,0,0]
    v_pk_fma_f32 v[182:183], v[98:99], s[8:9], v[30:31] op_sel_hi:[1,0,0]
    v_exp_f32 v176, v176 clamp
    v_max_f32 v92, s9, v92
    v_exp_f32 v177, v177 clamp
    v_max_f32 v93, s9, v93
    v_exp_f32 v178, v178 clamp
    v_max_f32 v94, s9, v94
    v_exp_f32 v179, v179 clamp
    v_max_f32 v95, s9, v95
    v_exp_f32 v180, v180 clamp
    v_max_f32 v96, s9, v96
    v_exp_f32 v181, v181 clamp
    v_max_f32 v97, s9, v97
    v_exp_f32 v182, v182 clamp
    v_max_f32 v98, s9, v98
    v_exp_f32 v183, v183 clamp
    v_max_f32 v99, s9, v99
    v_pk_add_f32 v[92:93], v[92:93], v[176:177]
    v_pk_add_f32 v[94:95], v[94:95], v[178:179]
    v_pk_add_f32 v[96:97], v[96:97], v[180:181]
    v_pk_add_f32 v[98:99], v[98:99], v[182:183]
    v_cvt_pk_bf16_f32 v92, v92, v93
    v_cvt_pk_bf16_f32 v93, v94, v95
    v_cvt_pk_bf16_f32 v94, v96, v97
    v_cvt_pk_bf16_f32 v95, v98, v99
    ds_write_b128 v48, v[92:95] offset:0
    v_cvt_pk_bf16_f32 v100, v100, v101
    v_cvt_pk_bf16_f32 v101, v102, v103
    v_cvt_pk_bf16_f32 v102, v104, v105
    v_cvt_pk_bf16_f32 v103, v106, v107
    s_mov_b64 exec, s[68:69]
    ds_write_b128 v44, v[100:103] offset:16384
    s_mov_b64 exec, -1
    v_cvt_pk_bf16_f32 v108, v108, v109
    v_cvt_pk_bf16_f32 v109, v110, v111
    v_cvt_pk_bf16_f32 v110, v112, v113
    v_cvt_pk_bf16_f32 v111, v114, v115
    s_waitcnt lgkmcnt(0)
    s_mov_b64 exec, 1
    ds_add_u32 v20, v21 offset:0
    s_mov_b64 exec, -1
    s_mov_b64 exec, s[70:71]
    ds_write_b128 v45, v[108:111] offset:16384
    s_mov_b64 exec, -1
    v_cvt_pk_bf16_f32 v116, v116, v117
    v_cvt_pk_bf16_f32 v117, v118, v119
    v_cvt_pk_bf16_f32 v118, v120, v121
    v_cvt_pk_bf16_f32 v119, v122, v123
    s_mov_b64 exec, s[72:73]
    ds_write_b128 v46, v[116:119] offset:16384
    s_mov_b64 exec, -1
    v_cvt_pk_bf16_f32 v124, v124, v125
    v_cvt_pk_bf16_f32 v125, v126, v127
    v_cvt_pk_bf16_f32 v126, v128, v129
    v_cvt_pk_bf16_f32 v127, v130, v131
    s_mov_b64 exec, s[74:75]
    ds_write_b128 v47, v[124:127] offset:16384
    s_mov_b64 exec, -1
    v_cvt_pk_bf16_f32 v132, v132, v133
    v_cvt_pk_bf16_f32 v133, v134, v135
    v_cvt_pk_bf16_f32 v134, v136, v137
    v_cvt_pk_bf16_f32 v135, v138, v139
    ds_write_b128 v48, v[132:135] offset:16384
    v_cndmask_b32 v152, v68, v60, s[70:71]
    v_cndmask_b32 v153, v69, v61, s[70:71]
    v_cndmask_b32 v154, v70, v62, s[70:71]
    v_cndmask_b32 v155, v71, v63, s[70:71]
    v_cndmask_b32 v152, v76, v152, s[72:73]
    v_cndmask_b32 v153, v77, v153, s[72:73]
    v_cndmask_b32 v154, v78, v154, s[72:73]
    v_cndmask_b32 v155, v79, v155, s[72:73]
    v_cndmask_b32 v152, v84, v152, s[74:75]
    v_cndmask_b32 v153, v85, v153, s[74:75]
    v_cndmask_b32 v154, v86, v154, s[74:75]
    v_cndmask_b32 v155, v87, v155, s[74:75]
    v_cndmask_b32 v52, v108, v100, s[70:71]
    v_cndmask_b32 v53, v109, v101, s[70:71]
    v_cndmask_b32 v54, v110, v102, s[70:71]
    v_cndmask_b32 v55, v111, v103, s[70:71]
    v_cndmask_b32 v52, v116, v52, s[72:73]
    v_cndmask_b32 v53, v117, v53, s[72:73]
    v_cndmask_b32 v54, v118, v54, s[72:73]
    v_cndmask_b32 v55, v119, v55, s[72:73]
    v_cndmask_b32 v52, v124, v52, s[74:75]
    v_cndmask_b32 v53, v125, v53, s[74:75]
    v_cndmask_b32 v54, v126, v54, s[74:75]
    v_cndmask_b32 v55, v127, v55, s[74:75]
    s_waitcnt lgkmcnt(0)
    s_mov_b64 exec, 1
    ds_add_u32 v20, v21 offset:12
    s_mov_b64 exec, -1
LA_c0:
    ds_read_b32 v2, v20 offset:0
    s_waitcnt lgkmcnt(0)
    v_readfirstlane_b32 s76, v2
    s_nop 0
    s_cmp_lt_u32 s76, 4
    s_cbranch_scc1 LA_c0
    ds_read_b128 v[140:143], v11 offset:0
    ds_read_b128 v[156:159], v12
    ds_read_b128 v[144:147], v11 offset:1024
    ds_read_b128 v[160:163], v13
    ds_read_b128 v[148:151], v11 offset:2048
    ds_read_b128 v[164:167], v14
    v_mfma_f32_16x16x32_bf16 v[60:63], v[152:155], v[52:55], 0
    v_mfma_f32_16x16x32_bf16 v[64:67], v[92:95], v[52:55], 0
    v_mfma_f32_16x16x32_bf16 v[68:71], v[152:155], v[132:135], 0
    v_mfma_f32_16x16x32_bf16 v[72:75], v[92:95], v[132:135], 0
    v_mfma_f32_16x16x32_bf16 v[76:79], v[152:155], v[36:39], 0
    v_mfma_f32_16x16x32_bf16 v[80:83], v[92:95], v[36:39], 0
LA_c3:
    ds_read_b32 v2, v20 offset:12
    s_waitcnt lgkmcnt(0)
    v_readfirstlane_b32 s76, v2
    s_nop 0
    s_cmp_lt_u32 s76, 4
    s_cbranch_scc1 LA_c3
    ds_read_b128 v[40:43], v11 offset:16384
    ds_read_b128 v[168:171], v12 offset:16384
    ds_read_b128 v[44:47], v11 offset:17408
    ds_read_b128 v[172:175], v13 offset:16384
    ds_read_b128 v[48:51], v11 offset:18432
    ds_read_b128 v[176:179], v14 offset:16384
    v_mfma_f32_16x16x32_bf16 v[76:79], v[140:143], v[36:39], v[76:79]
    v_mfma_f32_16x16x32_bf16 v[80:83], v[156:159], v[36:39], v[80:83]
    v_mfma_f32_16x16x32_bf16 v[76:79], v[144:147], v[36:39], v[76:79]
    v_mfma_f32_16x16x32_bf16 v[80:83], v[160:163], v[36:39], v[80:83]
    v_mfma_f32_16x16x32_bf16 v[76:79], v[148:151], v[36:39], v[76:79]
    v_mfma_f32_16x16x32_bf16 v[80:83], v[164:167], v[36:39], v[80:83]
    s_waitcnt lgkmcnt(4)
    v_mfma_f32_16x16x32_bf16 v[60:63], v[140:143], v[40:43], v[60:63]
    v_mfma_f32_16x16x32_bf16 v[64:67], v[156:159], v[40:43], v[64:67]
    v_mfma_f32_16x16x32_bf16 v[68:71], v[140:143], v[168:171], v[68:71]
    v_mfma_f32_16x16x32_bf16 v[72:75], v[156:159], v[168:171], v[72:75]
    s_waitcnt lgkmcnt(2)
    v_mfma_f32_16x16x32_bf16 v[60:63], v[144:147], v[44:47], v[60:63]
    v_mfma_f32_16x16x32_bf16 v[64:67], v[160:163], v[44:47], v[64:67]
    v_mfma_f32_16x16x32_bf16 v[68:71], v[144:147], v[172:175], v[68:71]
    v_mfma_f32_16x16x32_bf16 v[72:75], v[160:163], v[172:175], v[72:75]
    s_waitcnt lgkmcnt(0)
    v_mfma_f32_16x16x32_bf16 v[60:63], v[148:151], v[48:51], v[60:63]
    v_mfma_f32_16x16x32_bf16 v[64:67], v[164:167], v[48:51], v[64:67]
    v_mfma_f32_16x16x32_bf16 v[68:71], v[148:151], v[176:179], v[68:71]
    v_mfma_f32_16x16x32_bf16 v[72:75], v[164:167], v[176:179], v[72:75]
    s_nop 4
    v_cvt_pk_bf16_f32 v60, v60, v61
    v_cvt_pk_bf16_f32 v61, v62, v63
    v_cvt_pk_bf16_f32 v64, v64, v65
    v_cvt_pk_bf16_f32 v65, v66, v67
    v_cvt_pk_bf16_f32 v68, v68, v69
    v_cvt_pk_bf16_f32 v69, v70, v71
    v_cvt_pk_bf16_f32 v72, v72, v73
    v_cvt_pk_bf16_f32 v73, v74, v75
    v_cvt_pk_bf16_f32 v76, v76, v77
    v_cvt_pk_bf16_f32 v77, v78, v79
    v_cvt_pk_bf16_f32 v80, v80, v81
    v_cvt_pk_bf16_f32 v81, v82, v83
    buffer_store_dwordx2 v[60:61], v15, s[36:39], s17 offen sc1
    v_cndmask_b32 v68, v68, v76, s[6:7]
    v_cndmask_b32 v72, v72, v80, s[6:7]
    v_cndmask_b32 v69, v69, v77, s[6:7]
    v_cndmask_b32 v73, v73, v81, s[6:7]
    s_mov_b64 exec, s[30:31]
    buffer_store_dwordx2 v[64:65], v19, s[36:39], s17 offen sc1
    s_mov_b64 exec, s[4:5]
    buffer_store_dwordx2 v[68:69], v16, s[36:39], s17 offen sc1
    s_mov_b64 exec, s[40:41]
    buffer_store_dwordx2 v[72:73], v29, s[36:39], s17 offen sc1
    s_mov_b64 exec, -1
    s_setprio 0
    s_mov_b32 s76, s22
    s_add_u32 m0, s20, 81920
    s_nop 0
    buffer_load_dwordx4 v23, s[32:35], s76 offen lds
    s_add_u32 m0, s20, 82944
    s_nop 0
    buffer_load_dwordx4 v24, s[32:35], s76 offen lds
    s_add_u32 m0, s20, 83968
    s_nop 0
    buffer_load_dwordx4 v25, s[32:35], s76 offen lds
    s_add_u32 m0, s20, 84992
    s_nop 0
    buffer_load_dwordx4 v26, s[32:35], s76 offen lds
    s_add_u32 m0, s20, 86016
    s_nop 0
    buffer_load_dwordx4 v27, s[32:35], s76 offen lds
    s_mul_i32 s78, s55, 160
    s_movk_i32 s58, 1280
    v_add_u32 v1, 0, v0
    v_mul_u32_u24 v2, 6554, v1
    v_lshrrev_b32 v2, 16, v2
    v_lshl_add_u32 v1, v1, 4, s78
    v_mad_i32_i24 v1, v2, s59, v1
    v_lshrrev_b32 v3, 4, v2
    v_lshl_add_u32 v3, v3, 2, v2
    v_mad_u32_u24 v164, v3, s58, v1
    v_add_u32 v1, 64, v0
    v_mul_u32_u24 v2, 6554, v1
    v_lshrrev_b32 v2, 16, v2
    v_lshl_add_u32 v1, v1, 4, s78
    v_mad_i32_i24 v1, v2, s59, v1
    v_lshrrev_b32 v3, 4, v2
    v_lshl_add_u32 v3, v3, 2, v2
    v_mad_u32_u24 v165, v3, s58, v1
    v_add_u32 v1, 128, v0
    v_mul_u32_u24 v2, 6554, v1
    v_lshrrev_b32 v2, 16, v2
    v_lshl_add_u32 v1, v1, 4, s78
    v_mad_i32_i24 v1, v2, s59, v1
    v_lshrrev_b32 v3, 4, v2
    v_lshl_add_u32 v3, v3, 2, v2
    v_mad_u32_u24 v166, v3, s58, v1
    v_add_u32 v1, 192, v0
    v_mul_u32_u24 v2, 6554, v1
    v_lshrrev_b32 v2, 16, v2
    v_lshl_add_u32 v1, v1, 4, s78
    v_mad_i32_i24 v1, v2, s59, v1
    v_lshrrev_b32 v3, 4, v2
    v_lshl_add_u32 v3, v3, 2, v2
    v_mad_u32_u24 v167, v3, s58, v1
    v_add_u32 v1, 256, v0
    v_mul_u32_u24 v2, 6554, v1
    v_lshrrev_b32 v2, 16, v2
    v_lshl_add_u32 v1, v1, 4, s78
    v_mad_i32_i24 v1, v2, s59, v1
    v_lshrrev_b32 v3, 4, v2
    v_lshl_add_u32 v3, v3, 2, v2
    v_mad_u32_u24 v168, v3, s58, v1
LA_c1c:
    ds_read_b32 v2, v20 offset:4
    s_waitcnt lgkmcnt(0)
    v_readfirstlane_b32 s76, v2
    s_nop 0
    s_cmp_lt_u32 s76, 4
    s_cbranch_scc1 LA_c1c
    s_add_u32 s76, s21, 0
    s_add_u32 m0, s20, 0
    s_nop 0
    buffer_load_dwordx4 v164, s[32:35], s76 offen lds
    s_add_u32 m0, s20, 1024
    s_nop 0
    buffer_load_dwordx4 v165, s[32:35], s76 offen lds
    s_add_u32 m0, s20, 2048
    s_nop 0
    buffer_load_dwordx4 v166, s[32:35], s76 offen lds
    s_add_u32 m0, s20, 3072
    s_nop 0
    buffer_load_dwordx4 v167, s[32:35], s76 offen lds
    s_add_u32 m0, s20, 4096
    s_nop 0
    buffer_load_dwordx4 v168, s[32:35], s76 offen lds
    s_waitcnt vmcnt(0)
    s_mov_b32 s12, 0
    s_mov_b32 s11, 0
LA_try:
    s_bitcmp1_b32 s12, 0
    s_cbranch_scc1 LA_h0
    s_mov_b32 s76, 0
    buffer_load_dwordx4 v[84:87], v17, s[36:39], s76 offen sc1
    s_mov_b32 s76, 1024
    buffer_load_dwordx4 v[88:91], v17, s[36:39], s76 offen sc1
    s_mov_b32 s76, 2048
    buffer_load_dwordx4 v[92:95], v17, s[36:39], s76 offen sc1
    s_add_u32 s76, s15, 3072
    buffer_load_dwordx4 v[96:99], v17, s[36:39], s76 offen sc1
LA_h0:
    s_bitcmp1_b32 s12, 1
    s_cbranch_scc1 LA_h1
    s_mov_b32 s76, 16384
    buffer_load_dwordx4 v[100:103], v17, s[36:39], s76 offen sc1
    s_mov_b32 s76, 17408
    buffer_load_dwordx4 v[104:107], v17, s[36:39], s76 offen sc1
    s_mov_b32 s76, 18432
    buffer_load_dwordx4 v[108:111], v17, s[36:39], s76 offen sc1
    s_add_u32 s76, s15, 19456
    buffer_load_dwordx4 v[112:115], v17, s[36:39], s76 offen sc1
LA_h1:
    s_bitcmp1_b32 s12, 2
    s_cbranch_scc1 LA_h2
    s_mov_b32 s76, 32768
    buffer_load_dwordx4 v[116:119], v17, s[36:39], s76 offen sc1
    s_mov_b32 s76, 33792
    buffer_load_dwordx4 v[120:123], v17, s[36:39], s76 offen sc1
    s_mov_b32 s76, 34816
    buffer_load_dwordx4 v[124:127], v17, s[36:39], s76 offen sc1
    s_add_u32 s76, s15, 35840
    buffer_load_dwordx4 v[128:131], v17, s[36:39], s76 offen sc1
LA_h2:
    s_bitcmp1_b32 s12, 3
    s_cbranch_scc1 LA_h3
    s_mov_b32 s76, 49152
    buffer_load_dwordx4 v[132:135], v17, s[36:39], s76 offen sc1
    s_mov_b32 s76, 50176
    buffer_load_dwordx4 v[136:139], v17, s[36:39], s76 offen sc1
    s_mov_b32 s76, 51200
    buffer_load_dwordx4 v[140:143], v17, s[36:39], s76 offen sc1
    s_add_u32 s76, s15, 52224
    buffer_load_dwordx4 v[144:147], v17, s[36:39], s76 offen sc1
LA_h3:
    s_cmp_eq_u32 s11, 0
    s_cbranch_scc0 LA_w0
LA_e1:
    ds_read_b32 v2, v20 offset:8
    s_waitcnt lgkmcnt(0)
    v_readfirstlane_b32 s76, v2
    s_nop 0
    s_cmp_lt_u32 s76, 4
    s_cbranch_scc1 LA_e1
    s_add_u32 s76, s21, 204800
    s_add_u32 m0, s20, 20480
    s_nop 0
    buffer_load_dwordx4 v164, s[32:35], s76 offen lds
    s_add_u32 m0, s20, 21504
    s_nop 0
    buffer_load_dwordx4 v165, s[32:35], s76 offen lds
    s_add_u32 m0, s20, 22528
    s_nop 0
    buffer_load_dwordx4 v166, s[32:35], s76 offen lds
    s_add_u32 m0, s20, 23552
    s_nop 0
    buffer_load_dwordx4 v167, s[32:35], s76 offen lds
    s_add_u32 m0, s20, 24576
    s_nop 0
    buffer_load_dwordx4 v168, s[32:35], s76 offen lds
    s_waitcnt vmcnt(5)
    s_branch LA_w1
LA_w0:
    s_waitcnt vmcnt(0)
LA_w1:
    s_setprio 3
    v_max3_u32 v2, v84, v85, v86
    v_max3_u32 v3, v87, v88, v89
    v_max3_u32 v2, v2, v90, v91
    v_max3_u32 v3, v3, v92, v93
    v_max3_u32 v2, v2, v94, v95
    v_max3_u32 v3, v3, v96, v97
    v_max3_u32 v2, v2, v98, v99
    v_max_u32 v2, v2, v3
    v_cmp_eq_u32 vcc, -1, v2
    s_nop 0
    s_cmp_eq_u64 vcc, 0
    s_cselect_b32 s76, 1, 0
    s_or_b32 s12, s12, s76
    v_max3_u32 v2, v100, v101, v102
    v_max3_u32 v3, v103, v104, v105
    v_max3_u32 v2, v2, v106, v107
    v_max3_u32 v3, v3, v108, v109
    v_max3_u32 v2, v2, v110, v111
    v_max3_u32 v3, v3, v112, v113
    v_max3_u32 v2, v2, v114, v115
    v_max_u32 v2, v2, v3
    v_cmp_eq_u32 vcc, -1, v2
    s_nop 0
    s_cmp_eq_u64 vcc, 0
    s_cselect_b32 s76, 2, 0
    s_or_b32 s12, s12, s76
    v_max3_u32 v2, v116, v117, v118
    v_max3_u32 v3, v119, v120, v121
    v_max3_u32 v2, v2, v122, v123
    v_max3_u32 v3, v3, v124, v125
    v_max3_u32 v2, v2, v126, v127
    v_max3_u32 v3, v3, v128, v129
    v_max3_u32 v2, v2, v130, v131
    v_max_u32 v2, v2, v3
    v_cmp_eq_u32 vcc, -1, v2
    s_nop 0
    s_cmp_eq_u64 vcc, 0
    s_cselect_b32 s76, 4, 0
    s_or_b32 s12, s12, s76
    v_max3_u32 v2, v132, v133, v134
    v_max3_u32 v3, v135, v136, v137
    v_max3_u32 v2, v2, v138, v139
    v_max3_u32 v3, v3, v140, v141
    v_max3_u32 v2, v2, v142, v143
    v_max3_u32 v3, v3, v144, v145
    v_max3_u32 v2, v2, v146, v147
    v_max_u32 v2, v2, v3
    v_cmp_eq_u32 vcc, -1, v2
    s_nop 0
    s_cmp_eq_u64 vcc, 0
    s_cselect_b32 s76, 8, 0
    s_or_b32 s12, s12, s76
    s_cmp_eq_u32 s12, 15
    s_cbranch_scc1 LA_ok
    s_add_u32 s11, s11, 1
    s_cmp_lt_u32 s11, 32768
    s_cbranch_scc1 LA_try
LA_ok:
    v_mfma_f32_16x16x32_bf16 v[148:151], v[56:59], v[84:87], 0
    v_mfma_f32_16x16x32_bf16 v[152:155], v[56:59], v[88:91], 0
    v_mfma_f32_16x16x32_bf16 v[156:159], v[56:59], v[92:95], 0
    v_mfma_f32_16x16x32_bf16 v[160:163], v[56:59], v[96:99], 0
    v_mfma_f32_16x16x32_bf16 v[148:151], v[56:59], v[100:103], v[148:151]
    v_mfma_f32_16x16x32_bf16 v[152:155], v[56:59], v[104:107], v[152:155]
    v_mfma_f32_16x16x32_bf16 v[156:159], v[56:59], v[108:111], v[156:159]
    v_mfma_f32_16x16x32_bf16 v[160:163], v[56:59], v[112:115], v[160:163]
    v_mfma_f32_16x16x32_bf16 v[148:151], v[56:59], v[116:119], v[148:151]
    v_mfma_f32_16x16x32_bf16 v[152:155], v[56:59], v[120:123], v[152:155]
    v_mfma_f32_16x16x32_bf16 v[156:159], v[56:59], v[124:127], v[156:159]
    v_mfma_f32_16x16x32_bf16 v[160:163], v[56:59], v[128:131], v[160:163]
    v_mfma_f32_16x16x32_bf16 v[148:151], v[56:59], v[132:135], v[148:151]
    v_mfma_f32_16x16x32_bf16 v[152:155], v[56:59], v[136:139], v[152:155]
    v_mfma_f32_16x16x32_bf16 v[156:159], v[56:59], v[140:143], v[156:159]
    v_mfma_f32_16x16x32_bf16 v[160:163], v[56:59], v[144:147], v[160:163]
    s_nop 4
    v_cvt_pk_bf16_f32 v148, v148, v149
    v_cvt_pk_bf16_f32 v149, v150, v151
    v_cvt_pk_bf16_f32 v152, v152, v153
    v_cvt_pk_bf16_f32 v153, v154, v155
    v_cvt_pk_bf16_f32 v156, v156, v157
    v_cvt_pk_bf16_f32 v157, v158, v159
    v_cvt_pk_bf16_f32 v160, v160, v161
    v_cvt_pk_bf16_f32 v161, v162, v163
    s_mov_b64 exec, 0xffffffff
    ds_write_b64 v18, v[148:149] offset:0
    ds_write_b64 v18, v[152:153] offset:1024
    ds_write_b64 v18, v[156:157] offset:2048
    ds_write_b64 v18, v[160:161] offset:3072
    s_mov_b64 exec, -1
    s_waitcnt lgkmcnt(0)
    s_barrier
    s_setprio 0
    s_add_u32 s76, s21, 409600
    s_add_u32 m0, s20, 40960
    s_nop 0
    buffer_load_dwordx4 v164, s[32:35], s76 offen lds
    s_add_u32 m0, s20, 41984
    s_nop 0
    buffer_load_dwordx4 v165, s[32:35], s76 offen lds
    s_add_u32 m0, s20, 43008
    s_nop 0
    buffer_load_dwordx4 v166, s[32:35], s76 offen lds
    s_add_u32 m0, s20, 44032
    s_nop 0
    buffer_load_dwordx4 v167, s[32:35], s76 offen lds
    s_add_u32 m0, s20, 45056
    s_nop 0
    buffer_load_dwordx4 v168, s[32:35], s76 offen lds
    s_add_u32 s76, s21, 614400
    s_add_u32 m0, s20, 61440
    s_nop 0
    buffer_load_dwordx4 v164, s[32:35], s76 offen lds
    s_add_u32 m0, s20, 62464
    s_nop 0
    buffer_load_dwordx4 v165, s[32:35], s76 offen lds
    s_add_u32 m0, s20, 63488
    s_nop 0
    buffer_load_dwordx4 v166, s[32:35], s76 offen lds
    s_add_u32 m0, s20, 64512
    s_nop 0
    buffer_load_dwordx4 v167, s[32:35], s76 offen lds
    s_add_u32 m0, s20, 65536
    s_nop 0
    buffer_load_dwordx4 v168, s[32:35], s76 offen lds
    s_barrier
    s_mov_b32 s13, 1
    s_branch LP2
.p2align 6
L_B:
    v_lshrrev_b32 v1, 6, v0
    v_and_b32 v0, 63, v0
    s_and_b32 s76, s2, 3
    v_readfirstlane_b32 s52, v1
    s_bfe_u32 s77, s2, 0x20003
    s_lshr_b32 s55, s2, 5
    s_lshl_b32 s54, s76, 2
    s_add_u32 s54, s54, s77
    s_and_b32 s53, s52, 3
    s_mov_b32 s57, 1
    s_cmp_lt_u32 s52, 4
    s_cbranch_scc1 L_BC
    s_setprio 3
    s_mul_i32 s77, s77, 3
    s_lshr_b32 s78, s55, 1
    s_mul_i32 s78, s78, 2
    s_add_u32 s77, s77, s78
    s_and_b32 s77, s77, 7
    s_mul_i32 s77, s77, 10
    s_mul_i32 s76, s76, 5
    s_add_u32 s77, s77, s76
    s_lshr_b32 s56, s77, 3
    s_cmp_ge_u32 s56, 10
    s_cselect_b32 s77, 10, 0
    s_sub_u32 s56, s56, s77
    s_lshl_b32 s76, s54, 2
    s_add_u32 s76, s76, s53
    s_mul_i32 s76, s76, 40960
    v_lshrrev_b32 v1, 3, v0
    v_and_b32 v2, 7, v0
    v_xor_b32 v2, v2, v1
    v_mul_u32_u24 v1, 1280, v1
    v_lshl_add_u32 v9, v2, 4, v1
    v_add_u32 v4, s76, v9
    v_add_u32 v5, 10240, v4
    v_add_u32 v6, 20480, v4
    v_add_u32 v7, 30720, v4
    s_lshl_b32 s72, s56, 7
    s_mul_i32 s78, s55, 160
    s_movk_i32 s58, 3840
    s_movk_i32 s59, -160
    s_mov_b32 s26, 2621440
    s_mov_b32 s27, 0x20000
    s_mov_b32 s30, 2457600
    s_mov_b32 s31, 0x20000
    s_waitcnt lgkmcnt(0)
    s_mov_b64 s[24:25], s[10:11]
    s_mov_b64 s[28:29], s[12:13]
    s_mul_i32 s76, s54, 163840
    s_sub_u32 s76, s76, 20480
    v_add_u32 v8, s76, v9
    s_lshl_b32 s70, s53, 12
    s_mul_i32 s71, s56, 245760
    s_mov_b32 m0, 149504
    s_nop 0
    buffer_load_dwordx4 v8, s[24:27], s72 offen lds
    s_add_u32 m0, s70, 133120
    s_nop 0
    buffer_load_dwordx4 v4, s[24:27], s72 offen lds
    s_add_u32 m0, s70, 134144
    s_nop 0
    buffer_load_dwordx4 v5, s[24:27], s72 offen lds
    s_lshl_b32 s60, s53, 10
    s_lshl_b32 s76, s53, 6
    s_movk_i32 s77, 1280
    v_add_u32 v10, s76, v0
    v_add_u32 v1, 0, v10
    v_mul_u32_u24 v2, 6554, v1
    v_lshrrev_b32 v2, 16, v2
    v_lshl_add_u32 v1, v1, 4, s78
    v_mad_i32_i24 v1, v2, s59, v1
    v_lshrrev_b32 v3, 5, v2
    v_mad_u32_u24 v1, v3, s77, v1
    v_and_b32 v2, 31, v2
    v_bfe_u32 v3, v2, 2, 2
    v_lshl_add_u32 v3, v3, 2, v2
    v_lshrrev_b32 v2, 4, v2
    v_mad_i32_i24 v3, v2, -12, v3
    v_mad_u32_u24 v11, v3, s58, v1
    v_add_u32 v1, 256, v10
    v_mul_u32_u24 v2, 6554, v1
    v_lshrrev_b32 v2, 16, v2
    v_lshl_add_u32 v1, v1, 4, s78
    v_mad_i32_i24 v1, v2, s59, v1
    v_lshrrev_b32 v3, 5, v2
    v_mad_u32_u24 v1, v3, s77, v1
    v_and_b32 v2, 31, v2
    v_bfe_u32 v3, v2, 2, 2
    v_lshl_add_u32 v3, v3, 2, v2
    v_lshrrev_b32 v2, 4, v2
    v_mad_i32_i24 v3, v2, -12, v3
    v_mad_u32_u24 v12, v3, s58, v1
    v_add_u32 v1, 512, v10
    v_mul_u32_u24 v2, 6554, v1
    v_lshrrev_b32 v2, 16, v2
    v_lshl_add_u32 v1, v1, 4, s78
    v_mad_i32_i24 v1, v2, s59, v1
    v_lshrrev_b32 v3, 5, v2
    v_mad_u32_u24 v1, v3, s77, v1
    v_and_b32 v2, 31, v2
    v_bfe_u32 v3, v2, 2, 2
    v_lshl_add_u32 v3, v3, 2, v2
    v_lshrrev_b32 v2, 4, v2
    v_mad_i32_i24 v3, v2, -12, v3
    v_mad_u32_u24 v13, v3, s58, v1
    v_add_u32 v1, 768, v10
    v_mul_u32_u24 v2, 6554, v1
    v_lshrrev_b32 v2, 16, v2
    v_lshl_add_u32 v1, v1, 4, s78
    v_mad_i32_i24 v1, v2, s59, v1
    v_lshrrev_b32 v3, 5, v2
    v_mad_u32_u24 v1, v3, s77, v1
    v_and_b32 v2, 31, v2
    v_bfe_u32 v3, v2, 2, 2
    v_lshl_add_u32 v3, v3, 2, v2
    v_lshrrev_b32 v2, 4, v2
    v_mad_i32_i24 v3, v2, -12, v3
    v_mad_u32_u24 v14, v3, s58, v1
    s_cmp_eq_u32 s53, 3
    s_cselect_b64 vcc, -1, 0
    v_cndmask_b32 v14, v14, v8, vcc
    s_cselect_b32 s40, s10, s12
    s_cselect_b32 s41, s11, s13
    s_cselect_b32 s42, s26, s30
    s_mov_b32 s43, 0x20000
    s_add_u32 m0, s60, 0
    s_nop 0
    buffer_load_dwordx4 v11, s[28:31], s71 offen lds
    s_add_u32 m0, s60, 4096
    s_nop 0
    buffer_load_dwordx4 v12, s[28:31], s71 offen lds
    s_add_u32 m0, s60, 8192
    s_nop 0
    buffer_load_dwordx4 v13, s[28:31], s71 offen lds
    s_add_u32 s73, s72, 10240
    s_add_u32 s76, s60, 12288
    s_cmp_eq_u32 s53, 3
    s_cselect_b32 s73, s73, s71
    s_cselect_b32 m0, 150528, s76
    s_nop 0
    buffer_load_dwordx4 v14, s[40:43], s73 offen lds
    s_add_u32 m0, s70, 135168
    s_nop 0
    buffer_load_dwordx4 v6, s[24:27], s72 offen lds
    s_add_u32 m0, s70, 136192
    s_nop 0
    buffer_load_dwordx4 v7, s[24:27], s72 offen lds
    s_add_u32 s71, s71, 122880
    s_cmp_eq_u32 s71, 2457600
    s_cselect_b32 s71, 0, s71
    s_add_u32 m0, s60, 15360
    s_nop 0
    buffer_load_dwordx4 v11, s[28:31], s71 offen lds
    s_add_u32 m0, s60, 19456
    s_nop 0
    buffer_load_dwordx4 v12, s[28:31], s71 offen lds
    s_add_u32 m0, s60, 23552
    s_nop 0
    buffer_load_dwordx4 v13, s[28:31], s71 offen lds
    s_add_u32 s72, s72, 128
    s_cmp_eq_u32 s72, 1280
    s_cselect_b32 s72, 0, s72
    s_add_u32 s73, s72, 0
    s_add_u32 s76, s60, 27648
    s_cmp_eq_u32 s53, 3
    s_cselect_b32 s73, s73, s71
    s_cselect_b32 m0, 151552, s76
    s_nop 0
    buffer_load_dwordx4 v14, s[40:43], s73 offen lds
    s_add_u32 m0, s70, 92160
    s_nop 0
    buffer_load_dwordx4 v4, s[24:27], s72 offen lds
    s_add_u32 m0, s70, 93184
    s_nop 0
    buffer_load_dwordx4 v5, s[24:27], s72 offen lds
    s_add_u32 s71, s71, 122880
    s_cmp_eq_u32 s71, 2457600
    s_cselect_b32 s71, 0, s71
    s_mov_b32 s32, s14
    s_mov_b32 s33, s15
    s_mov_b32 s34, 819200
    s_mov_b32 s35, 0x20000
    s_mov_b32 s48, s16
    s_mov_b32 s49, s17
    s_mov_b32 s50, 5242880
    s_mov_b32 s51, 0x20000
    s_mov_b32 s44, s18
    s_mov_b32 s45, s19
    s_mov_b32 s46, 256
    s_mov_b32 s47, 0x20000
    s_mov_b32 s36, s20
    s_mov_b32 s37, s21
    s_mov_b32 s38, 8388608
    s_mov_b32 s39, 0x20000
    s_mov_b32 s23, 40960
    s_mul_i32 s20, s53, 5120
    s_mul_i32 s21, s53, 51200
    s_mul_i32 s22, s53, 204800
    s_getreg_b32 s76, hwreg(HW_REG_XCC_ID, 0, 3)
    s_lshl_b32 s76, s76, 2
    s_lshl_b32 s99, 1, s76
    s_lshl_b32 s98, 8, s76
    s_lshr_b32 s93, s55, 2
    s_xor_b32 s93, s93, 1
    s_lshl_b32 s92, s54, 3
    s_lshl_b32 s76, s53, 1
    s_add_u32 s92, s92, s76
    s_mul_i32 s92, s92, 40960
    s_add_u32 s92, s92, 1280
    s_lshl_b32 s97, s54, 2
    s_add_u32 s19, s97, s53
    s_lshl_b32 s19, s19, 7
    s_add_u32 s19, s19, 6823936
    s_add_u32 s97, s97, 96
    s_mov_b32 s76, 133120
    s_mov_b32 s77, 61440
    s_cmp_eq_u32 s93, 0
    s_cselect_b32 s78, 92160, s76
    s_cselect_b32 s79, 112640, s77
    s_add_u32 s76, s55, 0
    s_and_b32 s76, s76, 3
    s_lshl_b32 s77, s93, 2
    s_add_u32 s77, s77, s76
    s_mul_i32 s82, s77, 5120
    s_cmp_ge_u32 s76, 2
    s_cselect_b32 s77, s79, s78
    s_and_b32 s76, s76, 1
    s_mul_i32 s76, s76, 10240
    s_add_u32 s87, s77, s76
    s_add_u32 s76, s55, 1
    s_and_b32 s76, s76, 3
    s_lshl_b32 s77, s93, 2
    s_add_u32 s77, s77, s76
    s_mul_i32 s83, s77, 5120
    s_cmp_ge_u32 s76, 2
    s_cselect_b32 s77, s79, s78
    s_and_b32 s76, s76, 1
    s_mul_i32 s76, s76, 10240
    s_add_u32 s88, s77, s76
    s_add_u32 s76, s55, 2
    s_and_b32 s76, s76, 3
    s_lshl_b32 s77, s93, 2
    s_add_u32 s77, s77, s76
    s_mul_i32 s84, s77, 5120
    s_cmp_ge_u32 s76, 2
    s_cselect_b32 s77, s79, s78
    s_and_b32 s76, s76, 1
    s_mul_i32 s76, s76, 10240
    s_add_u32 s89, s77, s76
    s_add_u32 s76, s55, 3
    s_and_b32 s76, s76, 3
    s_lshl_b32 s77, s93, 2
    s_add_u32 s77, s77, s76
    s_mul_i32 s85, s77, 5120
    s_cmp_ge_u32 s76, 2
    s_cselect_b32 s77, s79, s78
    s_and_b32 s76, s76, 1
    s_mul_i32 s76, s76, 10240
    s_add_u32 s90, s77, s76
    s_mul_i32 s76, s93, 10240
    s_add_u32 s91, s76, 0
    s_mul_i32 s86, s93, 20480
    s_xor_b32 s79, s52, 4
    s_mul_i32 s94, s52, 5120
    s_mov_b32 s78, 30720
    s_cmp_ge_u32 s52, 6
    s_cselect_b32 s78, 51200, s78
    s_add_u32 s94, s94, s78
    s_mul_i32 s95, s79, 5120
    s_mov_b32 s78, 30720
    s_cmp_ge_u32 s79, 6
    s_cselect_b32 s78, 51200, s78
    s_add_u32 s95, s95, s78
    s_lshl_b32 s76, s54, 7
    s_lshl_b32 s78, s53, 5
    s_add_u32 s76, s76, s78
    s_add_u32 s76, s76, 0
    s_mul_i32 s76, s76, 2560
    s_mul_i32 s78, s55, 160
    s_add_u32 s76, s76, s78
    s_add_u32 s96, s76, 1280
    s_lshl_b32 s76, s55, 2
    v_lshlrev_b32 v1, 2, v0
    v_add_u32 v2, 28, v1
    v_add_u32 v2, s76, v2
    v_cmp_eq_u32 vcc, 0, v0
    s_nop 1
    v_cndmask_b32 v1, v2, v1, vcc
    v_add_u32 v1, s76, v1
    v_mov_b32 v2, 0
    s_mov_b64 exec, 7
    buffer_store_dword v2, v1, s[36:39], s19 offen sc1
    s_mov_b64 exec, -1
    s_mul_i32 s78, s55, 160
    s_movk_i32 s58, 1280
    v_add_u32 v1, 0, v0
    v_mul_u32_u24 v2, 6554, v1
    v_lshrrev_b32 v2, 16, v2
    v_lshl_add_u32 v1, v1, 4, s78
    v_mad_i32_i24 v1, v2, s59, v1
    v_lshrrev_b32 v3, 4, v2
    v_lshl_add_u32 v3, v3, 2, v2
    v_mad_u32_u24 v16, v3, s58, v1
    v_add_u32 v1, 64, v0
    v_mul_u32_u24 v2, 6554, v1
    v_lshrrev_b32 v2, 16, v2
    v_lshl_add_u32 v1, v1, 4, s78
    v_mad_i32_i24 v1, v2, s59, v1
    v_lshrrev_b32 v3, 4, v2
    v_lshl_add_u32 v3, v3, 2, v2
    v_mad_u32_u24 v17, v3, s58, v1
    v_add_u32 v1, 128, v0
    v_mul_u32_u24 v2, 6554, v1
    v_lshrrev_b32 v2, 16, v2
    v_lshl_add_u32 v1, v1, 4, s78
    v_mad_i32_i24 v1, v2, s59, v1
    v_lshrrev_b32 v3, 4, v2
    v_lshl_add_u32 v3, v3, 2, v2
    v_mad_u32_u24 v18, v3, s58, v1
    v_add_u32 v1, 192, v0
    v_mul_u32_u24 v2, 6554, v1
    v_lshrrev_b32 v2, 16, v2
    v_lshl_add_u32 v1, v1, 4, s78
    v_mad_i32_i24 v1, v2, s59, v1
    v_lshrrev_b32 v3, 4, v2
    v_lshl_add_u32 v3, v3, 2, v2
    v_mad_u32_u24 v19, v3, s58, v1
    v_add_u32 v1, 256, v0
    v_mul_u32_u24 v2, 6554, v1
    v_lshrrev_b32 v2, 16, v2
    v_lshl_add_u32 v1, v1, 4, s78
    v_mad_i32_i24 v1, v2, s59, v1
    v_lshrrev_b32 v3, 4, v2
    v_lshl_add_u32 v3, v3, 2, v2
    v_mad_u32_u24 v20, v3, s58, v1
    s_mul_i32 s78, s55, 160
    s_movk_i32 s58, 1280
    v_add_u32 v1, 0, v0
    v_mul_u32_u24 v2, 6554, v1
    v_lshrrev_b32 v2, 16, v2
    v_lshl_add_u32 v1, v1, 4, s78
    v_mad_i32_i24 v1, v2, s59, v1
    v_lshrrev_b32 v3, 2, v2
    v_and_b32 v2, 3, v2
    v_mad_u32_u24 v3, v3, 20, v2
    v_add_u32 v3, 16, v3
    v_mad_u32_u24 v21, v3, s58, v1
    v_add_u32 v1, 64, v0
    v_mul_u32_u24 v2, 6554, v1
    v_lshrrev_b32 v2, 16, v2
    v_lshl_add_u32 v1, v1, 4, s78
    v_mad_i32_i24 v1, v2, s59, v1
    v_lshrrev_b32 v3, 2, v2
    v_and_b32 v2, 3, v2
    v_mad_u32_u24 v3, v3, 20, v2
    v_add_u32 v3, 16, v3
    v_mad_u32_u24 v22, v3, s58, v1
    v_add_u32 v1, 128, v0
    v_mul_u32_u24 v2, 6554, v1
    v_lshrrev_b32 v2, 16, v2
    v_lshl_add_u32 v1, v1, 4, s78
    v_mad_i32_i24 v1, v2, s59, v1
    v_lshrrev_b32 v3, 2, v2
    v_and_b32 v2, 3, v2
    v_mad_u32_u24 v3, v3, 20, v2
    v_add_u32 v3, 16, v3
    v_mad_u32_u24 v23, v3, s58, v1
    v_add_u32 v1, 192, v0
    v_mul_u32_u24 v2, 6554, v1
    v_lshrrev_b32 v2, 16, v2
    v_lshl_add_u32 v1, v1, 4, s78
    v_mad_i32_i24 v1, v2, s59, v1
    v_lshrrev_b32 v3, 2, v2
    v_and_b32 v2, 3, v2
    v_mad_u32_u24 v3, v3, 20, v2
    v_add_u32 v3, 16, v3
    v_mad_u32_u24 v24, v3, s58, v1
    v_add_u32 v1, 256, v0
    v_mul_u32_u24 v2, 6554, v1
    v_lshrrev_b32 v2, 16, v2
    v_lshl_add_u32 v1, v1, 4, s78
    v_mad_i32_i24 v1, v2, s59, v1
    v_lshrrev_b32 v3, 2, v2
    v_and_b32 v2, 3, v2
    v_mad_u32_u24 v3, v3, 20, v2
    v_add_u32 v3, 16, v3
    v_mad_u32_u24 v25, v3, s58, v1
    s_waitcnt vmcnt(7)
    s_barrier
    s_add_u32 m0, s60, 30720
    s_nop 0
    buffer_load_dwordx4 v11, s[28:31], s71 offen lds
    s_add_u32 m0, s60, 34816
    s_nop 0
    buffer_load_dwordx4 v12, s[28:31], s71 offen lds
    s_add_u32 m0, s60, 38912
    s_nop 0
    buffer_load_dwordx4 v13, s[28:31], s71 offen lds
    s_add_u32 s73, s72, 10240
    s_add_u32 s76, s60, 43008
    s_cmp_eq_u32 s53, 3
    s_cselect_b32 s73, s73, s71
    s_cselect_b32 m0, 152576, s76
    s_nop 0
    buffer_load_dwordx4 v14, s[40:43], s73 offen lds
    s_add_u32 m0, s70, 94208
    s_nop 0
    buffer_load_dwordx4 v6, s[24:27], s72 offen lds
    s_add_u32 m0, s70, 95232
    s_nop 0
    buffer_load_dwordx4 v7, s[24:27], s72 offen lds
    s_add_u32 s71, s71, 122880
    s_cmp_eq_u32 s71, 2457600
    s_cselect_b32 s71, 0, s71
    s_add_u32 m0, s60, 46080
    s_nop 0
    buffer_load_dwordx4 v11, s[28:31], s71 offen lds
    s_add_u32 m0, s60, 50176
    s_nop 0
    buffer_load_dwordx4 v12, s[28:31], s71 offen lds
    s_add_u32 m0, s60, 54272
    s_nop 0
    buffer_load_dwordx4 v13, s[28:31], s71 offen lds
    s_add_u32 s72, s72, 128
    s_cmp_eq_u32 s72, 1280
    s_cselect_b32 s72, 0, s72
    s_add_u32 s73, s72, 0
    s_add_u32 s76, s60, 58368
    s_cmp_eq_u32 s53, 3
    s_cselect_b32 s73, s73, s71
    s_cselect_b32 m0, 153600, s76
    s_nop 0
    buffer_load_dwordx4 v14, s[40:43], s73 offen lds
    s_add_u32 m0, s70, 108544
    s_nop 0
    buffer_load_dwordx4 v4, s[24:27], s72 offen lds
    s_add_u32 m0, s70, 109568
    s_nop 0
    buffer_load_dwordx4 v5, s[24:27], s72 offen lds
    s_add_u32 s71, s71, 122880
    s_cmp_eq_u32 s71, 2457600
    s_cselect_b32 s71, 0, s71
    s_waitcnt vmcnt(13)
    s_barrier
    s_add_u32 m0, s60, 61440
    s_nop 0
    buffer_load_dwordx4 v11, s[28:31], s71 offen lds
    s_add_u32 m0, s60, 65536
    s_nop 0
    buffer_load_dwordx4 v12, s[28:31], s71 offen lds
    s_add_u32 m0, s60, 69632
    s_nop 0
    buffer_load_dwordx4 v13, s[28:31], s71 offen lds
    s_add_u32 s73, s72, 10240
    s_add_u32 s76, s60, 73728
    s_cmp_eq_u32 s53, 3
    s_cselect_b32 s73, s73, s71
    s_cselect_b32 m0, 154624, s76
    s_nop 0
    buffer_load_dwordx4 v14, s[40:43], s73 offen lds
    s_add_u32 m0, s70, 110592
    s_nop 0
    buffer_load_dwordx4 v6, s[24:27], s72 offen lds
    s_add_u32 m0, s70, 111616
    s_nop 0
    buffer_load_dwordx4 v7, s[24:27], s72 offen lds
    s_add_u32 s71, s71, 122880
    s_cmp_eq_u32 s71, 2457600
    s_cselect_b32 s71, 0, s71
    s_waitcnt vmcnt(12)
    s_barrier
    s_add_u32 m0, s60, 76800
    s_nop 0
    buffer_load_dwordx4 v11, s[28:31], s71 offen lds
    s_add_u32 m0, s60, 80896
    s_nop 0
    buffer_load_dwordx4 v12, s[28:31], s71 offen lds
    s_add_u32 m0, s60, 84992
    s_nop 0
    buffer_load_dwordx4 v13, s[28:31], s71 offen lds
    s_add_u32 s72, s72, 128
    s_cmp_eq_u32 s72, 1280
    s_cselect_b32 s72, 0, s72
    s_add_u32 s73, s72, 0
    s_add_u32 s76, s60, 89088
    s_cmp_eq_u32 s53, 3
    s_cselect_b32 s73, s73, s71
    s_cselect_b32 m0, 149504, s76
    s_nop 0
    buffer_load_dwordx4 v14, s[40:43], s73 offen lds
    s_add_u32 m0, s70, 133120
    s_nop 0
    buffer_load_dwordx4 v4, s[24:27], s72 offen lds
    s_add_u32 m0, s70, 134144
    s_nop 0
    buffer_load_dwordx4 v5, s[24:27], s72 offen lds
    s_add_u32 s71, s71, 122880
    s_cmp_eq_u32 s71, 2457600
    s_cselect_b32 s71, 0, s71
    s_cmp_eq_u32 s53, 0
    s_cbranch_scc0 LB_sig
    s_lshl_b32 s77, s55, 2
    s_add_u32 s77, s77, 0
    v_mov_b32 v1, s97
    v_mov_b32 v2, s77
    v_cmp_eq_u32 vcc, 0, v0
    s_nop 1
    v_cndmask_b32 v1, v2, v1, vcc
    v_mov_b32 v2, s99
    v_cndmask_b32 v2, 1, v2, vcc
    s_mov_b64 exec, 1
    buffer_atomic_add v2, v1, s[44:47], 0 offen sc1
    s_mov_b64 exec, -1
LB_sig:
    s_waitcnt vmcnt(12)
    s_barrier
    s_add_u32 m0, s60, 0
    s_nop 0
    buffer_load_dwordx4 v11, s[28:31], s71 offen lds
    s_add_u32 m0, s60, 4096
    s_nop 0
    buffer_load_dwordx4 v12, s[28:31], s71 offen lds
    s_add_u32 m0, s60, 8192
    s_nop 0
    buffer_load_dwordx4 v13, s[28:31], s71 offen lds
    s_add_u32 s73, s72, 10240
    s_add_u32 s76, s60, 12288
    s_cmp_eq_u32 s53, 3
    s_cselect_b32 s73, s73, s71
    s_cselect_b32 m0, 150528, s76
    s_nop 0
    buffer_load_dwordx4 v14, s[40:43], s73 offen lds
    s_add_u32 m0, s70, 135168
    s_nop 0
    buffer_load_dwordx4 v6, s[24:27], s72 offen lds
    s_add_u32 m0, s70, 136192
    s_nop 0
    buffer_load_dwordx4 v7, s[24:27], s72 offen lds
    s_add_u32 s71, s71, 122880
    s_cmp_eq_u32 s71, 2457600
    s_cselect_b32 s71, 0, s71
    s_waitcnt vmcnt(12)
    s_barrier
    s_add_u32 m0, s60, 15360
    s_nop 0
    buffer_load_dwordx4 v11, s[28:31], s71 offen lds
    s_add_u32 m0, s60, 19456
    s_nop 0
    buffer_load_dwordx4 v12, s[28:31], s71 offen lds
    s_add_u32 m0, s60, 23552
    s_nop 0
    buffer_load_dwordx4 v13, s[28:31], s71 offen lds
    s_add_u32 s72, s72, 128
    s_cmp_eq_u32 s72, 1280
    s_cselect_b32 s72, 0, s72
    s_add_u32 s73, s72, 0
    s_add_u32 s76, s60, 27648
    s_cmp_eq_u32 s53, 3
    s_cselect_b32 s73, s73, s71
    s_cselect_b32 m0, 151552, s76
    s_nop 0
    buffer_load_dwordx4 v14, s[40:43], s73 offen lds
    s_add_u32 m0, s70, 92160
    s_nop 0
    buffer_load_dwordx4 v4, s[24:27], s72 offen lds
    s_add_u32 m0, s70, 93184
    s_nop 0
    buffer_load_dwordx4 v5, s[24:27], s72 offen lds
    s_add_u32 s71, s71, 122880
    s_cmp_eq_u32 s71, 2457600
    s_cselect_b32 s71, 0, s71
    s_waitcnt vmcnt(12)
    s_barrier
    s_add_u32 m0, s60, 30720
    s_nop 0
    buffer_load_dwordx4 v11, s[28:31], s71 offen lds
    s_add_u32 m0, s60, 34816
    s_nop 0
    buffer_load_dwordx4 v12, s[28:31], s71 offen lds
    s_add_u32 m0, s60, 38912
    s_nop 0
    buffer_load_dwordx4 v13, s[28:31], s71 offen lds
    s_add_u32 s73, s72, 10240
    s_add_u32 s76, s60, 43008
    s_cmp_eq_u32 s53, 3
    s_cselect_b32 s73, s73, s71
    s_cselect_b32 m0, 152576, s76
    s_nop 0
    buffer_load_dwordx4 v14, s[40:43], s73 offen lds
    s_add_u32 m0, s70, 94208
    s_nop 0
    buffer_load_dwordx4 v6, s[24:27], s72 offen lds
    s_add_u32 m0, s70, 95232
    s_nop 0
    buffer_load_dwordx4 v7, s[24:27], s72 offen lds
    s_add_u32 s71, s71, 122880
    s_cmp_eq_u32 s71, 2457600
    s_cselect_b32 s71, 0, s71
    s_waitcnt vmcnt(12)
    s_barrier
    s_add_u32 m0, s60, 46080
    s_nop 0
    buffer_load_dwordx4 v11, s[28:31], s71 offen lds
    s_add_u32 m0, s60, 50176
    s_nop 0
    buffer_load_dwordx4 v12, s[28:31], s71 offen lds
    s_add_u32 m0, s60, 54272
    s_nop 0
    buffer_load_dwordx4 v13, s[28:31], s71 offen lds
    s_add_u32 s72, s72, 128
    s_cmp_eq_u32 s72, 1280
    s_cselect_b32 s72, 0, s72
    s_add_u32 s73, s72, 0
    s_add_u32 s76, s60, 58368
    s_cmp_eq_u32 s53, 3
    s_cselect_b32 s73, s73, s71
    s_cselect_b32 m0, 153600, s76
    s_nop 0
    buffer_load_dwordx4 v14, s[40:43], s73 offen lds
    s_add_u32 m0, s70, 108544
    s_nop 0
    buffer_load_dwordx4 v4, s[24:27], s72 offen lds
    s_add_u32 m0, s70, 109568
    s_nop 0
    buffer_load_dwordx4 v5, s[24:27], s72 offen lds
    s_add_u32 s71, s71, 122880
    s_cmp_eq_u32 s71, 2457600
    s_cselect_b32 s71, 0, s71
    s_waitcnt vmcnt(12)
    s_barrier
    s_add_u32 m0, s60, 61440
    s_nop 0
    buffer_load_dwordx4 v11, s[28:31], s71 offen lds
    s_add_u32 m0, s60, 65536
    s_nop 0
    buffer_load_dwordx4 v12, s[28:31], s71 offen lds
    s_add_u32 m0, s60, 69632
    s_nop 0
    buffer_load_dwordx4 v13, s[28:31], s71 offen lds
    s_add_u32 s73, s72, 10240
    s_add_u32 s76, s60, 73728
    s_cmp_eq_u32 s53, 3
    s_cselect_b32 s73, s73, s71
    s_cselect_b32 m0, 154624, s76
    s_nop 0
    buffer_load_dwordx4 v14, s[40:43], s73 offen lds
    s_add_u32 m0, s70, 110592
    s_nop 0
    buffer_load_dwordx4 v6, s[24:27], s72 offen lds
    s_add_u32 m0, s70, 111616
    s_nop 0
    buffer_load_dwordx4 v7, s[24:27], s72 offen lds
    s_add_u32 s71, s71, 122880
    s_cmp_eq_u32 s71, 2457600
    s_cselect_b32 s71, 0, s71
    s_waitcnt vmcnt(12)
    s_barrier
    s_add_u32 m0, s60, 76800
    s_nop 0
    buffer_load_dwordx4 v11, s[28:31], s71 offen lds
    s_add_u32 m0, s60, 80896
    s_nop 0
    buffer_load_dwordx4 v12, s[28:31], s71 offen lds
    s_add_u32 m0, s60, 84992
    s_nop 0
    buffer_load_dwordx4 v13, s[28:31], s71 offen lds
    s_add_u32 s72, s72, 128
    s_cmp_eq_u32 s72, 1280
    s_cselect_b32 s72, 0, s72
    s_add_u32 s73, s72, 0
    s_add_u32 s76, s60, 89088
    s_cmp_eq_u32 s53, 3
    s_cselect_b32 s73, s73, s71
    s_cselect_b32 m0, 149504, s76
    s_nop 0
    buffer_load_dwordx4 v14, s[40:43], s73 offen lds
    s_add_u32 m0, s70, 133120
    s_nop 0
    buffer_load_dwordx4 v4, s[24:27], s72 offen lds
    s_add_u32 m0, s70, 134144
    s_nop 0
    buffer_load_dwordx4 v5, s[24:27], s72 offen lds
    s_add_u32 s71, s71, 122880
    s_cmp_eq_u32 s71, 2457600
    s_cselect_b32 s71, 0, s71
    s_waitcnt vmcnt(12)
    s_barrier
    s_add_u32 m0, s60, 0
    s_nop 0
    buffer_load_dwordx4 v11, s[28:31], s71 offen lds
    s_add_u32 m0, s60, 4096
    s_nop 0
    buffer_load_dwordx4 v12, s[28:31], s71 offen lds
    s_add_u32 m0, s60, 8192
    s_nop 0
    buffer_load_dwordx4 v13, s[28:31], s71 offen lds
    s_add_u32 s73, s72, 10240
    s_add_u32 s76, s60, 12288
    s_cmp_eq_u32 s53, 3
    s_cselect_b32 s73, s73, s71
    s_cselect_b32 m0, 150528, s76
    s_nop 0
    buffer_load_dwordx4 v14, s[40:43], s73 offen lds
    s_add_u32 m0, s70, 135168
    s_nop 0
    buffer_load_dwordx4 v6, s[24:27], s72 offen lds
    s_add_u32 m0, s70, 136192
    s_nop 0
    buffer_load_dwordx4 v7, s[24:27], s72 offen lds
    s_add_u32 s71, s71, 122880
    s_cmp_eq_u32 s71, 2457600
    s_cselect_b32 s71, 0, s71
    s_waitcnt vmcnt(12)
    s_barrier
    s_add_u32 m0, s60, 15360
    s_nop 0
    buffer_load_dwordx4 v11, s[28:31], s71 offen lds
    s_add_u32 m0, s60, 19456
    s_nop 0
    buffer_load_dwordx4 v12, s[28:31], s71 offen lds
    s_add_u32 m0, s60, 23552
    s_nop 0
    buffer_load_dwordx4 v13, s[28:31], s71 offen lds
    s_add_u32 s72, s72, 128
    s_cmp_eq_u32 s72, 1280
    s_cselect_b32 s72, 0, s72
    s_add_u32 s73, s72, 0
    s_add_u32 s76, s60, 27648
    s_cmp_eq_u32 s53, 3
    s_cselect_b32 s73, s73, s71
    s_cselect_b32 m0, 151552, s76
    s_nop 0
    buffer_load_dwordx4 v14, s[40:43], s73 offen lds
    s_add_u32 m0, s70, 92160
    s_nop 0
    buffer_load_dwordx4 v4, s[24:27], s72 offen lds
    s_add_u32 m0, s70, 93184
    s_nop 0
    buffer_load_dwordx4 v5, s[24:27], s72 offen lds
    s_add_u32 s71, s71, 122880
    s_cmp_eq_u32 s71, 2457600
    s_cselect_b32 s71, 0, s71
    buffer_load_dword v26, off, s[44:47], s97 sc1
    s_waitcnt vmcnt(13)
    s_barrier
    s_add_u32 m0, s60, 30720
    s_nop 0
    buffer_load_dwordx4 v11, s[28:31], s71 offen lds
    s_add_u32 m0, s60, 34816
    s_nop 0
    buffer_load_dwordx4 v12, s[28:31], s71 offen lds
    s_add_u32 m0, s60, 38912
    s_nop 0
    buffer_load_dwordx4 v13, s[28:31], s71 offen lds
    s_add_u32 s73, s72, 10240
    s_add_u32 s76, s60, 43008
    s_cmp_eq_u32 s53, 3
    s_cselect_b32 s73, s73, s71
    s_cselect_b32 m0, 152576, s76
    s_nop 0
    buffer_load_dwordx4 v14, s[40:43], s73 offen lds
    s_add_u32 m0, s70, 94208
    s_nop 0
    buffer_load_dwordx4 v6, s[24:27], s72 offen lds
    s_add_u32 m0, s70, 95232
    s_nop 0
    buffer_load_dwordx4 v7, s[24:27], s72 offen lds
    s_add_u32 s71, s71, 122880
    s_cmp_eq_u32 s71, 2457600
    s_cselect_b32 s71, 0, s71
    s_waitcnt vmcnt(13)
    s_barrier
    s_add_u32 m0, s60, 46080
    s_nop 0
    buffer_load_dwordx4 v11, s[28:31], s71 offen lds
    s_add_u32 m0, s60, 50176
    s_nop 0
    buffer_load_dwordx4 v12, s[28:31], s71 offen lds
    s_add_u32 m0, s60, 54272
    s_nop 0
    buffer_load_dwordx4 v13, s[28:31], s71 offen lds
    s_add_u32 s72, s72, 128
    s_cmp_eq_u32 s72, 1280
    s_cselect_b32 s72, 0, s72
    s_add_u32 s73, s72, 0
    s_add_u32 s76, s60, 58368
    s_cmp_eq_u32 s53, 3
    s_cselect_b32 s73, s73, s71
    s_cselect_b32 m0, 153600, s76
    s_nop 0
    buffer_load_dwordx4 v14, s[40:43], s73 offen lds
    s_add_u32 m0, s70, 108544
    s_nop 0
    buffer_load_dwordx4 v4, s[24:27], s72 offen lds
    s_add_u32 m0, s70, 109568
    s_nop 0
    buffer_load_dwordx4 v5, s[24:27], s72 offen lds
    s_add_u32 s71, s71, 122880
    s_cmp_eq_u32 s71, 2457600
    s_cselect_b32 s71, 0, s71
    s_waitcnt vmcnt(13)
    s_barrier
    s_add_u32 m0, s60, 61440
    s_nop 0
    buffer_load_dwordx4 v11, s[28:31], s71 offen lds
    s_add_u32 m0, s60, 65536
    s_nop 0
    buffer_load_dwordx4 v12, s[28:31], s71 offen lds
    s_add_u32 m0, s60, 69632
    s_nop 0
    buffer_load_dwordx4 v13, s[28:31], s71 offen lds
    s_add_u32 s73, s72, 10240
    s_add_u32 s76, s60, 73728
    s_cmp_eq_u32 s53, 3
    s_cselect_b32 s73, s73, s71
    s_cselect_b32 m0, 154624, s76
    s_nop 0
    buffer_load_dwordx4 v14, s[40:43], s73 offen lds
    s_add_u32 m0, s70, 110592
    s_nop 0
    buffer_load_dwordx4 v6, s[24:27], s72 offen lds
    s_add_u32 m0, s70, 111616
    s_nop 0
    buffer_load_dwordx4 v7, s[24:27], s72 offen lds
    s_add_u32 s71, s71, 122880
    s_cmp_eq_u32 s71, 2457600
    s_cselect_b32 s71, 0, s71
    s_waitcnt vmcnt(12)
    s_barrier
    s_add_u32 m0, s60, 76800
    s_nop 0
    buffer_load_dwordx4 v11, s[28:31], s71 offen lds
    s_add_u32 m0, s60, 80896
    s_nop 0
    buffer_load_dwordx4 v12, s[28:31], s71 offen lds
    s_add_u32 m0, s60, 84992
    s_nop 0
    buffer_load_dwordx4 v13, s[28:31], s71 offen lds
    s_add_u32 s72, s72, 128
    s_cmp_eq_u32 s72, 1280
    s_cselect_b32 s72, 0, s72
    s_add_u32 s73, s72, 0
    s_add_u32 s76, s60, 89088
    s_cmp_eq_u32 s53, 3
    s_cselect_b32 s73, s73, s71
    s_cselect_b32 m0, 149504, s76
    s_nop 0
    buffer_load_dwordx4 v14, s[40:43], s73 offen lds
    s_add_u32 m0, s70, 133120
    s_nop 0
    buffer_load_dwordx4 v4, s[24:27], s72 offen lds
    s_add_u32 m0, s70, 134144
    s_nop 0
    buffer_load_dwordx4 v5, s[24:27], s72 offen lds
    s_add_u32 s71, s71, 122880
    s_cmp_eq_u32 s71, 2457600
    s_cselect_b32 s71, 0, s71
    s_waitcnt vmcnt(12)
    s_barrier
    s_add_u32 m0, s60, 0
    s_nop 0
    buffer_load_dwordx4 v11, s[28:31], s71 offen lds
    s_add_u32 m0, s60, 4096
    s_nop 0
    buffer_load_dwordx4 v12, s[28:31], s71 offen lds
    s_add_u32 m0, s60, 8192
    s_nop 0
    buffer_load_dwordx4 v13, s[28:31], s71 offen lds
    s_add_u32 s73, s72, 10240
    s_add_u32 s76, s60, 12288
    s_cmp_eq_u32 s53, 3
    s_cselect_b32 s73, s73, s71
    s_cselect_b32 m0, 150528, s76
    s_nop 0
    buffer_load_dwordx4 v14, s[40:43], s73 offen lds
    s_add_u32 m0, s70, 135168
    s_nop 0
    buffer_load_dwordx4 v6, s[24:27], s72 offen lds
    s_add_u32 m0, s70, 136192
    s_nop 0
    buffer_load_dwordx4 v7, s[24:27], s72 offen lds
    s_add_u32 s71, s71, 122880
    s_cmp_eq_u32 s71, 2457600
    s_cselect_b32 s71, 0, s71
    s_waitcnt vmcnt(12)
    s_barrier
    s_add_u32 m0, s60, 15360
    s_nop 0
    buffer_load_dwordx4 v11, s[28:31], s71 offen lds
    s_add_u32 m0, s60, 19456
    s_nop 0
    buffer_load_dwordx4 v12, s[28:31], s71 offen lds
    s_add_u32 m0, s60, 23552
    s_nop 0
    buffer_load_dwordx4 v13, s[28:31], s71 offen lds
    s_add_u32 s72, s72, 128
    s_cmp_eq_u32 s72, 1280
    s_cselect_b32 s72, 0, s72
    s_add_u32 s73, s72, 0
    s_add_u32 s76, s60, 27648
    s_cmp_eq_u32 s53, 3
    s_cselect_b32 s73, s73, s71
    s_cselect_b32 m0, 151552, s76
    s_nop 0
    buffer_load_dwordx4 v14, s[40:43], s73 offen lds
    s_add_u32 s71, s71, 122880
    s_cmp_eq_u32 s71, 2457600
    s_cselect_b32 s71, 0, s71
    v_mov_b32 v27, 158720
    v_mov_b32 v28, v26
    v_mov_b32 v29, 0
    v_mov_b32 v30, 0
    v_mov_b32 v31, 0
    ds_write_b128 v27, v[28:31]
    s_waitcnt lgkmcnt(0)
    s_and_b32 s76, s54, 3
    s_lshl_b32 s77, s55, 2
    s_add_u32 s76, s76, s77
    s_mul_i32 s76, s76, 25600
    s_mul_i32 s77, s53, 6400
    s_add_u32 s81, s76, s77
    v_min_u32 v10, 49, v0
    v_lshlrev_b32 v10, 7, v10
    buffer_load_dword v10, v10, s[32:35], s81 offen
    s_waitcnt vmcnt(11)
    s_barrier
    v_min_u32 v9, 39, v0
    v_mul_u32_u24 v1, 6554, v9
    v_lshrrev_b32 v1, 16, v1
    v_lshlrev_b32 v9, 7, v9
    v_mul_u32_u24 v2, 1280, v1
    v_add_u32 v9, v9, v2
    v_lshrrev_b32 v1, 1, v1
    v_mul_u32_u24 v1, 35840, v1
    s_mul_i32 s76, s55, 5120
    s_add_u32 s76, s76, s92
    v_add_u32 v9, v9, v1
    buffer_load_dword v9, v9, s[48:51], s76 offen sc1
    s_waitcnt vmcnt(2)
    s_barrier
    s_setprio 0
    s_add_u32 s76, s21, 0
    s_add_u32 m0, s20, 92160
    s_nop 0
    buffer_load_dwordx4 v16, s[32:35], s76 offen lds
    s_add_u32 m0, s20, 93184
    s_nop 0
    buffer_load_dwordx4 v17, s[32:35], s76 offen lds
    s_add_u32 m0, s20, 94208
    s_nop 0
    buffer_load_dwordx4 v18, s[32:35], s76 offen lds
    s_add_u32 m0, s20, 95232
    s_nop 0
    buffer_load_dwordx4 v19, s[32:35], s76 offen lds
    s_add_u32 m0, s20, 96256
    s_nop 0
    buffer_load_dwordx4 v20, s[32:35], s76 offen lds
    s_add_u32 s76, s21, 204800
    s_add_u32 m0, s20, 112640
    s_nop 0
    buffer_load_dwordx4 v16, s[32:35], s76 offen lds
    s_add_u32 m0, s20, 113664
    s_nop 0
    buffer_load_dwordx4 v17, s[32:35], s76 offen lds
    s_add_u32 m0, s20, 114688
    s_nop 0
    buffer_load_dwordx4 v18, s[32:35], s76 offen lds
    s_add_u32 m0, s20, 115712
    s_nop 0
    buffer_load_dwordx4 v19, s[32:35], s76 offen lds
    s_add_u32 m0, s20, 116736
    s_nop 0
    buffer_load_dwordx4 v20, s[32:35], s76 offen lds
    s_waitcnt vmcnt(10)
    v_mov_b32 v28, 1
    s_mov_b64 exec, 1
    ds_add_u32 v27, v28 offset:8
    s_mov_b64 exec, -1
LB_c1:
    ds_read_b32 v1, v27 offset:4
    s_waitcnt lgkmcnt(0)
    v_readfirstlane_b32 s76, v1
    s_nop 0
    s_cmp_lt_u32 s76, 4
    s_cbranch_scc1 LB_c1
    s_add_u32 s76, s21, 409600
    s_add_u32 m0, s20, 133120
    s_nop 0
    buffer_load_dwordx4 v16, s[32:35], s76 offen lds
    s_add_u32 m0, s20, 134144
    s_nop 0
    buffer_load_dwordx4 v17, s[32:35], s76 offen lds
    s_add_u32 m0, s20, 135168
    s_nop 0
    buffer_load_dwordx4 v18, s[32:35], s76 offen lds
    s_add_u32 m0, s20, 136192
    s_nop 0
    buffer_load_dwordx4 v19, s[32:35], s76 offen lds
    s_add_u32 m0, s20, 137216
    s_nop 0
    buffer_load_dwordx4 v20, s[32:35], s76 offen lds
    s_add_u32 s76, s21, 614400
    s_add_u32 m0, s20, 61440
    s_nop 0
    buffer_load_dwordx4 v16, s[32:35], s76 offen lds
    s_add_u32 m0, s20, 62464
    s_nop 0
    buffer_load_dwordx4 v17, s[32:35], s76 offen lds
    s_add_u32 m0, s20, 63488
    s_nop 0
    buffer_load_dwordx4 v18, s[32:35], s76 offen lds
    s_add_u32 m0, s20, 64512
    s_nop 0
    buffer_load_dwordx4 v19, s[32:35], s76 offen lds
    s_add_u32 m0, s20, 65536
    s_nop 0
    buffer_load_dwordx4 v20, s[32:35], s76 offen lds
    s_mov_b32 s76, s22
    s_add_u32 m0, s20, 0
    s_nop 0
    buffer_load_dwordx4 v21, s[32:35], s76 offen lds
    s_add_u32 m0, s20, 1024
    s_nop 0
    buffer_load_dwordx4 v22, s[32:35], s76 offen lds
    s_add_u32 m0, s20, 2048
    s_nop 0
    buffer_load_dwordx4 v23, s[32:35], s76 offen lds
    s_add_u32 m0, s20, 3072
    s_nop 0
    buffer_load_dwordx4 v24, s[32:35], s76 offen lds
    s_add_u32 m0, s20, 4096
    s_nop 0
    buffer_load_dwordx4 v25, s[32:35], s76 offen lds
    s_mov_b32 s13, 1
    s_branch LP2
L_BC:
    s_waitcnt lgkmcnt(0)
    s_mov_b32 s60, 0xffff
    s_mov_b32 s61, 0x0
    s_mov_b32 s62, 0xffff0000
    s_mov_b32 s63, 0x0
    s_mov_b32 s64, 0x0
    s_mov_b32 s65, 0xffff
    s_mov_b32 s66, 0x0
    s_mov_b32 s67, 0xffff0000
    s_mov_b32 s32, s14
    s_mov_b32 s33, s15
    s_mov_b32 s34, 819200
    s_mov_b32 s35, 0x20000
    s_mov_b32 s48, s16
    s_mov_b32 s49, s17
    s_mov_b32 s50, 5242880
    s_mov_b32 s51, 0x20000
    s_mov_b32 s44, s18
    s_mov_b32 s45, s19
    s_mov_b32 s46, 256
    s_mov_b32 s47, 0x20000
    s_mov_b32 s36, s20
    s_mov_b32 s37, s21
    s_mov_b32 s38, 8388608
    s_mov_b32 s39, 0x20000
    s_mov_b32 s23, 40960
    s_mul_i32 s20, s53, 5120
    s_mul_i32 s21, s53, 51200
    s_mul_i32 s22, s53, 204800
    s_getreg_b32 s76, hwreg(HW_REG_XCC_ID, 0, 3)
    s_lshl_b32 s76, s76, 2
    s_lshl_b32 s99, 1, s76
    s_lshl_b32 s98, 8, s76
    s_lshr_b32 s93, s55, 2
    s_xor_b32 s93, s93, 0
    s_lshl_b32 s92, s54, 3
    s_lshl_b32 s76, s53, 1
    s_add_u32 s92, s92, s76
    s_mul_i32 s92, s92, 40960
    s_add_u32 s92, s92, 1280
    s_lshl_b32 s97, s54, 2
    s_add_u32 s19, s97, s53
    s_lshl_b32 s19, s19, 7
    s_add_u32 s19, s19, 6823936
    s_add_u32 s97, s97, 96
    s_mov_b32 s76, 133120
    s_mov_b32 s77, 61440
    s_cmp_eq_u32 s93, 0
    s_cselect_b32 s78, 92160, s76
    s_cselect_b32 s79, 112640, s77
    s_add_u32 s76, s55, 0
    s_and_b32 s76, s76, 3
    s_lshl_b32 s77, s93, 2
    s_add_u32 s77, s77, s76
    s_mul_i32 s82, s77, 5120
    s_cmp_ge_u32 s76, 2
    s_cselect_b32 s77, s79, s78
    s_and_b32 s76, s76, 1
    s_mul_i32 s76, s76, 10240
    s_add_u32 s87, s77, s76
    s_add_u32 s76, s55, 1
    s_and_b32 s76, s76, 3
    s_lshl_b32 s77, s93, 2
    s_add_u32 s77, s77, s76
    s_mul_i32 s83, s77, 5120
    s_cmp_ge_u32 s76, 2
    s_cselect_b32 s77, s79, s78
    s_and_b32 s76, s76, 1
    s_mul_i32 s76, s76, 10240
    s_add_u32 s88, s77, s76
    s_add_u32 s76, s55, 2
    s_and_b32 s76, s76, 3
    s_lshl_b32 s77, s93, 2
    s_add_u32 s77, s77, s76
    s_mul_i32 s84, s77, 5120
    s_cmp_ge_u32 s76, 2
    s_cselect_b32 s77, s79, s78
    s_and_b32 s76, s76, 1
    s_mul_i32 s76, s76, 10240
    s_add_u32 s89, s77, s76
    s_add_u32 s76, s55, 3
    s_and_b32 s76, s76, 3
    s_lshl_b32 s77, s93, 2
    s_add_u32 s77, s77, s76
    s_mul_i32 s85, s77, 5120
    s_cmp_ge_u32 s76, 2
    s_cselect_b32 s77, s79, s78
    s_and_b32 s76, s76, 1
    s_mul_i32 s76, s76, 10240
    s_add_u32 s90, s77, s76
    s_mul_i32 s76, s93, 10240
    s_add_u32 s91, s76, 0
    s_mul_i32 s86, s93, 20480
    s_xor_b32 s79, s52, 4
    s_mul_i32 s94, s52, 5120
    s_mov_b32 s78, 30720
    s_cmp_ge_u32 s52, 6
    s_cselect_b32 s78, 51200, s78
    s_add_u32 s94, s94, s78
    s_mul_i32 s95, s79, 5120
    s_mov_b32 s78, 30720
    s_cmp_ge_u32 s79, 6
    s_cselect_b32 s78, 51200, s78
    s_add_u32 s95, s95, s78
    s_lshl_b32 s76, s54, 7
    s_lshl_b32 s78, s53, 5
    s_add_u32 s76, s76, s78
    s_add_u32 s76, s76, 16
    s_mul_i32 s76, s76, 2560
    s_mul_i32 s78, s55, 160
    s_add_u32 s76, s76, s78
    s_add_u32 s96, s76, 1280
    s_lshl_b32 s78, s53, 12
    s_add_u32 s78, s78, 92160
    v_and_b32 v1, 15, v0
    v_lshrrev_b32 v2, 4, v0
    v_and_b32 v3, 7, v0
    v_xor_b32 v2, v2, v3
    v_lshlrev_b32 v1, 7, v1
    v_lshl_add_u32 v1, v2, 4, v1
    v_add_u32 v4, s78, v1
    v_xor_b32 v5, 64, v4
    v_and_b32 v1, 15, v0
    v_lshrrev_b32 v2, 4, v0
    v_and_b32 v3, 7, v0
    v_xor_b32 v2, v2, v3
    v_lshlrev_b32 v1, 7, v1
    v_lshl_add_u32 v1, v2, 4, v1
    v_add_u32 v6, 149504, v1
    v_xor_b32 v7, 64, v6
    v_lshrrev_b32 v1, 2, v0
    v_mul_u32_u24 v1, 160, v1
    v_and_b32 v2, 3, v0
    v_lshl_add_u32 v8, v2, 3, v1
    v_mul_u32_u24 v2, 40, v2
    v_add3_u32 v10, v1, v2, 32
    v_add_u32 v9, 61440, v8
    v_add_u32 v11, 61440, v10
    s_mul_i32 s76, s53, 40
    v_add_u32 v12, s76, v8
    v_add_u32 v13, s76, v9
    v_and_b32 v1, 15, v0
    v_lshrrev_b32 v2, 4, v0
    v_lshlrev_b32 v2, 2, v2
    v_and_b32 v3, 1, v0
    v_mov_b32 v20, 0xfe967699
    s_lshl_b32 s76, s54, 2
    s_add_u32 s76, s76, s53
    s_cmp_eq_u32 s76, 0
    s_cselect_b64 s[80:81], 0, -1
    v_add_u32 v21, 0, v2
    v_cmp_eq_u32 s[76:77], 0, v3
    v_cmp_le_u32 vcc, v21, v1
    s_nop 0
    s_and_b64 s[78:79], s[76:77], vcc
    s_andn2_b64 s[76:77], s[76:77], vcc
    v_cndmask_b32 v24, v20, 0, s[78:79]
    v_cndmask_b32 v28, v20, 0, s[76:77]
    s_and_b64 s[76:77], s[76:77], s[80:81]
    v_cndmask_b32 v32, v20, 0, s[76:77]
    v_add_u32 v21, 1, v2
    v_cmp_eq_u32 s[76:77], 1, v3
    v_cmp_le_u32 vcc, v21, v1
    s_nop 0
    s_and_b64 s[78:79], s[76:77], vcc
    s_andn2_b64 s[76:77], s[76:77], vcc
    v_cndmask_b32 v25, v20, 0, s[78:79]
    v_cndmask_b32 v29, v20, 0, s[76:77]
    s_and_b64 s[76:77], s[76:77], s[80:81]
    v_cndmask_b32 v33, v20, 0, s[76:77]
    v_add_u32 v21, 2, v2
    v_cmp_eq_u32 s[76:77], 0, v3
    v_cmp_le_u32 vcc, v21, v1
    s_nop 0
    s_and_b64 s[78:79], s[76:77], vcc
    s_andn2_b64 s[76:77], s[76:77], vcc
    v_cndmask_b32 v26, v20, 0, s[78:79]
    v_cndmask_b32 v30, v20, 0, s[76:77]
    s_and_b64 s[76:77], s[76:77], s[80:81]
    v_cndmask_b32 v34, v20, 0, s[76:77]
    v_add_u32 v21, 3, v2
    v_cmp_eq_u32 s[76:77], 1, v3
    v_cmp_le_u32 vcc, v21, v1
    s_nop 0
    s_and_b64 s[78:79], s[76:77], vcc
    s_andn2_b64 s[76:77], s[76:77], vcc
    v_cndmask_b32 v27, v20, 0, s[78:79]
    v_cndmask_b32 v31, v20, 0, s[76:77]
    s_and_b64 s[76:77], s[76:77], s[80:81]
    v_cndmask_b32 v35, v20, 0, s[76:77]
    v_mov_b32 v21, 0xc0c0100
    v_mov_b32 v22, 0x1000c0c
    v_cmp_eq_u32 vcc, 1, v3
    s_nop 1
    v_cndmask_b32 v21, v21, v22, vcc
    v_add3_u32 v22, v2, v3, 0
    v_cmp_le_u32 vcc, v22, v1
    v_mov_b32 v22, 0x0c0c0c0c
    s_nop 0
    v_cndmask_b32 v38, v22, v21, vcc
    v_cndmask_b32 v36, v21, v22, vcc
    v_mov_b32 v21, 0xc0c0302
    v_mov_b32 v22, 0x3020c0c
    v_cmp_eq_u32 vcc, 1, v3
    s_nop 1
    v_cndmask_b32 v21, v21, v22, vcc
    v_add3_u32 v22, v2, v3, 2
    v_cmp_le_u32 vcc, v22, v1
    v_mov_b32 v22, 0x0c0c0c0c
    s_nop 0
    v_cndmask_b32 v39, v22, v21, vcc
    v_cndmask_b32 v37, v21, v22, vcc
    s_mul_i32 s76, s53, 5120
    s_add_u32 s76, s76, 30720
    v_lshlrev_b32 v1, 3, v0
    v_add_u32 v17, s76, v1
    v_add_u32 v14, 5120, v17
    s_lshl_b32 s76, s53, 9
    s_add_u32 s76, s76, 30720
    v_add_u32 v15, s76, v1
    v_add_u32 v16, 30720, v1
    s_mul_i32 s77, s55, 5120
    s_add_u32 s77, s77, s92
    v_lshlrev_b32 v1, 4, v0
    v_add_u32 v18, s77, v1
    s_add_u32 s77, s77, 1024
    v_lshrrev_b32 v1, 5, v0
    v_mul_u32_u24 v1, 2304, v1
    v_lshl_add_u32 v1, v0, 3, v1
    v_add_u32 v19, s77, v1
    s_mov_b32 s70, 0x3ea52b5c
    v_mov_b32 v22, 158720
    s_barrier
    ds_read_b128 a[24:27], v4 offset:40960
    ds_read_b128 a[28:31], v4 offset:43008
    ds_read_b128 a[56:59], v6 offset:0
    ds_read_b128 a[32:35], v5 offset:40960
    ds_read_b128 a[36:39], v5 offset:43008
    ds_read_b128 a[60:63], v7 offset:0
    ds_read_b64_tr_b16 a[0:1], v8 offset:0
    ds_read_b64_tr_b16 a[2:3], v8 offset:2560
    ds_read_b64_tr_b16 a[4:5], v8 offset:40
    ds_read_b64_tr_b16 a[6:7], v8 offset:2600
    ds_read_b64_tr_b16 a[8:9], v8 offset:80
    ds_read_b64_tr_b16 a[10:11], v8 offset:2640
    ds_read_b64_tr_b16 a[12:13], v8 offset:120
    ds_read_b64_tr_b16 a[14:15], v8 offset:2680
    ds_read_b64_tr_b16 a[16:17], v10 offset:0
    ds_read_b64_tr_b16 a[18:19], v10 offset:2560
    s_waitcnt lgkmcnt(6)
    v_mfma_f32_16x16x32_bf16 v[80:83], a[0:3], a[24:27], 0
    ds_read_b64_tr_b16 a[20:21], v8 offset:10240
    v_mfma_f32_16x16x32_bf16 v[100:103], a[0:3], a[28:31], 0
    ds_read_b64_tr_b16 a[22:23], v8 offset:12800
    v_mfma_f32_16x16x32_bf16 v[84:87], a[4:7], a[24:27], 0
    ds_read_b64_tr_b16 a[0:1], v8 offset:10280
    v_mfma_f32_16x16x32_bf16 v[104:107], a[4:7], a[28:31], 0
    ds_read_b64_tr_b16 a[2:3], v8 offset:12840
    s_waitcnt lgkmcnt(6)
    v_mfma_f32_16x16x32_bf16 v[88:91], a[8:11], a[24:27], 0
    ds_read_b64_tr_b16 a[4:5], v8 offset:10320
    v_mfma_f32_16x16x32_bf16 v[108:111], a[8:11], a[28:31], 0
    ds_read_b64_tr_b16 a[6:7], v8 offset:12880
    v_mfma_f32_16x16x32_bf16 v[92:95], a[12:15], a[24:27], 0
    ds_read_b64_tr_b16 a[8:9], v8 offset:10360
    v_mfma_f32_16x16x32_bf16 v[112:115], a[12:15], a[28:31], 0
    ds_read_b64_tr_b16 a[10:11], v8 offset:12920
    s_waitcnt lgkmcnt(6)
    v_mfma_f32_16x16x32_bf16 v[96:99], a[16:19], a[24:27], 0
    ds_read_b64_tr_b16 a[12:13], v12 offset:10240
    v_mfma_f32_16x16x32_bf16 v[116:119], a[16:19], a[28:31], 0
    ds_read_b64_tr_b16 a[14:15], v12 offset:12800
    v_mfma_f32_16x16x32_bf16 v[120:123], a[24:27], a[20:23], 0
    ds_read_b64_tr_b16 a[16:17], v10 offset:10240
    v_mfma_f32_16x16x32_bf16 v[124:127], a[28:31], a[20:23], 0
    ds_read_b64_tr_b16 a[18:19], v10 offset:12800
    s_waitcnt lgkmcnt(6)
    v_mfma_f32_16x16x32_bf16 v[128:131], a[24:27], a[0:3], 0
    ds_read_b64_tr_b16 a[20:21], v8 offset:5120
    v_mfma_f32_16x16x32_bf16 v[132:135], a[28:31], a[0:3], 0
    ds_read_b64_tr_b16 a[22:23], v8 offset:7680
    v_mfma_f32_16x16x32_bf16 v[136:139], a[24:27], a[4:7], 0
    ds_read_b64_tr_b16 a[0:1], v8 offset:5160
    v_mfma_f32_16x16x32_bf16 v[140:143], a[28:31], a[4:7], 0
    ds_read_b64_tr_b16 a[2:3], v8 offset:7720
    s_waitcnt lgkmcnt(6)
    v_mfma_f32_16x16x32_bf16 v[144:147], a[24:27], a[8:11], 0
    ds_read_b64_tr_b16 a[4:5], v8 offset:5200
    v_mfma_f32_16x16x32_bf16 v[148:151], a[28:31], a[8:11], 0
    ds_read_b64_tr_b16 a[6:7], v8 offset:7760
    v_mfma_f32_16x16x32_bf16 v[168:171], a[56:59], a[12:15], 0
    ds_read_b64_tr_b16 a[8:9], v8 offset:5240
    ds_read_b64_tr_b16 a[10:11], v8 offset:7800
    s_waitcnt lgkmcnt(6)
    v_mfma_f32_16x16x32_bf16 v[152:155], a[24:27], a[16:19], 0
    ds_read_b64_tr_b16 a[12:13], v12 offset:5120
    v_mfma_f32_16x16x32_bf16 v[156:159], a[28:31], a[16:19], 0
    ds_read_b64_tr_b16 a[14:15], v12 offset:7680
    v_mfma_f32_16x16x32_bf16 v[172:175], a[56:59], a[16:19], 0
    v_mfma_f32_16x16x32_bf16 v[40:43], a[20:23], a[24:27], 0
    ds_read_b64_tr_b16 a[16:17], v10 offset:5120
    v_mfma_f32_16x16x32_bf16 v[60:63], a[20:23], a[28:31], 0
    ds_read_b64_tr_b16 a[18:19], v10 offset:7680
    s_barrier
    s_waitcnt lgkmcnt(6)
    v_mfma_f32_16x16x32_bf16 v[44:47], a[0:3], a[24:27], 0
    ds_read_b64_tr_b16 a[20:21], v8 offset:15360
    v_mfma_f32_16x16x32_bf16 v[64:67], a[0:3], a[28:31], 0
    ds_read_b64_tr_b16 a[22:23], v8 offset:17920
    v_mfma_f32_16x16x32_bf16 v[48:51], a[4:7], a[24:27], 0
    ds_read_b64_tr_b16 a[0:1], v8 offset:15400
    v_mfma_f32_16x16x32_bf16 v[68:71], a[4:7], a[28:31], 0
    ds_read_b64_tr_b16 a[2:3], v8 offset:17960
    s_waitcnt lgkmcnt(6)
    v_mfma_f32_16x16x32_bf16 v[52:55], a[8:11], a[24:27], 0
    ds_read_b64_tr_b16 a[4:5], v8 offset:15440
    v_mfma_f32_16x16x32_bf16 v[72:75], a[8:11], a[28:31], 0
    ds_read_b64_tr_b16 a[6:7], v8 offset:18000
    v_mfma_f32_16x16x32_bf16 v[160:163], a[12:15], a[56:59], 0
    ds_read_b64_tr_b16 a[8:9], v8 offset:15480
    ds_read_b64_tr_b16 a[10:11], v8 offset:18040
    s_waitcnt lgkmcnt(6)
    v_mfma_f32_16x16x32_bf16 v[56:59], a[16:19], a[24:27], 0
    ds_read_b64_tr_b16 a[12:13], v10 offset:15360
    v_mfma_f32_16x16x32_bf16 v[76:79], a[16:19], a[28:31], 0
    ds_read_b64_tr_b16 a[14:15], v10 offset:17920
    v_mfma_f32_16x16x32_bf16 v[164:167], a[16:19], a[56:59], 0
    v_mfma_f32_16x16x32_bf16 v[80:83], a[20:23], a[32:35], v[80:83]
    ds_read_b64_tr_b16 a[16:17], v8 offset:25600
    v_mfma_f32_16x16x32_bf16 v[100:103], a[20:23], a[36:39], v[100:103]
    ds_read_b64_tr_b16 a[18:19], v8 offset:28160
    s_waitcnt lgkmcnt(6)
    v_mfma_f32_16x16x32_bf16 v[84:87], a[0:3], a[32:35], v[84:87]
    ds_read_b64_tr_b16 a[20:21], v8 offset:25640
    v_mfma_f32_16x16x32_bf16 v[104:107], a[0:3], a[36:39], v[104:107]
    ds_read_b64_tr_b16 a[22:23], v8 offset:28200
    v_mfma_f32_16x16x32_bf16 v[88:91], a[4:7], a[32:35], v[88:91]
    ds_read_b64_tr_b16 a[0:1], v8 offset:25680
    v_mfma_f32_16x16x32_bf16 v[108:111], a[4:7], a[36:39], v[108:111]
    ds_read_b64_tr_b16 a[2:3], v8 offset:28240
    s_waitcnt lgkmcnt(6)
    v_mfma_f32_16x16x32_bf16 v[92:95], a[8:11], a[32:35], v[92:95]
    ds_read_b64_tr_b16 a[4:5], v8 offset:25720
    v_mfma_f32_16x16x32_bf16 v[112:115], a[8:11], a[36:39], v[112:115]
    ds_read_b64_tr_b16 a[6:7], v8 offset:28280
    v_mfma_f32_16x16x32_bf16 v[96:99], a[12:15], a[32:35], v[96:99]
    ds_read_b64_tr_b16 a[8:9], v12 offset:25600
    v_mfma_f32_16x16x32_bf16 v[116:119], a[12:15], a[36:39], v[116:119]
    ds_read_b64_tr_b16 a[10:11], v12 offset:28160
    s_waitcnt lgkmcnt(6)
    v_mfma_f32_16x16x32_bf16 v[120:123], a[32:35], a[16:19], v[120:123]
    ds_read_b64_tr_b16 a[12:13], v10 offset:25600
    v_mfma_f32_16x16x32_bf16 v[124:127], a[36:39], a[16:19], v[124:127]
    ds_read_b64_tr_b16 a[14:15], v10 offset:28160
    v_mfma_f32_16x16x32_bf16 v[128:131], a[32:35], a[20:23], v[128:131]
    ds_read_b64_tr_b16 a[16:17], v8 offset:20480
    v_mfma_f32_16x16x32_bf16 v[132:135], a[36:39], a[20:23], v[132:135]
    ds_read_b64_tr_b16 a[18:19], v8 offset:23040
    s_waitcnt lgkmcnt(6)
    v_mfma_f32_16x16x32_bf16 v[136:139], a[32:35], a[0:3], v[136:139]
    ds_read_b64_tr_b16 a[20:21], v8 offset:20520
    v_mfma_f32_16x16x32_bf16 v[140:143], a[36:39], a[0:3], v[140:143]
    ds_read_b64_tr_b16 a[22:23], v8 offset:23080
    v_mfma_f32_16x16x32_bf16 v[144:147], a[32:35], a[4:7], v[144:147]
    ds_read_b64_tr_b16 a[0:1], v8 offset:20560
    v_mfma_f32_16x16x32_bf16 v[148:151], a[36:39], a[4:7], v[148:151]
    ds_read_b64_tr_b16 a[2:3], v8 offset:23120
    s_waitcnt lgkmcnt(6)
    v_mfma_f32_16x16x32_bf16 v[168:171], a[60:63], a[8:11], v[168:171]
    ds_read_b64_tr_b16 a[4:5], v8 offset:20600
    ds_read_b64_tr_b16 a[6:7], v8 offset:23160
    v_mfma_f32_16x16x32_bf16 v[152:155], a[32:35], a[12:15], v[152:155]
    ds_read_b64_tr_b16 a[8:9], v12 offset:20480
    v_mfma_f32_16x16x32_bf16 v[156:159], a[36:39], a[12:15], v[156:159]
    ds_read_b64_tr_b16 a[10:11], v12 offset:23040
    v_mfma_f32_16x16x32_bf16 v[172:175], a[60:63], a[12:15], v[172:175]
    s_waitcnt lgkmcnt(6)
    v_mfma_f32_16x16x32_bf16 v[40:43], a[16:19], a[32:35], v[40:43]
    ds_read_b64_tr_b16 a[12:13], v10 offset:20480
    v_mfma_f32_16x16x32_bf16 v[60:63], a[16:19], a[36:39], v[60:63]
    ds_read_b64_tr_b16 a[14:15], v10 offset:23040
    s_barrier
    v_mfma_f32_16x16x32_bf16 v[44:47], a[20:23], a[32:35], v[44:47]
    ds_read_b64_tr_b16 a[16:17], v8 offset:30720
    ds_read_b128 a[40:43], v4 offset:0
    v_mfma_f32_16x16x32_bf16 v[64:67], a[20:23], a[36:39], v[64:67]
    ds_read_b64_tr_b16 a[18:19], v8 offset:33280
    ds_read_b128 a[44:47], v4 offset:2048
    s_waitcnt lgkmcnt(8)
    v_mfma_f32_16x16x32_bf16 v[48:51], a[0:3], a[32:35], v[48:51]
    ds_read_b64_tr_b16 a[20:21], v8 offset:30760
    ds_read_b128 a[64:67], v6 offset:2048
    v_mfma_f32_16x16x32_bf16 v[68:71], a[0:3], a[36:39], v[68:71]
    ds_read_b64_tr_b16 a[22:23], v8 offset:33320
    ds_read_b128 a[48:51], v5 offset:0
    v_mfma_f32_16x16x32_bf16 v[52:55], a[4:7], a[32:35], v[52:55]
    ds_read_b64_tr_b16 a[0:1], v8 offset:30800
    ds_read_b128 a[52:55], v5 offset:2048
    v_mfma_f32_16x16x32_bf16 v[72:75], a[4:7], a[36:39], v[72:75]
    ds_read_b64_tr_b16 a[2:3], v8 offset:33360
    ds_read_b128 a[68:71], v7 offset:2048
    s_waitcnt lgkmcnt(12)
    v_mfma_f32_16x16x32_bf16 v[160:163], a[8:11], a[60:63], v[160:163]
    ds_read_b64_tr_b16 a[4:5], v8 offset:30840
    ds_read_b64_tr_b16 a[6:7], v8 offset:33400
    v_mfma_f32_16x16x32_bf16 v[56:59], a[12:15], a[32:35], v[56:59]
    ds_read_b64_tr_b16 a[8:9], v10 offset:30720
    v_mfma_f32_16x16x32_bf16 v[76:79], a[12:15], a[36:39], v[76:79]
    ds_read_b64_tr_b16 a[10:11], v10 offset:33280
    v_mfma_f32_16x16x32_bf16 v[164:167], a[12:15], a[60:63], v[164:167]
    s_waitcnt lgkmcnt(4)
    v_mfma_f32_16x16x32_bf16 v[80:83], a[16:19], a[40:43], v[80:83]
    ds_read_b64_tr_b16 a[12:13], v8 offset:40960
    v_mfma_f32_16x16x32_bf16 v[100:103], a[16:19], a[44:47], v[100:103]
    ds_read_b64_tr_b16 a[14:15], v8 offset:43520
    v_mfma_f32_16x16x32_bf16 v[84:87], a[20:23], a[40:43], v[84:87]
    ds_read_b64_tr_b16 a[16:17], v8 offset:41000
    v_mfma_f32_16x16x32_bf16 v[104:107], a[20:23], a[44:47], v[104:107]
    ds_read_b64_tr_b16 a[18:19], v8 offset:43560
    s_waitcnt lgkmcnt(6)
    v_mfma_f32_16x16x32_bf16 v[88:91], a[0:3], a[40:43], v[88:91]
    ds_read_b64_tr_b16 a[20:21], v8 offset:41040
    v_mfma_f32_16x16x32_bf16 v[108:111], a[0:3], a[44:47], v[108:111]
    ds_read_b64_tr_b16 a[22:23], v8 offset:43600
    v_mfma_f32_16x16x32_bf16 v[92:95], a[4:7], a[40:43], v[92:95]
    ds_read_b64_tr_b16 a[0:1], v8 offset:41080
    v_mfma_f32_16x16x32_bf16 v[112:115], a[4:7], a[44:47], v[112:115]
    ds_read_b64_tr_b16 a[2:3], v8 offset:43640
    s_waitcnt lgkmcnt(6)
    v_mfma_f32_16x16x32_bf16 v[96:99], a[8:11], a[40:43], v[96:99]
    ds_read_b64_tr_b16 a[4:5], v12 offset:40960
    v_mfma_f32_16x16x32_bf16 v[116:119], a[8:11], a[44:47], v[116:119]
    ds_read_b64_tr_b16 a[6:7], v12 offset:43520
    v_mfma_f32_16x16x32_bf16 v[120:123], a[40:43], a[12:15], v[120:123]
    ds_read_b64_tr_b16 a[8:9], v10 offset:40960
    v_mfma_f32_16x16x32_bf16 v[124:127], a[44:47], a[12:15], v[124:127]
    ds_read_b64_tr_b16 a[10:11], v10 offset:43520
    s_waitcnt lgkmcnt(6)
    v_mfma_f32_16x16x32_bf16 v[128:131], a[40:43], a[16:19], v[128:131]
    ds_read_b64_tr_b16 a[12:13], v8 offset:35840
    v_mfma_f32_16x16x32_bf16 v[132:135], a[44:47], a[16:19], v[132:135]
    ds_read_b64_tr_b16 a[14:15], v8 offset:38400
    v_mfma_f32_16x16x32_bf16 v[136:139], a[40:43], a[20:23], v[136:139]
    ds_read_b64_tr_b16 a[16:17], v8 offset:35880
    v_mfma_f32_16x16x32_bf16 v[140:143], a[44:47], a[20:23], v[140:143]
    ds_read_b64_tr_b16 a[18:19], v8 offset:38440
    s_waitcnt lgkmcnt(6)
    v_mfma_f32_16x16x32_bf16 v[144:147], a[40:43], a[0:3], v[144:147]
    ds_read_b64_tr_b16 a[20:21], v8 offset:35920
    v_mfma_f32_16x16x32_bf16 v[148:151], a[44:47], a[0:3], v[148:151]
    ds_read_b64_tr_b16 a[22:23], v8 offset:38480
    v_mfma_f32_16x16x32_bf16 v[168:171], a[64:67], a[4:7], v[168:171]
    ds_read_b64_tr_b16 a[0:1], v8 offset:35960
    ds_read_b64_tr_b16 a[2:3], v8 offset:38520
    s_waitcnt lgkmcnt(6)
    v_mfma_f32_16x16x32_bf16 v[152:155], a[40:43], a[8:11], v[152:155]
    ds_read_b64_tr_b16 a[4:5], v12 offset:35840
    v_mfma_f32_16x16x32_bf16 v[156:159], a[44:47], a[8:11], v[156:159]
    ds_read_b64_tr_b16 a[6:7], v12 offset:38400
    v_mfma_f32_16x16x32_bf16 v[172:175], a[64:67], a[8:11], v[172:175]
    v_mfma_f32_16x16x32_bf16 v[40:43], a[12:15], a[40:43], v[40:43]
    ds_read_b64_tr_b16 a[8:9], v10 offset:35840
    v_mfma_f32_16x16x32_bf16 v[60:63], a[12:15], a[44:47], v[60:63]
    ds_read_b64_tr_b16 a[10:11], v10 offset:38400
    s_barrier
    s_waitcnt lgkmcnt(6)
    v_mfma_f32_16x16x32_bf16 v[44:47], a[16:19], a[40:43], v[44:47]
    ds_read_b64_tr_b16 a[12:13], v8 offset:46080
    v_mfma_f32_16x16x32_bf16 v[64:67], a[16:19], a[44:47], v[64:67]
    ds_read_b64_tr_b16 a[14:15], v8 offset:48640
    v_mfma_f32_16x16x32_bf16 v[48:51], a[20:23], a[40:43], v[48:51]
    ds_read_b64_tr_b16 a[16:17], v8 offset:46120
    v_mfma_f32_16x16x32_bf16 v[68:71], a[20:23], a[44:47], v[68:71]
    ds_read_b64_tr_b16 a[18:19], v8 offset:48680
    s_waitcnt lgkmcnt(6)
    v_mfma_f32_16x16x32_bf16 v[52:55], a[0:3], a[40:43], v[52:55]
    ds_read_b64_tr_b16 a[20:21], v8 offset:46160
    v_mfma_f32_16x16x32_bf16 v[72:75], a[0:3], a[44:47], v[72:75]
    ds_read_b64_tr_b16 a[22:23], v8 offset:48720
    v_mfma_f32_16x16x32_bf16 v[160:163], a[4:7], a[64:67], v[160:163]
    ds_read_b64_tr_b16 a[0:1], v8 offset:46200
    ds_read_b64_tr_b16 a[2:3], v8 offset:48760
    s_waitcnt lgkmcnt(6)
    v_mfma_f32_16x16x32_bf16 v[56:59], a[8:11], a[40:43], v[56:59]
    ds_read_b64_tr_b16 a[4:5], v10 offset:46080
    v_mfma_f32_16x16x32_bf16 v[76:79], a[8:11], a[44:47], v[76:79]
    ds_read_b64_tr_b16 a[6:7], v10 offset:48640
    v_mfma_f32_16x16x32_bf16 v[164:167], a[8:11], a[64:67], v[164:167]
    v_mfma_f32_16x16x32_bf16 v[80:83], a[12:15], a[48:51], v[80:83]
    ds_read_b64_tr_b16 a[8:9], v8 offset:56320
    v_mfma_f32_16x16x32_bf16 v[100:103], a[12:15], a[52:55], v[100:103]
    ds_read_b64_tr_b16 a[10:11], v8 offset:58880
    s_waitcnt lgkmcnt(6)
    v_mfma_f32_16x16x32_bf16 v[84:87], a[16:19], a[48:51], v[84:87]
    ds_read_b64_tr_b16 a[12:13], v8 offset:56360
    v_mfma_f32_16x16x32_bf16 v[104:107], a[16:19], a[52:55], v[104:107]
    ds_read_b64_tr_b16 a[14:15], v8 offset:58920
    v_mfma_f32_16x16x32_bf16 v[88:91], a[20:23], a[48:51], v[88:91]
    ds_read_b64_tr_b16 a[16:17], v8 offset:56400
    v_mfma_f32_16x16x32_bf16 v[108:111], a[20:23], a[52:55], v[108:111]
    ds_read_b64_tr_b16 a[18:19], v8 offset:58960
    s_waitcnt lgkmcnt(6)
    v_mfma_f32_16x16x32_bf16 v[92:95], a[0:3], a[48:51], v[92:95]
    ds_read_b64_tr_b16 a[20:21], v8 offset:56440
    v_mfma_f32_16x16x32_bf16 v[112:115], a[0:3], a[52:55], v[112:115]
    ds_read_b64_tr_b16 a[22:23], v8 offset:59000
    v_mfma_f32_16x16x32_bf16 v[96:99], a[4:7], a[48:51], v[96:99]
    ds_read_b64_tr_b16 a[0:1], v12 offset:56320
    v_mfma_f32_16x16x32_bf16 v[116:119], a[4:7], a[52:55], v[116:119]
    ds_read_b64_tr_b16 a[2:3], v12 offset:58880
    s_waitcnt lgkmcnt(6)
    v_mfma_f32_16x16x32_bf16 v[120:123], a[48:51], a[8:11], v[120:123]
    ds_read_b64_tr_b16 a[4:5], v10 offset:56320
    v_mfma_f32_16x16x32_bf16 v[124:127], a[52:55], a[8:11], v[124:127]
    ds_read_b64_tr_b16 a[6:7], v10 offset:58880
    v_mfma_f32_16x16x32_bf16 v[128:131], a[48:51], a[12:15], v[128:131]
    ds_read_b64_tr_b16 a[8:9], v8 offset:51200
    v_mfma_f32_16x16x32_bf16 v[132:135], a[52:55], a[12:15], v[132:135]
    ds_read_b64_tr_b16 a[10:11], v8 offset:53760
    s_waitcnt lgkmcnt(6)
    v_mfma_f32_16x16x32_bf16 v[136:139], a[48:51], a[16:19], v[136:139]
    ds_read_b64_tr_b16 a[12:13], v8 offset:51240
    v_mfma_f32_16x16x32_bf16 v[140:143], a[52:55], a[16:19], v[140:143]
    ds_read_b64_tr_b16 a[14:15], v8 offset:53800
    v_mfma_f32_16x16x32_bf16 v[144:147], a[48:51], a[20:23], v[144:147]
    ds_read_b64_tr_b16 a[16:17], v8 offset:51280
    v_mfma_f32_16x16x32_bf16 v[148:151], a[52:55], a[20:23], v[148:151]
    ds_read_b64_tr_b16 a[18:19], v8 offset:53840
    s_waitcnt lgkmcnt(6)
    v_mfma_f32_16x16x32_bf16 v[168:171], a[68:71], a[0:3], v[168:171]
    ds_read_b64_tr_b16 a[20:21], v8 offset:51320
    ds_read_b64_tr_b16 a[22:23], v8 offset:53880
    v_mfma_f32_16x16x32_bf16 v[152:155], a[48:51], a[4:7], v[152:155]
    ds_read_b64_tr_b16 a[0:1], v12 offset:51200
    v_mfma_f32_16x16x32_bf16 v[156:159], a[52:55], a[4:7], v[156:159]
    ds_read_b64_tr_b16 a[2:3], v12 offset:53760
    v_mfma_f32_16x16x32_bf16 v[172:175], a[68:71], a[4:7], v[172:175]
    s_waitcnt lgkmcnt(6)
    v_mfma_f32_16x16x32_bf16 v[40:43], a[8:11], a[48:51], v[40:43]
    ds_read_b64_tr_b16 a[4:5], v10 offset:51200
    v_mfma_f32_16x16x32_bf16 v[60:63], a[8:11], a[52:55], v[60:63]
    ds_read_b64_tr_b16 a[6:7], v10 offset:53760
    s_barrier
    v_mfma_f32_16x16x32_bf16 v[44:47], a[12:15], a[48:51], v[44:47]
    ds_read_b64_tr_b16 a[8:9], v9 offset:0
    ds_read_b128 a[24:27], v4 offset:16384
    v_mfma_f32_16x16x32_bf16 v[64:67], a[12:15], a[52:55], v[64:67]
    ds_read_b64_tr_b16 a[10:11], v9 offset:2560
    ds_read_b128 a[28:31], v4 offset:18432
    s_waitcnt lgkmcnt(8)
    v_mfma_f32_16x16x32_bf16 v[48:51], a[16:19], a[48:51], v[48:51]
    ds_read_b64_tr_b16 a[12:13], v9 offset:40
    ds_read_b128 a[56:59], v6 offset:4096
    v_mfma_f32_16x16x32_bf16 v[68:71], a[16:19], a[52:55], v[68:71]
    ds_read_b64_tr_b16 a[14:15], v9 offset:2600
    ds_read_b128 a[32:35], v5 offset:16384
    v_mfma_f32_16x16x32_bf16 v[52:55], a[20:23], a[48:51], v[52:55]
    ds_read_b64_tr_b16 a[16:17], v9 offset:80
    ds_read_b128 a[36:39], v5 offset:18432
    v_mfma_f32_16x16x32_bf16 v[72:75], a[20:23], a[52:55], v[72:75]
    ds_read_b64_tr_b16 a[18:19], v9 offset:2640
    ds_read_b128 a[60:63], v7 offset:4096
    s_waitcnt lgkmcnt(12)
    v_mfma_f32_16x16x32_bf16 v[160:163], a[0:3], a[68:71], v[160:163]
    ds_read_b64_tr_b16 a[20:21], v9 offset:120
    ds_read_b64_tr_b16 a[22:23], v9 offset:2680
    v_mfma_f32_16x16x32_bf16 v[56:59], a[4:7], a[48:51], v[56:59]
    ds_read_b64_tr_b16 a[0:1], v11 offset:0
    v_mfma_f32_16x16x32_bf16 v[76:79], a[4:7], a[52:55], v[76:79]
    ds_read_b64_tr_b16 a[2:3], v11 offset:2560
    v_mfma_f32_16x16x32_bf16 v[164:167], a[4:7], a[68:71], v[164:167]
    s_waitcnt lgkmcnt(4)
    v_mfma_f32_16x16x32_bf16 v[80:83], a[8:11], a[24:27], v[80:83]
    ds_read_b64_tr_b16 a[4:5], v9 offset:10240
    v_mfma_f32_16x16x32_bf16 v[100:103], a[8:11], a[28:31], v[100:103]
    ds_read_b64_tr_b16 a[6:7], v9 offset:12800
    v_mfma_f32_16x16x32_bf16 v[84:87], a[12:15], a[24:27], v[84:87]
    ds_read_b64_tr_b16 a[8:9], v9 offset:10280
    v_mfma_f32_16x16x32_bf16 v[104:107], a[12:15], a[28:31], v[104:107]
    ds_read_b64_tr_b16 a[10:11], v9 offset:12840
    s_waitcnt lgkmcnt(6)
    v_mfma_f32_16x16x32_bf16 v[88:91], a[16:19], a[24:27], v[88:91]
    ds_read_b64_tr_b16 a[12:13], v9 offset:10320
    v_mfma_f32_16x16x32_bf16 v[108:111], a[16:19], a[28:31], v[108:111]
    ds_read_b64_tr_b16 a[14:15], v9 offset:12880
    v_mfma_f32_16x16x32_bf16 v[92:95], a[20:23], a[24:27], v[92:95]
    ds_read_b64_tr_b16 a[16:17], v9 offset:10360
    v_mfma_f32_16x16x32_bf16 v[112:115], a[20:23], a[28:31], v[112:115]
    ds_read_b64_tr_b16 a[18:19], v9 offset:12920
    s_waitcnt lgkmcnt(6)
    v_mfma_f32_16x16x32_bf16 v[96:99], a[0:3], a[24:27], v[96:99]
    ds_read_b64_tr_b16 a[20:21], v13 offset:10240
    v_mfma_f32_16x16x32_bf16 v[116:119], a[0:3], a[28:31], v[116:119]
    ds_read_b64_tr_b16 a[22:23], v13 offset:12800
    v_mfma_f32_16x16x32_bf16 v[120:123], a[24:27], a[4:7], v[120:123]
    ds_read_b64_tr_b16 a[0:1], v11 offset:10240
    v_mfma_f32_16x16x32_bf16 v[124:127], a[28:31], a[4:7], v[124:127]
    ds_read_b64_tr_b16 a[2:3], v11 offset:12800
    s_waitcnt lgkmcnt(6)
    v_mfma_f32_16x16x32_bf16 v[128:131], a[24:27], a[8:11], v[128:131]
    ds_read_b64_tr_b16 a[4:5], v9 offset:5120
    v_mfma_f32_16x16x32_bf16 v[132:135], a[28:31], a[8:11], v[132:135]
    ds_read_b64_tr_b16 a[6:7], v9 offset:7680
    v_mfma_f32_16x16x32_bf16 v[136:139], a[24:27], a[12:15], v[136:139]
    ds_read_b64_tr_b16 a[8:9], v9 offset:5160
    v_mfma_f32_16x16x32_bf16 v[140:143], a[28:31], a[12:15], v[140:143]
    ds_read_b64_tr_b16 a[10:11], v9 offset:7720
    s_waitcnt lgkmcnt(6)
    v_mfma_f32_16x16x32_bf16 v[144:147], a[24:27], a[16:19], v[144:147]
    ds_read_b64_tr_b16 a[12:13], v9 offset:5200
    v_mfma_f32_16x16x32_bf16 v[148:151], a[28:31], a[16:19], v[148:151]
    ds_read_b64_tr_b16 a[14:15], v9 offset:7760
    v_mfma_f32_16x16x32_bf16 v[168:171], a[56:59], a[20:23], v[168:171]
    ds_read_b64_tr_b16 a[16:17], v9 offset:5240
    ds_read_b64_tr_b16 a[18:19], v9 offset:7800
    s_waitcnt lgkmcnt(6)
    v_mfma_f32_16x16x32_bf16 v[152:155], a[24:27], a[0:3], v[152:155]
    ds_read_b64_tr_b16 a[20:21], v13 offset:5120
    v_mfma_f32_16x16x32_bf16 v[156:159], a[28:31], a[0:3], v[156:159]
    ds_read_b64_tr_b16 a[22:23], v13 offset:7680
    v_mfma_f32_16x16x32_bf16 v[172:175], a[56:59], a[0:3], v[172:175]
    v_mfma_f32_16x16x32_bf16 v[40:43], a[4:7], a[24:27], v[40:43]
    ds_read_b64_tr_b16 a[0:1], v11 offset:5120
    v_mfma_f32_16x16x32_bf16 v[60:63], a[4:7], a[28:31], v[60:63]
    ds_read_b64_tr_b16 a[2:3], v11 offset:7680
    s_barrier
    s_waitcnt lgkmcnt(6)
    v_mfma_f32_16x16x32_bf16 v[44:47], a[8:11], a[24:27], v[44:47]
    ds_read_b64_tr_b16 a[4:5], v9 offset:15360
    v_mfma_f32_16x16x32_bf16 v[64:67], a[8:11], a[28:31], v[64:67]
    ds_read_b64_tr_b16 a[6:7], v9 offset:17920
    v_mfma_f32_16x16x32_bf16 v[48:51], a[12:15], a[24:27], v[48:51]
    ds_read_b64_tr_b16 a[8:9], v9 offset:15400
    v_mfma_f32_16x16x32_bf16 v[68:71], a[12:15], a[28:31], v[68:71]
    ds_read_b64_tr_b16 a[10:11], v9 offset:17960
    s_waitcnt lgkmcnt(6)
    v_mfma_f32_16x16x32_bf16 v[52:55], a[16:19], a[24:27], v[52:55]
    ds_read_b64_tr_b16 a[12:13], v9 offset:15440
    v_mfma_f32_16x16x32_bf16 v[72:75], a[16:19], a[28:31], v[72:75]
    ds_read_b64_tr_b16 a[14:15], v9 offset:18000
    v_mfma_f32_16x16x32_bf16 v[160:163], a[20:23], a[56:59], v[160:163]
    ds_read_b64_tr_b16 a[16:17], v9 offset:15480
    ds_read_b64_tr_b16 a[18:19], v9 offset:18040
    s_waitcnt lgkmcnt(6)
    v_mfma_f32_16x16x32_bf16 v[56:59], a[0:3], a[24:27], v[56:59]
    ds_read_b64_tr_b16 a[20:21], v11 offset:15360
    v_mfma_f32_16x16x32_bf16 v[76:79], a[0:3], a[28:31], v[76:79]
    ds_read_b64_tr_b16 a[22:23], v11 offset:17920
    v_mfma_f32_16x16x32_bf16 v[164:167], a[0:3], a[56:59], v[164:167]
    v_mfma_f32_16x16x32_bf16 v[80:83], a[4:7], a[32:35], v[80:83]
    ds_read_b64_tr_b16 a[0:1], v9 offset:25600
    v_mfma_f32_16x16x32_bf16 v[100:103], a[4:7], a[36:39], v[100:103]
    ds_read_b64_tr_b16 a[2:3], v9 offset:28160
    s_waitcnt lgkmcnt(6)
    v_mfma_f32_16x16x32_bf16 v[84:87], a[8:11], a[32:35], v[84:87]
    ds_read_b64_tr_b16 a[4:5], v9 offset:25640
    v_mfma_f32_16x16x32_bf16 v[104:107], a[8:11], a[36:39], v[104:107]
    ds_read_b64_tr_b16 a[6:7], v9 offset:28200
    v_mfma_f32_16x16x32_bf16 v[88:91], a[12:15], a[32:35], v[88:91]
    ds_read_b64_tr_b16 a[8:9], v9 offset:25680
    v_mfma_f32_16x16x32_bf16 v[108:111], a[12:15], a[36:39], v[108:111]
    ds_read_b64_tr_b16 a[10:11], v9 offset:28240
    s_waitcnt lgkmcnt(6)
    v_mfma_f32_16x16x32_bf16 v[92:95], a[16:19], a[32:35], v[92:95]
    ds_read_b64_tr_b16 a[12:13], v9 offset:25720
    v_mfma_f32_16x16x32_bf16 v[112:115], a[16:19], a[36:39], v[112:115]
    ds_read_b64_tr_b16 a[14:15], v9 offset:28280
    v_mfma_f32_16x16x32_bf16 v[96:99], a[20:23], a[32:35], v[96:99]
    ds_read_b64_tr_b16 a[16:17], v13 offset:25600
    v_mfma_f32_16x16x32_bf16 v[116:119], a[20:23], a[36:39], v[116:119]
    ds_read_b64_tr_b16 a[18:19], v13 offset:28160
    s_waitcnt lgkmcnt(6)
    v_mfma_f32_16x16x32_bf16 v[120:123], a[32:35], a[0:3], v[120:123]
    ds_read_b64_tr_b16 a[20:21], v11 offset:25600
    v_mfma_f32_16x16x32_bf16 v[124:127], a[36:39], a[0:3], v[124:127]
    ds_read_b64_tr_b16 a[22:23], v11 offset:28160
    v_mfma_f32_16x16x32_bf16 v[128:131], a[32:35], a[4:7], v[128:131]
    ds_read_b64_tr_b16 a[0:1], v9 offset:20480
    v_mfma_f32_16x16x32_bf16 v[132:135], a[36:39], a[4:7], v[132:135]
    ds_read_b64_tr_b16 a[2:3], v9 offset:23040
    s_waitcnt lgkmcnt(6)
    v_mfma_f32_16x16x32_bf16 v[136:139], a[32:35], a[8:11], v[136:139]
    ds_read_b64_tr_b16 a[4:5], v9 offset:20520
    v_mfma_f32_16x16x32_bf16 v[140:143], a[36:39], a[8:11], v[140:143]
    ds_read_b64_tr_b16 a[6:7], v9 offset:23080
    v_mfma_f32_16x16x32_bf16 v[144:147], a[32:35], a[12:15], v[144:147]
    ds_read_b64_tr_b16 a[8:9], v9 offset:20560
    v_mfma_f32_16x16x32_bf16 v[148:151], a[36:39], a[12:15], v[148:151]
    ds_read_b64_tr_b16 a[10:11], v9 offset:23120
    s_waitcnt lgkmcnt(6)
    v_mfma_f32_16x16x32_bf16 v[168:171], a[60:63], a[16:19], v[168:171]
    ds_read_b64_tr_b16 a[12:13], v9 offset:20600
    ds_read_b64_tr_b16 a[14:15], v9 offset:23160
    v_mfma_f32_16x16x32_bf16 v[152:155], a[32:35], a[20:23], v[152:155]
    ds_read_b64_tr_b16 a[16:17], v13 offset:20480
    v_mfma_f32_16x16x32_bf16 v[156:159], a[36:39], a[20:23], v[156:159]
    ds_read_b64_tr_b16 a[18:19], v13 offset:23040
    v_mfma_f32_16x16x32_bf16 v[172:175], a[60:63], a[20:23], v[172:175]
    s_waitcnt lgkmcnt(6)
    v_mfma_f32_16x16x32_bf16 v[40:43], a[0:3], a[32:35], v[40:43]
    ds_read_b64_tr_b16 a[20:21], v11 offset:20480
    v_mfma_f32_16x16x32_bf16 v[60:63], a[0:3], a[36:39], v[60:63]
    ds_read_b64_tr_b16 a[22:23], v11 offset:23040
    s_barrier
    v_mfma_f32_16x16x32_bf16 v[44:47], a[4:7], a[32:35], v[44:47]
    ds_read_b64_tr_b16 a[0:1], v8 offset:0
    ds_read_b128 a[40:43], v4 offset:40960
    v_mfma_f32_16x16x32_bf16 v[64:67], a[4:7], a[36:39], v[64:67]
    ds_read_b64_tr_b16 a[2:3], v8 offset:2560
    ds_read_b128 a[44:47], v4 offset:43008
    s_waitcnt lgkmcnt(8)
    v_mfma_f32_16x16x32_bf16 v[48:51], a[8:11], a[32:35], v[48:51]
    ds_read_b64_tr_b16 a[4:5], v8 offset:40
    ds_read_b128 a[64:67], v6 offset:0
    v_mfma_f32_16x16x32_bf16 v[68:71], a[8:11], a[36:39], v[68:71]
    ds_read_b64_tr_b16 a[6:7], v8 offset:2600
    ds_read_b128 a[48:51], v5 offset:40960
    v_mfma_f32_16x16x32_bf16 v[52:55], a[12:15], a[32:35], v[52:55]
    ds_read_b64_tr_b16 a[8:9], v8 offset:80
    ds_read_b128 a[52:55], v5 offset:43008
    v_mfma_f32_16x16x32_bf16 v[72:75], a[12:15], a[36:39], v[72:75]
    ds_read_b64_tr_b16 a[10:11], v8 offset:2640
    ds_read_b128 a[68:71], v7 offset:0
    s_waitcnt lgkmcnt(12)
    v_mfma_f32_16x16x32_bf16 v[160:163], a[16:19], a[60:63], v[160:163]
    ds_read_b64_tr_b16 a[12:13], v8 offset:120
    ds_read_b64_tr_b16 a[14:15], v8 offset:2680
    v_mfma_f32_16x16x32_bf16 v[56:59], a[20:23], a[32:35], v[56:59]
    ds_read_b64_tr_b16 a[16:17], v10 offset:0
    v_mfma_f32_16x16x32_bf16 v[76:79], a[20:23], a[36:39], v[76:79]
    ds_read_b64_tr_b16 a[18:19], v10 offset:2560
    v_mfma_f32_16x16x32_bf16 v[164:167], a[20:23], a[60:63], v[164:167]
    s_waitcnt lgkmcnt(4)
    v_mfma_f32_16x16x32_bf16 v[80:83], a[0:3], a[40:43], v[80:83]
    ds_read_b64_tr_b16 a[20:21], v8 offset:10240
    v_mfma_f32_16x16x32_bf16 v[100:103], a[0:3], a[44:47], v[100:103]
    ds_read_b64_tr_b16 a[22:23], v8 offset:12800
    v_mfma_f32_16x16x32_bf16 v[84:87], a[4:7], a[40:43], v[84:87]
    ds_read_b64_tr_b16 a[0:1], v8 offset:10280
    v_mfma_f32_16x16x32_bf16 v[104:107], a[4:7], a[44:47], v[104:107]
    ds_read_b64_tr_b16 a[2:3], v8 offset:12840
    s_waitcnt lgkmcnt(6)
    v_mfma_f32_16x16x32_bf16 v[88:91], a[8:11], a[40:43], v[88:91]
    ds_read_b64_tr_b16 a[4:5], v8 offset:10320
    v_mfma_f32_16x16x32_bf16 v[108:111], a[8:11], a[44:47], v[108:111]
    ds_read_b64_tr_b16 a[6:7], v8 offset:12880
    v_mfma_f32_16x16x32_bf16 v[92:95], a[12:15], a[40:43], v[92:95]
    ds_read_b64_tr_b16 a[8:9], v8 offset:10360
    v_mfma_f32_16x16x32_bf16 v[112:115], a[12:15], a[44:47], v[112:115]
    ds_read_b64_tr_b16 a[10:11], v8 offset:12920
    s_waitcnt lgkmcnt(6)
    v_mfma_f32_16x16x32_bf16 v[96:99], a[16:19], a[40:43], v[96:99]
    ds_read_b64_tr_b16 a[12:13], v12 offset:10240
    v_mfma_f32_16x16x32_bf16 v[116:119], a[16:19], a[44:47], v[116:119]
    ds_read_b64_tr_b16 a[14:15], v12 offset:12800
    v_mfma_f32_16x16x32_bf16 v[120:123], a[40:43], a[20:23], v[120:123]
    ds_read_b64_tr_b16 a[16:17], v10 offset:10240
    v_mfma_f32_16x16x32_bf16 v[124:127], a[44:47], a[20:23], v[124:127]
    ds_read_b64_tr_b16 a[18:19], v10 offset:12800
    s_waitcnt lgkmcnt(6)
    v_mfma_f32_16x16x32_bf16 v[128:131], a[40:43], a[0:3], v[128:131]
    ds_read_b64_tr_b16 a[20:21], v8 offset:5120
    v_mfma_f32_16x16x32_bf16 v[132:135], a[44:47], a[0:3], v[132:135]
    ds_read_b64_tr_b16 a[22:23], v8 offset:7680
    v_mfma_f32_16x16x32_bf16 v[136:139], a[40:43], a[4:7], v[136:139]
    ds_read_b64_tr_b16 a[0:1], v8 offset:5160
    v_mfma_f32_16x16x32_bf16 v[140:143], a[44:47], a[4:7], v[140:143]
    ds_read_b64_tr_b16 a[2:3], v8 offset:7720
    s_waitcnt lgkmcnt(6)
    v_mfma_f32_16x16x32_bf16 v[144:147], a[40:43], a[8:11], v[144:147]
    ds_read_b64_tr_b16 a[4:5], v8 offset:5200
    v_mfma_f32_16x16x32_bf16 v[148:151], a[44:47], a[8:11], v[148:151]
    ds_read_b64_tr_b16 a[6:7], v8 offset:7760
    v_mfma_f32_16x16x32_bf16 v[168:171], a[64:67], a[12:15], v[168:171]
    ds_read_b64_tr_b16 a[8:9], v8 offset:5240
    ds_read_b64_tr_b16 a[10:11], v8 offset:7800
    s_waitcnt lgkmcnt(6)
    v_mfma_f32_16x16x32_bf16 v[152:155], a[40:43], a[16:19], v[152:155]
    ds_read_b64_tr_b16 a[12:13], v12 offset:5120
    v_mfma_f32_16x16x32_bf16 v[156:159], a[44:47], a[16:19], v[156:159]
    ds_read_b64_tr_b16 a[14:15], v12 offset:7680
    v_mfma_f32_16x16x32_bf16 v[172:175], a[64:67], a[16:19], v[172:175]
    v_mfma_f32_16x16x32_bf16 v[40:43], a[20:23], a[40:43], v[40:43]
    ds_read_b64_tr_b16 a[16:17], v10 offset:5120
    v_mfma_f32_16x16x32_bf16 v[60:63], a[20:23], a[44:47], v[60:63]
    ds_read_b64_tr_b16 a[18:19], v10 offset:7680
    s_barrier
    s_waitcnt lgkmcnt(6)
    v_mfma_f32_16x16x32_bf16 v[44:47], a[0:3], a[40:43], v[44:47]
    ds_read_b64_tr_b16 a[20:21], v8 offset:15360
    v_mfma_f32_16x16x32_bf16 v[64:67], a[0:3], a[44:47], v[64:67]
    ds_read_b64_tr_b16 a[22:23], v8 offset:17920
    v_mfma_f32_16x16x32_bf16 v[48:51], a[4:7], a[40:43], v[48:51]
    ds_read_b64_tr_b16 a[0:1], v8 offset:15400
    v_mfma_f32_16x16x32_bf16 v[68:71], a[4:7], a[44:47], v[68:71]
    ds_read_b64_tr_b16 a[2:3], v8 offset:17960
    s_waitcnt lgkmcnt(6)
    v_mfma_f32_16x16x32_bf16 v[52:55], a[8:11], a[40:43], v[52:55]
    ds_read_b64_tr_b16 a[4:5], v8 offset:15440
    v_mfma_f32_16x16x32_bf16 v[72:75], a[8:11], a[44:47], v[72:75]
    ds_read_b64_tr_b16 a[6:7], v8 offset:18000
    v_mfma_f32_16x16x32_bf16 v[160:163], a[12:15], a[64:67], v[160:163]
    ds_read_b64_tr_b16 a[8:9], v8 offset:15480
    ds_read_b64_tr_b16 a[10:11], v8 offset:18040
    s_waitcnt lgkmcnt(6)
    v_mfma_f32_16x16x32_bf16 v[56:59], a[16:19], a[40:43], v[56:59]
    ds_read_b64_tr_b16 a[12:13], v10 offset:15360
    v_mfma_f32_16x16x32_bf16 v[76:79], a[16:19], a[44:47], v[76:79]
    ds_read_b64_tr_b16 a[14:15], v10 offset:17920
    v_mfma_f32_16x16x32_bf16 v[164:167], a[16:19], a[64:67], v[164:167]
    v_mfma_f32_16x16x32_bf16 v[80:83], a[20:23], a[48:51], v[80:83]
    ds_read_b64_tr_b16 a[16:17], v8 offset:25600
    v_mfma_f32_16x16x32_bf16 v[100:103], a[20:23], a[52:55], v[100:103]
    ds_read_b64_tr_b16 a[18:19], v8 offset:28160
    s_waitcnt lgkmcnt(6)
    v_mfma_f32_16x16x32_bf16 v[84:87], a[0:3], a[48:51], v[84:87]
    ds_read_b64_tr_b16 a[20:21], v8 offset:25640
    v_mfma_f32_16x16x32_bf16 v[104:107], a[0:3], a[52:55], v[104:107]
    ds_read_b64_tr_b16 a[22:23], v8 offset:28200
    v_mfma_f32_16x16x32_bf16 v[88:91], a[4:7], a[48:51], v[88:91]
    ds_read_b64_tr_b16 a[0:1], v8 offset:25680
    v_mfma_f32_16x16x32_bf16 v[108:111], a[4:7], a[52:55], v[108:111]
    ds_read_b64_tr_b16 a[2:3], v8 offset:28240
    s_waitcnt lgkmcnt(6)
    v_mfma_f32_16x16x32_bf16 v[92:95], a[8:11], a[48:51], v[92:95]
    ds_read_b64_tr_b16 a[4:5], v8 offset:25720
    v_mfma_f32_16x16x32_bf16 v[112:115], a[8:11], a[52:55], v[112:115]
    ds_read_b64_tr_b16 a[6:7], v8 offset:28280
    v_mfma_f32_16x16x32_bf16 v[96:99], a[12:15], a[48:51], v[96:99]
    ds_read_b64_tr_b16 a[8:9], v12 offset:25600
    v_mfma_f32_16x16x32_bf16 v[116:119], a[12:15], a[52:55], v[116:119]
    ds_read_b64_tr_b16 a[10:11], v12 offset:28160
    s_waitcnt lgkmcnt(6)
    v_mfma_f32_16x16x32_bf16 v[120:123], a[48:51], a[16:19], v[120:123]
    ds_read_b64_tr_b16 a[12:13], v10 offset:25600
    v_mfma_f32_16x16x32_bf16 v[124:127], a[52:55], a[16:19], v[124:127]
    ds_read_b64_tr_b16 a[14:15], v10 offset:28160
    v_mfma_f32_16x16x32_bf16 v[128:131], a[48:51], a[20:23], v[128:131]
    ds_read_b64_tr_b16 a[16:17], v8 offset:20480
    v_mfma_f32_16x16x32_bf16 v[132:135], a[52:55], a[20:23], v[132:135]
    ds_read_b64_tr_b16 a[18:19], v8 offset:23040
    s_waitcnt lgkmcnt(6)
    v_mfma_f32_16x16x32_bf16 v[136:139], a[48:51], a[0:3], v[136:139]
    ds_read_b64_tr_b16 a[20:21], v8 offset:20520
    v_mfma_f32_16x16x32_bf16 v[140:143], a[52:55], a[0:3], v[140:143]
    ds_read_b64_tr_b16 a[22:23], v8 offset:23080
    v_mfma_f32_16x16x32_bf16 v[144:147], a[48:51], a[4:7], v[144:147]
    ds_read_b64_tr_b16 a[0:1], v8 offset:20560
    v_mfma_f32_16x16x32_bf16 v[148:151], a[52:55], a[4:7], v[148:151]
    ds_read_b64_tr_b16 a[2:3], v8 offset:23120
    s_waitcnt lgkmcnt(6)
    v_mfma_f32_16x16x32_bf16 v[168:171], a[68:71], a[8:11], v[168:171]
    ds_read_b64_tr_b16 a[4:5], v8 offset:20600
    ds_read_b64_tr_b16 a[6:7], v8 offset:23160
    v_mfma_f32_16x16x32_bf16 v[152:155], a[48:51], a[12:15], v[152:155]
    ds_read_b64_tr_b16 a[8:9], v12 offset:20480
    v_mfma_f32_16x16x32_bf16 v[156:159], a[52:55], a[12:15], v[156:159]
    ds_read_b64_tr_b16 a[10:11], v12 offset:23040
    v_mfma_f32_16x16x32_bf16 v[172:175], a[68:71], a[12:15], v[172:175]
    s_waitcnt lgkmcnt(6)
    v_mfma_f32_16x16x32_bf16 v[40:43], a[16:19], a[48:51], v[40:43]
    ds_read_b64_tr_b16 a[12:13], v10 offset:20480
    v_mfma_f32_16x16x32_bf16 v[60:63], a[16:19], a[52:55], v[60:63]
    ds_read_b64_tr_b16 a[14:15], v10 offset:23040
    s_barrier
    v_mfma_f32_16x16x32_bf16 v[44:47], a[20:23], a[48:51], v[44:47]
    ds_read_b64_tr_b16 a[16:17], v8 offset:30720
    ds_read_b128 a[24:27], v4 offset:0
    v_mfma_f32_16x16x32_bf16 v[64:67], a[20:23], a[52:55], v[64:67]
    ds_read_b64_tr_b16 a[18:19], v8 offset:33280
    ds_read_b128 a[28:31], v4 offset:2048
    s_waitcnt lgkmcnt(8)
    v_mfma_f32_16x16x32_bf16 v[48:51], a[0:3], a[48:51], v[48:51]
    ds_read_b64_tr_b16 a[20:21], v8 offset:30760
    ds_read_b128 a[56:59], v6 offset:2048
    v_mfma_f32_16x16x32_bf16 v[68:71], a[0:3], a[52:55], v[68:71]
    ds_read_b64_tr_b16 a[22:23], v8 offset:33320
    ds_read_b128 a[32:35], v5 offset:0
    v_mfma_f32_16x16x32_bf16 v[52:55], a[4:7], a[48:51], v[52:55]
    ds_read_b64_tr_b16 a[0:1], v8 offset:30800
    ds_read_b128 a[36:39], v5 offset:2048
    v_mfma_f32_16x16x32_bf16 v[72:75], a[4:7], a[52:55], v[72:75]
    ds_read_b64_tr_b16 a[2:3], v8 offset:33360
    ds_read_b128 a[60:63], v7 offset:2048
    s_waitcnt lgkmcnt(12)
    v_mfma_f32_16x16x32_bf16 v[160:163], a[8:11], a[68:71], v[160:163]
    ds_read_b64_tr_b16 a[4:5], v8 offset:30840
    ds_read_b64_tr_b16 a[6:7], v8 offset:33400
    v_mfma_f32_16x16x32_bf16 v[56:59], a[12:15], a[48:51], v[56:59]
    ds_read_b64_tr_b16 a[8:9], v10 offset:30720
    v_mfma_f32_16x16x32_bf16 v[76:79], a[12:15], a[52:55], v[76:79]
    ds_read_b64_tr_b16 a[10:11], v10 offset:33280
    v_mfma_f32_16x16x32_bf16 v[164:167], a[12:15], a[68:71], v[164:167]
    s_waitcnt lgkmcnt(4)
    v_mfma_f32_16x16x32_bf16 v[80:83], a[16:19], a[24:27], v[80:83]
    ds_read_b64_tr_b16 a[12:13], v8 offset:40960
    v_mfma_f32_16x16x32_bf16 v[100:103], a[16:19], a[28:31], v[100:103]
    ds_read_b64_tr_b16 a[14:15], v8 offset:43520
    v_mfma_f32_16x16x32_bf16 v[84:87], a[20:23], a[24:27], v[84:87]
    ds_read_b64_tr_b16 a[16:17], v8 offset:41000
    v_mfma_f32_16x16x32_bf16 v[104:107], a[20:23], a[28:31], v[104:107]
    ds_read_b64_tr_b16 a[18:19], v8 offset:43560
    s_waitcnt lgkmcnt(6)
    v_mfma_f32_16x16x32_bf16 v[88:91], a[0:3], a[24:27], v[88:91]
    ds_read_b64_tr_b16 a[20:21], v8 offset:41040
    v_mfma_f32_16x16x32_bf16 v[108:111], a[0:3], a[28:31], v[108:111]
    ds_read_b64_tr_b16 a[22:23], v8 offset:43600
    v_mfma_f32_16x16x32_bf16 v[92:95], a[4:7], a[24:27], v[92:95]
    ds_read_b64_tr_b16 a[0:1], v8 offset:41080
    v_mfma_f32_16x16x32_bf16 v[112:115], a[4:7], a[28:31], v[112:115]
    ds_read_b64_tr_b16 a[2:3], v8 offset:43640
    s_waitcnt lgkmcnt(6)
    v_mfma_f32_16x16x32_bf16 v[96:99], a[8:11], a[24:27], v[96:99]
    ds_read_b64_tr_b16 a[4:5], v12 offset:40960
    v_mfma_f32_16x16x32_bf16 v[116:119], a[8:11], a[28:31], v[116:119]
    ds_read_b64_tr_b16 a[6:7], v12 offset:43520
    v_mfma_f32_16x16x32_bf16 v[120:123], a[24:27], a[12:15], v[120:123]
    ds_read_b64_tr_b16 a[8:9], v10 offset:40960
    v_mfma_f32_16x16x32_bf16 v[124:127], a[28:31], a[12:15], v[124:127]
    ds_read_b64_tr_b16 a[10:11], v10 offset:43520
    s_waitcnt lgkmcnt(6)
    v_mfma_f32_16x16x32_bf16 v[128:131], a[24:27], a[16:19], v[128:131]
    ds_read_b64_tr_b16 a[12:13], v8 offset:35840
    v_mfma_f32_16x16x32_bf16 v[132:135], a[28:31], a[16:19], v[132:135]
    ds_read_b64_tr_b16 a[14:15], v8 offset:38400
    v_mfma_f32_16x16x32_bf16 v[136:139], a[24:27], a[20:23], v[136:139]
    ds_read_b64_tr_b16 a[16:17], v8 offset:35880
    v_mfma_f32_16x16x32_bf16 v[140:143], a[28:31], a[20:23], v[140:143]
    ds_read_b64_tr_b16 a[18:19], v8 offset:38440
    s_waitcnt lgkmcnt(6)
    v_mfma_f32_16x16x32_bf16 v[144:147], a[24:27], a[0:3], v[144:147]
    ds_read_b64_tr_b16 a[20:21], v8 offset:35920
    v_mfma_f32_16x16x32_bf16 v[148:151], a[28:31], a[0:3], v[148:151]
    ds_read_b64_tr_b16 a[22:23], v8 offset:38480
    v_mfma_f32_16x16x32_bf16 v[168:171], a[56:59], a[4:7], v[168:171]
    ds_read_b64_tr_b16 a[0:1], v8 offset:35960
    ds_read_b64_tr_b16 a[2:3], v8 offset:38520
    s_waitcnt lgkmcnt(6)
    v_mfma_f32_16x16x32_bf16 v[152:155], a[24:27], a[8:11], v[152:155]
    ds_read_b64_tr_b16 a[4:5], v12 offset:35840
    v_mfma_f32_16x16x32_bf16 v[156:159], a[28:31], a[8:11], v[156:159]
    ds_read_b64_tr_b16 a[6:7], v12 offset:38400
    v_mfma_f32_16x16x32_bf16 v[172:175], a[56:59], a[8:11], v[172:175]
    v_mfma_f32_16x16x32_bf16 v[40:43], a[12:15], a[24:27], v[40:43]
    ds_read_b64_tr_b16 a[8:9], v10 offset:35840
    v_mfma_f32_16x16x32_bf16 v[60:63], a[12:15], a[28:31], v[60:63]
    ds_read_b64_tr_b16 a[10:11], v10 offset:38400
    s_barrier
    s_waitcnt lgkmcnt(6)
    v_mfma_f32_16x16x32_bf16 v[44:47], a[16:19], a[24:27], v[44:47]
    ds_read_b64_tr_b16 a[12:13], v8 offset:46080
    v_mfma_f32_16x16x32_bf16 v[64:67], a[16:19], a[28:31], v[64:67]
    ds_read_b64_tr_b16 a[14:15], v8 offset:48640
    v_mfma_f32_16x16x32_bf16 v[48:51], a[20:23], a[24:27], v[48:51]
    ds_read_b64_tr_b16 a[16:17], v8 offset:46120
    v_mfma_f32_16x16x32_bf16 v[68:71], a[20:23], a[28:31], v[68:71]
    ds_read_b64_tr_b16 a[18:19], v8 offset:48680
    s_waitcnt lgkmcnt(6)
    v_mfma_f32_16x16x32_bf16 v[52:55], a[0:3], a[24:27], v[52:55]
    ds_read_b64_tr_b16 a[20:21], v8 offset:46160
    v_mfma_f32_16x16x32_bf16 v[72:75], a[0:3], a[28:31], v[72:75]
    ds_read_b64_tr_b16 a[22:23], v8 offset:48720
    v_mfma_f32_16x16x32_bf16 v[160:163], a[4:7], a[56:59], v[160:163]
    ds_read_b64_tr_b16 a[0:1], v8 offset:46200
    ds_read_b64_tr_b16 a[2:3], v8 offset:48760
    s_waitcnt lgkmcnt(6)
    v_mfma_f32_16x16x32_bf16 v[56:59], a[8:11], a[24:27], v[56:59]
    ds_read_b64_tr_b16 a[4:5], v10 offset:46080
    v_mfma_f32_16x16x32_bf16 v[76:79], a[8:11], a[28:31], v[76:79]
    ds_read_b64_tr_b16 a[6:7], v10 offset:48640
    v_mfma_f32_16x16x32_bf16 v[164:167], a[8:11], a[56:59], v[164:167]
    v_mfma_f32_16x16x32_bf16 v[80:83], a[12:15], a[32:35], v[80:83]
    ds_read_b64_tr_b16 a[8:9], v8 offset:56320
    v_mfma_f32_16x16x32_bf16 v[100:103], a[12:15], a[36:39], v[100:103]
    ds_read_b64_tr_b16 a[10:11], v8 offset:58880
    s_waitcnt lgkmcnt(6)
    v_mfma_f32_16x16x32_bf16 v[84:87], a[16:19], a[32:35], v[84:87]
    ds_read_b64_tr_b16 a[12:13], v8 offset:56360
    v_mfma_f32_16x16x32_bf16 v[104:107], a[16:19], a[36:39], v[104:107]
    ds_read_b64_tr_b16 a[14:15], v8 offset:58920
    v_mfma_f32_16x16x32_bf16 v[88:91], a[20:23], a[32:35], v[88:91]
    ds_read_b64_tr_b16 a[16:17], v8 offset:56400
    v_mfma_f32_16x16x32_bf16 v[108:111], a[20:23], a[36:39], v[108:111]
    ds_read_b64_tr_b16 a[18:19], v8 offset:58960
    s_waitcnt lgkmcnt(6)
    v_mfma_f32_16x16x32_bf16 v[92:95], a[0:3], a[32:35], v[92:95]
    ds_read_b64_tr_b16 a[20:21], v8 offset:56440
    v_mfma_f32_16x16x32_bf16 v[112:115], a[0:3], a[36:39], v[112:115]
    ds_read_b64_tr_b16 a[22:23], v8 offset:59000
    v_mfma_f32_16x16x32_bf16 v[96:99], a[4:7], a[32:35], v[96:99]
    ds_read_b64_tr_b16 a[0:1], v12 offset:56320
    v_mfma_f32_16x16x32_bf16 v[116:119], a[4:7], a[36:39], v[116:119]
    ds_read_b64_tr_b16 a[2:3], v12 offset:58880
    s_waitcnt lgkmcnt(6)
    v_mfma_f32_16x16x32_bf16 v[120:123], a[32:35], a[8:11], v[120:123]
    ds_read_b64_tr_b16 a[4:5], v10 offset:56320
    v_mfma_f32_16x16x32_bf16 v[124:127], a[36:39], a[8:11], v[124:127]
    ds_read_b64_tr_b16 a[6:7], v10 offset:58880
    v_mfma_f32_16x16x32_bf16 v[128:131], a[32:35], a[12:15], v[128:131]
    ds_read_b64_tr_b16 a[8:9], v8 offset:51200
    v_mfma_f32_16x16x32_bf16 v[132:135], a[36:39], a[12:15], v[132:135]
    ds_read_b64_tr_b16 a[10:11], v8 offset:53760
    s_waitcnt lgkmcnt(6)
    v_mfma_f32_16x16x32_bf16 v[136:139], a[32:35], a[16:19], v[136:139]
    ds_read_b64_tr_b16 a[12:13], v8 offset:51240
    v_mfma_f32_16x16x32_bf16 v[140:143], a[36:39], a[16:19], v[140:143]
    ds_read_b64_tr_b16 a[14:15], v8 offset:53800
    v_mfma_f32_16x16x32_bf16 v[144:147], a[32:35], a[20:23], v[144:147]
    ds_read_b64_tr_b16 a[16:17], v8 offset:51280
    v_mfma_f32_16x16x32_bf16 v[148:151], a[36:39], a[20:23], v[148:151]
    ds_read_b64_tr_b16 a[18:19], v8 offset:53840
    s_waitcnt lgkmcnt(6)
    v_mfma_f32_16x16x32_bf16 v[168:171], a[60:63], a[0:3], v[168:171]
    ds_read_b64_tr_b16 a[20:21], v8 offset:51320
    ds_read_b64_tr_b16 a[22:23], v8 offset:53880
    v_mfma_f32_16x16x32_bf16 v[152:155], a[32:35], a[4:7], v[152:155]
    ds_read_b64_tr_b16 a[0:1], v12 offset:51200
    v_mfma_f32_16x16x32_bf16 v[156:159], a[36:39], a[4:7], v[156:159]
    ds_read_b64_tr_b16 a[2:3], v12 offset:53760
    v_mfma_f32_16x16x32_bf16 v[172:175], a[60:63], a[4:7], v[172:175]
    s_waitcnt lgkmcnt(6)
    v_mfma_f32_16x16x32_bf16 v[40:43], a[8:11], a[32:35], v[40:43]
    ds_read_b64_tr_b16 a[4:5], v10 offset:51200
    v_mfma_f32_16x16x32_bf16 v[60:63], a[8:11], a[36:39], v[60:63]
    ds_read_b64_tr_b16 a[6:7], v10 offset:53760
    s_barrier
    v_mfma_f32_16x16x32_bf16 v[44:47], a[12:15], a[32:35], v[44:47]
    ds_read_b64_tr_b16 a[8:9], v9 offset:0
    ds_read_b128 a[40:43], v4 offset:16384
    v_mfma_f32_16x16x32_bf16 v[64:67], a[12:15], a[36:39], v[64:67]
    ds_read_b64_tr_b16 a[10:11], v9 offset:2560
    ds_read_b128 a[44:47], v4 offset:18432
    s_waitcnt lgkmcnt(8)
    v_mfma_f32_16x16x32_bf16 v[48:51], a[16:19], a[32:35], v[48:51]
    ds_read_b64_tr_b16 a[12:13], v9 offset:40
    ds_read_b128 a[64:67], v6 offset:4096
    v_mfma_f32_16x16x32_bf16 v[68:71], a[16:19], a[36:39], v[68:71]
    ds_read_b64_tr_b16 a[14:15], v9 offset:2600
    ds_read_b128 a[48:51], v5 offset:16384
    v_mfma_f32_16x16x32_bf16 v[52:55], a[20:23], a[32:35], v[52:55]
    ds_read_b64_tr_b16 a[16:17], v9 offset:80
    ds_read_b128 a[52:55], v5 offset:18432
    v_mfma_f32_16x16x32_bf16 v[72:75], a[20:23], a[36:39], v[72:75]
    ds_read_b64_tr_b16 a[18:19], v9 offset:2640
    ds_read_b128 a[68:71], v7 offset:4096
    s_waitcnt lgkmcnt(12)
    v_mfma_f32_16x16x32_bf16 v[160:163], a[0:3], a[60:63], v[160:163]
    ds_read_b64_tr_b16 a[20:21], v9 offset:120
    ds_read_b64_tr_b16 a[22:23], v9 offset:2680
    v_mfma_f32_16x16x32_bf16 v[56:59], a[4:7], a[32:35], v[56:59]
    ds_read_b64_tr_b16 a[0:1], v11 offset:0
    v_mfma_f32_16x16x32_bf16 v[76:79], a[4:7], a[36:39], v[76:79]
    ds_read_b64_tr_b16 a[2:3], v11 offset:2560
    v_mfma_f32_16x16x32_bf16 v[164:167], a[4:7], a[60:63], v[164:167]
    s_waitcnt lgkmcnt(4)
    v_mfma_f32_16x16x32_bf16 v[80:83], a[8:11], a[40:43], v[80:83]
    ds_read_b64_tr_b16 a[4:5], v9 offset:10240
    v_mfma_f32_16x16x32_bf16 v[100:103], a[8:11], a[44:47], v[100:103]
    ds_read_b64_tr_b16 a[6:7], v9 offset:12800
    v_mfma_f32_16x16x32_bf16 v[84:87], a[12:15], a[40:43], v[84:87]
    ds_read_b64_tr_b16 a[8:9], v9 offset:10280
    v_mfma_f32_16x16x32_bf16 v[104:107], a[12:15], a[44:47], v[104:107]
    ds_read_b64_tr_b16 a[10:11], v9 offset:12840
    s_waitcnt lgkmcnt(6)
    v_mfma_f32_16x16x32_bf16 v[88:91], a[16:19], a[40:43], v[88:91]
    ds_read_b64_tr_b16 a[12:13], v9 offset:10320
    v_mfma_f32_16x16x32_bf16 v[108:111], a[16:19], a[44:47], v[108:111]
    ds_read_b64_tr_b16 a[14:15], v9 offset:12880
    v_mfma_f32_16x16x32_bf16 v[92:95], a[20:23], a[40:43], v[92:95]
    ds_read_b64_tr_b16 a[16:17], v9 offset:10360
    v_mfma_f32_16x16x32_bf16 v[112:115], a[20:23], a[44:47], v[112:115]
    ds_read_b64_tr_b16 a[18:19], v9 offset:12920
    s_waitcnt lgkmcnt(6)
    v_mfma_f32_16x16x32_bf16 v[96:99], a[0:3], a[40:43], v[96:99]
    ds_read_b64_tr_b16 a[20:21], v13 offset:10240
    v_mfma_f32_16x16x32_bf16 v[116:119], a[0:3], a[44:47], v[116:119]
    ds_read_b64_tr_b16 a[22:23], v13 offset:12800
    v_mfma_f32_16x16x32_bf16 v[120:123], a[40:43], a[4:7], v[120:123]
    ds_read_b64_tr_b16 a[0:1], v11 offset:10240
    v_mfma_f32_16x16x32_bf16 v[124:127], a[44:47], a[4:7], v[124:127]
    ds_read_b64_tr_b16 a[2:3], v11 offset:12800
    s_waitcnt lgkmcnt(6)
    v_mfma_f32_16x16x32_bf16 v[128:131], a[40:43], a[8:11], v[128:131]
    ds_read_b64_tr_b16 a[4:5], v9 offset:5120
    v_mfma_f32_16x16x32_bf16 v[132:135], a[44:47], a[8:11], v[132:135]
    ds_read_b64_tr_b16 a[6:7], v9 offset:7680
    v_mfma_f32_16x16x32_bf16 v[136:139], a[40:43], a[12:15], v[136:139]
    ds_read_b64_tr_b16 a[8:9], v9 offset:5160
    v_mfma_f32_16x16x32_bf16 v[140:143], a[44:47], a[12:15], v[140:143]
    ds_read_b64_tr_b16 a[10:11], v9 offset:7720
    s_waitcnt lgkmcnt(6)
    v_mfma_f32_16x16x32_bf16 v[144:147], a[40:43], a[16:19], v[144:147]
    ds_read_b64_tr_b16 a[12:13], v9 offset:5200
    v_mfma_f32_16x16x32_bf16 v[148:151], a[44:47], a[16:19], v[148:151]
    ds_read_b64_tr_b16 a[14:15], v9 offset:7760
    v_mfma_f32_16x16x32_bf16 v[168:171], a[64:67], a[20:23], v[168:171]
    ds_read_b64_tr_b16 a[16:17], v9 offset:5240
    ds_read_b64_tr_b16 a[18:19], v9 offset:7800
    s_waitcnt lgkmcnt(6)
    v_mfma_f32_16x16x32_bf16 v[152:155], a[40:43], a[0:3], v[152:155]
    ds_read_b64_tr_b16 a[20:21], v13 offset:5120
    v_mfma_f32_16x16x32_bf16 v[156:159], a[44:47], a[0:3], v[156:159]
    ds_read_b64_tr_b16 a[22:23], v13 offset:7680
    v_mfma_f32_16x16x32_bf16 v[172:175], a[64:67], a[0:3], v[172:175]
    v_mfma_f32_16x16x32_bf16 v[40:43], a[4:7], a[40:43], v[40:43]
    ds_read_b64_tr_b16 a[0:1], v11 offset:5120
    v_mfma_f32_16x16x32_bf16 v[60:63], a[4:7], a[44:47], v[60:63]
    ds_read_b64_tr_b16 a[2:3], v11 offset:7680
    s_barrier
    s_waitcnt lgkmcnt(6)
    v_mfma_f32_16x16x32_bf16 v[44:47], a[8:11], a[40:43], v[44:47]
    ds_read_b64_tr_b16 a[4:5], v9 offset:15360
    v_mfma_f32_16x16x32_bf16 v[64:67], a[8:11], a[44:47], v[64:67]
    ds_read_b64_tr_b16 a[6:7], v9 offset:17920
    v_mfma_f32_16x16x32_bf16 v[48:51], a[12:15], a[40:43], v[48:51]
    ds_read_b64_tr_b16 a[8:9], v9 offset:15400
    v_mfma_f32_16x16x32_bf16 v[68:71], a[12:15], a[44:47], v[68:71]
    ds_read_b64_tr_b16 a[10:11], v9 offset:17960
    s_waitcnt lgkmcnt(6)
    v_mfma_f32_16x16x32_bf16 v[52:55], a[16:19], a[40:43], v[52:55]
    ds_read_b64_tr_b16 a[12:13], v9 offset:15440
    v_mfma_f32_16x16x32_bf16 v[72:75], a[16:19], a[44:47], v[72:75]
    ds_read_b64_tr_b16 a[14:15], v9 offset:18000
    v_mfma_f32_16x16x32_bf16 v[160:163], a[20:23], a[64:67], v[160:163]
    ds_read_b64_tr_b16 a[16:17], v9 offset:15480
    ds_read_b64_tr_b16 a[18:19], v9 offset:18040
    s_waitcnt lgkmcnt(6)
    v_mfma_f32_16x16x32_bf16 v[56:59], a[0:3], a[40:43], v[56:59]
    ds_read_b64_tr_b16 a[20:21], v11 offset:15360
    v_mfma_f32_16x16x32_bf16 v[76:79], a[0:3], a[44:47], v[76:79]
    ds_read_b64_tr_b16 a[22:23], v11 offset:17920
    v_mfma_f32_16x16x32_bf16 v[164:167], a[0:3], a[64:67], v[164:167]
    v_mfma_f32_16x16x32_bf16 v[80:83], a[4:7], a[48:51], v[80:83]
    ds_read_b64_tr_b16 a[0:1], v9 offset:25600
    v_mfma_f32_16x16x32_bf16 v[100:103], a[4:7], a[52:55], v[100:103]
    ds_read_b64_tr_b16 a[2:3], v9 offset:28160
    s_waitcnt lgkmcnt(6)
    v_mfma_f32_16x16x32_bf16 v[84:87], a[8:11], a[48:51], v[84:87]
    ds_read_b64_tr_b16 a[4:5], v9 offset:25640
    v_mfma_f32_16x16x32_bf16 v[104:107], a[8:11], a[52:55], v[104:107]
    ds_read_b64_tr_b16 a[6:7], v9 offset:28200
    v_mfma_f32_16x16x32_bf16 v[88:91], a[12:15], a[48:51], v[88:91]
    ds_read_b64_tr_b16 a[8:9], v9 offset:25680
    v_mfma_f32_16x16x32_bf16 v[108:111], a[12:15], a[52:55], v[108:111]
    ds_read_b64_tr_b16 a[10:11], v9 offset:28240
    s_waitcnt lgkmcnt(6)
    v_mfma_f32_16x16x32_bf16 v[92:95], a[16:19], a[48:51], v[92:95]
    ds_read_b64_tr_b16 a[12:13], v9 offset:25720
    v_mfma_f32_16x16x32_bf16 v[112:115], a[16:19], a[52:55], v[112:115]
    ds_read_b64_tr_b16 a[14:15], v9 offset:28280
    v_mfma_f32_16x16x32_bf16 v[96:99], a[20:23], a[48:51], v[96:99]
    ds_read_b64_tr_b16 a[16:17], v13 offset:25600
    v_mfma_f32_16x16x32_bf16 v[116:119], a[20:23], a[52:55], v[116:119]
    ds_read_b64_tr_b16 a[18:19], v13 offset:28160
    s_waitcnt lgkmcnt(6)
    v_mfma_f32_16x16x32_bf16 v[120:123], a[48:51], a[0:3], v[120:123]
    ds_read_b64_tr_b16 a[20:21], v11 offset:25600
    v_mfma_f32_16x16x32_bf16 v[124:127], a[52:55], a[0:3], v[124:127]
    ds_read_b64_tr_b16 a[22:23], v11 offset:28160
    v_mfma_f32_16x16x32_bf16 v[128:131], a[48:51], a[4:7], v[128:131]
    ds_read_b64_tr_b16 a[0:1], v9 offset:20480
    v_mfma_f32_16x16x32_bf16 v[132:135], a[52:55], a[4:7], v[132:135]
    ds_read_b64_tr_b16 a[2:3], v9 offset:23040
    s_waitcnt lgkmcnt(6)
    v_mfma_f32_16x16x32_bf16 v[136:139], a[48:51], a[8:11], v[136:139]
    ds_read_b64_tr_b16 a[4:5], v9 offset:20520
    v_mfma_f32_16x16x32_bf16 v[140:143], a[52:55], a[8:11], v[140:143]
    ds_read_b64_tr_b16 a[6:7], v9 offset:23080
    v_mfma_f32_16x16x32_bf16 v[144:147], a[48:51], a[12:15], v[144:147]
    ds_read_b64_tr_b16 a[8:9], v9 offset:20560
    v_mfma_f32_16x16x32_bf16 v[148:151], a[52:55], a[12:15], v[148:151]
    ds_read_b64_tr_b16 a[10:11], v9 offset:23120
    s_waitcnt lgkmcnt(6)
    v_mfma_f32_16x16x32_bf16 v[168:171], a[68:71], a[16:19], v[168:171]
    ds_read_b64_tr_b16 a[12:13], v9 offset:20600
    ds_read_b64_tr_b16 a[14:15], v9 offset:23160
    v_mfma_f32_16x16x32_bf16 v[152:155], a[48:51], a[20:23], v[152:155]
    ds_read_b64_tr_b16 a[16:17], v13 offset:20480
    v_mfma_f32_16x16x32_bf16 v[156:159], a[52:55], a[20:23], v[156:159]
    ds_read_b64_tr_b16 a[18:19], v13 offset:23040
    v_mfma_f32_16x16x32_bf16 v[172:175], a[68:71], a[20:23], v[172:175]
    s_waitcnt lgkmcnt(6)
    v_mfma_f32_16x16x32_bf16 v[40:43], a[0:3], a[48:51], v[40:43]
    ds_read_b64_tr_b16 a[20:21], v11 offset:20480
    v_mfma_f32_16x16x32_bf16 v[60:63], a[0:3], a[52:55], v[60:63]
    ds_read_b64_tr_b16 a[22:23], v11 offset:23040
    s_barrier
    v_mfma_f32_16x16x32_bf16 v[44:47], a[4:7], a[48:51], v[44:47]
    ds_read_b64_tr_b16 a[0:1], v8 offset:0
    ds_read_b128 a[24:27], v4 offset:40960
    v_mfma_f32_16x16x32_bf16 v[64:67], a[4:7], a[52:55], v[64:67]
    ds_read_b64_tr_b16 a[2:3], v8 offset:2560
    ds_read_b128 a[28:31], v4 offset:43008
    s_waitcnt lgkmcnt(8)
    v_mfma_f32_16x16x32_bf16 v[48:51], a[8:11], a[48:51], v[48:51]
    ds_read_b64_tr_b16 a[4:5], v8 offset:40
    ds_read_b128 a[56:59], v6 offset:0
    v_mfma_f32_16x16x32_bf16 v[68:71], a[8:11], a[52:55], v[68:71]
    ds_read_b64_tr_b16 a[6:7], v8 offset:2600
    ds_read_b128 a[32:35], v5 offset:40960
    v_mfma_f32_16x16x32_bf16 v[52:55], a[12:15], a[48:51], v[52:55]
    ds_read_b64_tr_b16 a[8:9], v8 offset:80
    ds_read_b128 a[36:39], v5 offset:43008
    v_mfma_f32_16x16x32_bf16 v[72:75], a[12:15], a[52:55], v[72:75]
    ds_read_b64_tr_b16 a[10:11], v8 offset:2640
    ds_read_b128 a[60:63], v7 offset:0
    s_waitcnt lgkmcnt(12)
    v_mfma_f32_16x16x32_bf16 v[160:163], a[16:19], a[68:71], v[160:163]
    ds_read_b64_tr_b16 a[12:13], v8 offset:120
    ds_read_b64_tr_b16 a[14:15], v8 offset:2680
    v_mfma_f32_16x16x32_bf16 v[56:59], a[20:23], a[48:51], v[56:59]
    ds_read_b64_tr_b16 a[16:17], v10 offset:0
    v_mfma_f32_16x16x32_bf16 v[76:79], a[20:23], a[52:55], v[76:79]
    ds_read_b64_tr_b16 a[18:19], v10 offset:2560
    v_mfma_f32_16x16x32_bf16 v[164:167], a[20:23], a[68:71], v[164:167]
    s_waitcnt lgkmcnt(4)
    v_mfma_f32_16x16x32_bf16 v[80:83], a[0:3], a[24:27], v[80:83]
    ds_read_b64_tr_b16 a[20:21], v8 offset:10240
    v_mfma_f32_16x16x32_bf16 v[100:103], a[0:3], a[28:31], v[100:103]
    ds_read_b64_tr_b16 a[22:23], v8 offset:12800
    v_mfma_f32_16x16x32_bf16 v[84:87], a[4:7], a[24:27], v[84:87]
    ds_read_b64_tr_b16 a[0:1], v8 offset:10280
    v_mfma_f32_16x16x32_bf16 v[104:107], a[4:7], a[28:31], v[104:107]
    ds_read_b64_tr_b16 a[2:3], v8 offset:12840
    s_waitcnt lgkmcnt(6)
    v_mfma_f32_16x16x32_bf16 v[88:91], a[8:11], a[24:27], v[88:91]
    ds_read_b64_tr_b16 a[4:5], v8 offset:10320
    v_mfma_f32_16x16x32_bf16 v[108:111], a[8:11], a[28:31], v[108:111]
    ds_read_b64_tr_b16 a[6:7], v8 offset:12880
    v_mfma_f32_16x16x32_bf16 v[92:95], a[12:15], a[24:27], v[92:95]
    ds_read_b64_tr_b16 a[8:9], v8 offset:10360
    v_mfma_f32_16x16x32_bf16 v[112:115], a[12:15], a[28:31], v[112:115]
    ds_read_b64_tr_b16 a[10:11], v8 offset:12920
    s_waitcnt lgkmcnt(6)
    v_mfma_f32_16x16x32_bf16 v[96:99], a[16:19], a[24:27], v[96:99]
    ds_read_b64_tr_b16 a[12:13], v12 offset:10240
    v_mfma_f32_16x16x32_bf16 v[116:119], a[16:19], a[28:31], v[116:119]
    ds_read_b64_tr_b16 a[14:15], v12 offset:12800
    v_mfma_f32_16x16x32_bf16 v[120:123], a[24:27], a[20:23], v[120:123]
    ds_read_b64_tr_b16 a[16:17], v10 offset:10240
    v_mfma_f32_16x16x32_bf16 v[124:127], a[28:31], a[20:23], v[124:127]
    ds_read_b64_tr_b16 a[18:19], v10 offset:12800
    s_waitcnt lgkmcnt(6)
    v_mfma_f32_16x16x32_bf16 v[128:131], a[24:27], a[0:3], v[128:131]
    ds_read_b64_tr_b16 a[20:21], v8 offset:5120
    v_mfma_f32_16x16x32_bf16 v[132:135], a[28:31], a[0:3], v[132:135]
    ds_read_b64_tr_b16 a[22:23], v8 offset:7680
    v_mfma_f32_16x16x32_bf16 v[136:139], a[24:27], a[4:7], v[136:139]
    ds_read_b64_tr_b16 a[0:1], v8 offset:5160
    v_mfma_f32_16x16x32_bf16 v[140:143], a[28:31], a[4:7], v[140:143]
    ds_read_b64_tr_b16 a[2:3], v8 offset:7720
    s_waitcnt lgkmcnt(6)
    v_mfma_f32_16x16x32_bf16 v[144:147], a[24:27], a[8:11], v[144:147]
    ds_read_b64_tr_b16 a[4:5], v8 offset:5200
    v_mfma_f32_16x16x32_bf16 v[148:151], a[28:31], a[8:11], v[148:151]
    ds_read_b64_tr_b16 a[6:7], v8 offset:7760
    v_mfma_f32_16x16x32_bf16 v[168:171], a[56:59], a[12:15], v[168:171]
    ds_read_b64_tr_b16 a[8:9], v8 offset:5240
    ds_read_b64_tr_b16 a[10:11], v8 offset:7800
    s_waitcnt lgkmcnt(6)
    v_mfma_f32_16x16x32_bf16 v[152:155], a[24:27], a[16:19], v[152:155]
    ds_read_b64_tr_b16 a[12:13], v12 offset:5120
    v_mfma_f32_16x16x32_bf16 v[156:159], a[28:31], a[16:19], v[156:159]
    ds_read_b64_tr_b16 a[14:15], v12 offset:7680
    v_mfma_f32_16x16x32_bf16 v[172:175], a[56:59], a[16:19], v[172:175]
    v_mfma_f32_16x16x32_bf16 v[40:43], a[20:23], a[24:27], v[40:43]
    ds_read_b64_tr_b16 a[16:17], v10 offset:5120
    v_mfma_f32_16x16x32_bf16 v[60:63], a[20:23], a[28:31], v[60:63]
    ds_read_b64_tr_b16 a[18:19], v10 offset:7680
    s_barrier
    s_waitcnt lgkmcnt(6)
    v_mfma_f32_16x16x32_bf16 v[44:47], a[0:3], a[24:27], v[44:47]
    ds_read_b64_tr_b16 a[20:21], v8 offset:15360
    v_mfma_f32_16x16x32_bf16 v[64:67], a[0:3], a[28:31], v[64:67]
    ds_read_b64_tr_b16 a[22:23], v8 offset:17920
    v_mfma_f32_16x16x32_bf16 v[48:51], a[4:7], a[24:27], v[48:51]
    ds_read_b64_tr_b16 a[0:1], v8 offset:15400
    v_mfma_f32_16x16x32_bf16 v[68:71], a[4:7], a[28:31], v[68:71]
    ds_read_b64_tr_b16 a[2:3], v8 offset:17960
    s_waitcnt lgkmcnt(6)
    v_mfma_f32_16x16x32_bf16 v[52:55], a[8:11], a[24:27], v[52:55]
    ds_read_b64_tr_b16 a[4:5], v8 offset:15440
    v_mfma_f32_16x16x32_bf16 v[72:75], a[8:11], a[28:31], v[72:75]
    ds_read_b64_tr_b16 a[6:7], v8 offset:18000
    v_mfma_f32_16x16x32_bf16 v[160:163], a[12:15], a[56:59], v[160:163]
    ds_read_b64_tr_b16 a[8:9], v8 offset:15480
    ds_read_b64_tr_b16 a[10:11], v8 offset:18040
    s_waitcnt lgkmcnt(6)
    v_mfma_f32_16x16x32_bf16 v[56:59], a[16:19], a[24:27], v[56:59]
    ds_read_b64_tr_b16 a[12:13], v10 offset:15360
    v_mfma_f32_16x16x32_bf16 v[76:79], a[16:19], a[28:31], v[76:79]
    ds_read_b64_tr_b16 a[14:15], v10 offset:17920
    v_mfma_f32_16x16x32_bf16 v[164:167], a[16:19], a[56:59], v[164:167]
    v_mfma_f32_16x16x32_bf16 v[80:83], a[20:23], a[32:35], v[80:83]
    ds_read_b64_tr_b16 a[16:17], v8 offset:25600
    v_mfma_f32_16x16x32_bf16 v[100:103], a[20:23], a[36:39], v[100:103]
    ds_read_b64_tr_b16 a[18:19], v8 offset:28160
    s_waitcnt lgkmcnt(6)
    v_mfma_f32_16x16x32_bf16 v[84:87], a[0:3], a[32:35], v[84:87]
    ds_read_b64_tr_b16 a[20:21], v8 offset:25640
    v_mfma_f32_16x16x32_bf16 v[104:107], a[0:3], a[36:39], v[104:107]
    ds_read_b64_tr_b16 a[22:23], v8 offset:28200
    v_mfma_f32_16x16x32_bf16 v[88:91], a[4:7], a[32:35], v[88:91]
    ds_read_b64_tr_b16 a[0:1], v8 offset:25680
    v_mfma_f32_16x16x32_bf16 v[108:111], a[4:7], a[36:39], v[108:111]
    ds_read_b64_tr_b16 a[2:3], v8 offset:28240
    s_waitcnt lgkmcnt(6)
    v_mfma_f32_16x16x32_bf16 v[92:95], a[8:11], a[32:35], v[92:95]
    ds_read_b64_tr_b16 a[4:5], v8 offset:25720
    v_mfma_f32_16x16x32_bf16 v[112:115], a[8:11], a[36:39], v[112:115]
    ds_read_b64_tr_b16 a[6:7], v8 offset:28280
    v_mfma_f32_16x16x32_bf16 v[96:99], a[12:15], a[32:35], v[96:99]
    ds_read_b64_tr_b16 a[8:9], v12 offset:25600
    v_mfma_f32_16x16x32_bf16 v[116:119], a[12:15], a[36:39], v[116:119]
    ds_read_b64_tr_b16 a[10:11], v12 offset:28160
    s_waitcnt lgkmcnt(6)
    v_mfma_f32_16x16x32_bf16 v[120:123], a[32:35], a[16:19], v[120:123]
    ds_read_b64_tr_b16 a[12:13], v10 offset:25600
    v_mfma_f32_16x16x32_bf16 v[124:127], a[36:39], a[16:19], v[124:127]
    ds_read_b64_tr_b16 a[14:15], v10 offset:28160
    v_mfma_f32_16x16x32_bf16 v[128:131], a[32:35], a[20:23], v[128:131]
    ds_read_b64_tr_b16 a[16:17], v8 offset:20480
    v_mfma_f32_16x16x32_bf16 v[132:135], a[36:39], a[20:23], v[132:135]
    ds_read_b64_tr_b16 a[18:19], v8 offset:23040
    s_waitcnt lgkmcnt(6)
    v_mfma_f32_16x16x32_bf16 v[136:139], a[32:35], a[0:3], v[136:139]
    ds_read_b64_tr_b16 a[20:21], v8 offset:20520
    v_mfma_f32_16x16x32_bf16 v[140:143], a[36:39], a[0:3], v[140:143]
    ds_read_b64_tr_b16 a[22:23], v8 offset:23080
    v_mfma_f32_16x16x32_bf16 v[144:147], a[32:35], a[4:7], v[144:147]
    ds_read_b64_tr_b16 a[0:1], v8 offset:20560
    v_mfma_f32_16x16x32_bf16 v[148:151], a[36:39], a[4:7], v[148:151]
    ds_read_b64_tr_b16 a[2:3], v8 offset:23120
    s_waitcnt lgkmcnt(6)
    v_mfma_f32_16x16x32_bf16 v[168:171], a[60:63], a[8:11], v[168:171]
    ds_read_b64_tr_b16 a[4:5], v8 offset:20600
    ds_read_b64_tr_b16 a[6:7], v8 offset:23160
    v_mfma_f32_16x16x32_bf16 v[152:155], a[32:35], a[12:15], v[152:155]
    ds_read_b64_tr_b16 a[8:9], v12 offset:20480
    v_mfma_f32_16x16x32_bf16 v[156:159], a[36:39], a[12:15], v[156:159]
    ds_read_b64_tr_b16 a[10:11], v12 offset:23040
    v_mfma_f32_16x16x32_bf16 v[172:175], a[60:63], a[12:15], v[172:175]
    s_waitcnt lgkmcnt(6)
    v_mfma_f32_16x16x32_bf16 v[40:43], a[16:19], a[32:35], v[40:43]
    ds_read_b64_tr_b16 a[12:13], v10 offset:20480
    v_mfma_f32_16x16x32_bf16 v[60:63], a[16:19], a[36:39], v[60:63]
    ds_read_b64_tr_b16 a[14:15], v10 offset:23040
    s_barrier
    v_mfma_f32_16x16x32_bf16 v[44:47], a[20:23], a[32:35], v[44:47]
    ds_read_b64_tr_b16 a[16:17], v8 offset:30720
    ds_read_b128 a[40:43], v4 offset:0
    v_mfma_f32_16x16x32_bf16 v[64:67], a[20:23], a[36:39], v[64:67]
    ds_read_b64_tr_b16 a[18:19], v8 offset:33280
    ds_read_b128 a[44:47], v4 offset:2048
    s_waitcnt lgkmcnt(8)
    v_mfma_f32_16x16x32_bf16 v[48:51], a[0:3], a[32:35], v[48:51]
    ds_read_b64_tr_b16 a[20:21], v8 offset:30760
    ds_read_b128 a[64:67], v6 offset:2048
    v_mfma_f32_16x16x32_bf16 v[68:71], a[0:3], a[36:39], v[68:71]
    ds_read_b64_tr_b16 a[22:23], v8 offset:33320
    ds_read_b128 a[48:51], v5 offset:0
    v_mfma_f32_16x16x32_bf16 v[52:55], a[4:7], a[32:35], v[52:55]
    ds_read_b64_tr_b16 a[0:1], v8 offset:30800
    ds_read_b128 a[52:55], v5 offset:2048
    v_mfma_f32_16x16x32_bf16 v[72:75], a[4:7], a[36:39], v[72:75]
    ds_read_b64_tr_b16 a[2:3], v8 offset:33360
    ds_read_b128 a[68:71], v7 offset:2048
    s_waitcnt lgkmcnt(12)
    v_mfma_f32_16x16x32_bf16 v[160:163], a[8:11], a[60:63], v[160:163]
    ds_read_b64_tr_b16 a[4:5], v8 offset:30840
    ds_read_b64_tr_b16 a[6:7], v8 offset:33400
    v_mfma_f32_16x16x32_bf16 v[56:59], a[12:15], a[32:35], v[56:59]
    ds_read_b64_tr_b16 a[8:9], v10 offset:30720
    v_mfma_f32_16x16x32_bf16 v[76:79], a[12:15], a[36:39], v[76:79]
    ds_read_b64_tr_b16 a[10:11], v10 offset:33280
    v_mfma_f32_16x16x32_bf16 v[164:167], a[12:15], a[60:63], v[164:167]
    s_waitcnt lgkmcnt(4)
    v_mfma_f32_16x16x32_bf16 v[80:83], a[16:19], a[40:43], v[80:83]
    ds_read_b64_tr_b16 a[12:13], v8 offset:40960
    v_mfma_f32_16x16x32_bf16 v[100:103], a[16:19], a[44:47], v[100:103]
    ds_read_b64_tr_b16 a[14:15], v8 offset:43520
    v_mfma_f32_16x16x32_bf16 v[84:87], a[20:23], a[40:43], v[84:87]
    ds_read_b64_tr_b16 a[16:17], v8 offset:41000
    v_mfma_f32_16x16x32_bf16 v[104:107], a[20:23], a[44:47], v[104:107]
    ds_read_b64_tr_b16 a[18:19], v8 offset:43560
    s_waitcnt lgkmcnt(6)
    v_mfma_f32_16x16x32_bf16 v[88:91], a[0:3], a[40:43], v[88:91]
    ds_read_b64_tr_b16 a[20:21], v8 offset:41040
    v_mfma_f32_16x16x32_bf16 v[108:111], a[0:3], a[44:47], v[108:111]
    ds_read_b64_tr_b16 a[22:23], v8 offset:43600
    v_mfma_f32_16x16x32_bf16 v[92:95], a[4:7], a[40:43], v[92:95]
    ds_read_b64_tr_b16 a[0:1], v8 offset:41080
    v_mfma_f32_16x16x32_bf16 v[112:115], a[4:7], a[44:47], v[112:115]
    ds_read_b64_tr_b16 a[2:3], v8 offset:43640
    s_waitcnt lgkmcnt(6)
    v_mfma_f32_16x16x32_bf16 v[96:99], a[8:11], a[40:43], v[96:99]
    ds_read_b64_tr_b16 a[4:5], v12 offset:40960
    v_mfma_f32_16x16x32_bf16 v[116:119], a[8:11], a[44:47], v[116:119]
    ds_read_b64_tr_b16 a[6:7], v12 offset:43520
    v_mfma_f32_16x16x32_bf16 v[120:123], a[40:43], a[12:15], v[120:123]
    ds_read_b64_tr_b16 a[8:9], v10 offset:40960
    v_mfma_f32_16x16x32_bf16 v[124:127], a[44:47], a[12:15], v[124:127]
    ds_read_b64_tr_b16 a[10:11], v10 offset:43520
    s_waitcnt lgkmcnt(6)
    v_mfma_f32_16x16x32_bf16 v[128:131], a[40:43], a[16:19], v[128:131]
    ds_read_b64_tr_b16 a[12:13], v8 offset:35840
    v_mfma_f32_16x16x32_bf16 v[132:135], a[44:47], a[16:19], v[132:135]
    ds_read_b64_tr_b16 a[14:15], v8 offset:38400
    v_mfma_f32_16x16x32_bf16 v[136:139], a[40:43], a[20:23], v[136:139]
    ds_read_b64_tr_b16 a[16:17], v8 offset:35880
    v_mfma_f32_16x16x32_bf16 v[140:143], a[44:47], a[20:23], v[140:143]
    ds_read_b64_tr_b16 a[18:19], v8 offset:38440
    s_waitcnt lgkmcnt(6)
    v_mfma_f32_16x16x32_bf16 v[144:147], a[40:43], a[0:3], v[144:147]
    ds_read_b64_tr_b16 a[20:21], v8 offset:35920
    v_mfma_f32_16x16x32_bf16 v[148:151], a[44:47], a[0:3], v[148:151]
    ds_read_b64_tr_b16 a[22:23], v8 offset:38480
    v_mfma_f32_16x16x32_bf16 v[168:171], a[64:67], a[4:7], v[168:171]
    ds_read_b64_tr_b16 a[0:1], v8 offset:35960
    ds_read_b64_tr_b16 a[2:3], v8 offset:38520
    s_waitcnt lgkmcnt(6)
    v_mfma_f32_16x16x32_bf16 v[152:155], a[40:43], a[8:11], v[152:155]
    ds_read_b64_tr_b16 a[4:5], v12 offset:35840
    v_mfma_f32_16x16x32_bf16 v[156:159], a[44:47], a[8:11], v[156:159]
    ds_read_b64_tr_b16 a[6:7], v12 offset:38400
    v_mfma_f32_16x16x32_bf16 v[172:175], a[64:67], a[8:11], v[172:175]
    v_mfma_f32_16x16x32_bf16 v[40:43], a[12:15], a[40:43], v[40:43]
    ds_read_b64_tr_b16 a[8:9], v10 offset:35840
    v_mfma_f32_16x16x32_bf16 v[60:63], a[12:15], a[44:47], v[60:63]
    ds_read_b64_tr_b16 a[10:11], v10 offset:38400
    s_barrier
    s_waitcnt lgkmcnt(6)
    v_mfma_f32_16x16x32_bf16 v[44:47], a[16:19], a[40:43], v[44:47]
    ds_read_b64_tr_b16 a[12:13], v8 offset:46080
    v_mfma_f32_16x16x32_bf16 v[64:67], a[16:19], a[44:47], v[64:67]
    ds_read_b64_tr_b16 a[14:15], v8 offset:48640
    v_mfma_f32_16x16x32_bf16 v[48:51], a[20:23], a[40:43], v[48:51]
    ds_read_b64_tr_b16 a[16:17], v8 offset:46120
    v_mfma_f32_16x16x32_bf16 v[68:71], a[20:23], a[44:47], v[68:71]
    ds_read_b64_tr_b16 a[18:19], v8 offset:48680
    s_waitcnt lgkmcnt(6)
    v_mfma_f32_16x16x32_bf16 v[52:55], a[0:3], a[40:43], v[52:55]
    ds_read_b64_tr_b16 a[20:21], v8 offset:46160
    v_mfma_f32_16x16x32_bf16 v[72:75], a[0:3], a[44:47], v[72:75]
    ds_read_b64_tr_b16 a[22:23], v8 offset:48720
    v_mfma_f32_16x16x32_bf16 v[160:163], a[4:7], a[64:67], v[160:163]
    ds_read_b64_tr_b16 a[0:1], v8 offset:46200
    ds_read_b64_tr_b16 a[2:3], v8 offset:48760
    s_waitcnt lgkmcnt(6)
    v_mfma_f32_16x16x32_bf16 v[56:59], a[8:11], a[40:43], v[56:59]
    ds_read_b64_tr_b16 a[4:5], v10 offset:46080
    v_mfma_f32_16x16x32_bf16 v[76:79], a[8:11], a[44:47], v[76:79]
    ds_read_b64_tr_b16 a[6:7], v10 offset:48640
    v_mfma_f32_16x16x32_bf16 v[164:167], a[8:11], a[64:67], v[164:167]
    v_mfma_f32_16x16x32_bf16 v[80:83], a[12:15], a[48:51], v[80:83]
    ds_read_b64_tr_b16 a[8:9], v8 offset:56320
    v_mfma_f32_16x16x32_bf16 v[100:103], a[12:15], a[52:55], v[100:103]
    ds_read_b64_tr_b16 a[10:11], v8 offset:58880
    s_waitcnt lgkmcnt(6)
    v_mfma_f32_16x16x32_bf16 v[84:87], a[16:19], a[48:51], v[84:87]
    ds_read_b64_tr_b16 a[12:13], v8 offset:56360
    v_mfma_f32_16x16x32_bf16 v[104:107], a[16:19], a[52:55], v[104:107]
    ds_read_b64_tr_b16 a[14:15], v8 offset:58920
    v_mfma_f32_16x16x32_bf16 v[88:91], a[20:23], a[48:51], v[88:91]
    ds_read_b64_tr_b16 a[16:17], v8 offset:56400
    v_mfma_f32_16x16x32_bf16 v[108:111], a[20:23], a[52:55], v[108:111]
    ds_read_b64_tr_b16 a[18:19], v8 offset:58960
    s_waitcnt lgkmcnt(6)
    v_mfma_f32_16x16x32_bf16 v[92:95], a[0:3], a[48:51], v[92:95]
    ds_read_b64_tr_b16 a[20:21], v8 offset:56440
    v_mfma_f32_16x16x32_bf16 v[112:115], a[0:3], a[52:55], v[112:115]
    ds_read_b64_tr_b16 a[22:23], v8 offset:59000
    v_mfma_f32_16x16x32_bf16 v[96:99], a[4:7], a[48:51], v[96:99]
    ds_read_b64_tr_b16 a[0:1], v12 offset:56320
    v_mfma_f32_16x16x32_bf16 v[116:119], a[4:7], a[52:55], v[116:119]
    ds_read_b64_tr_b16 a[2:3], v12 offset:58880
    s_waitcnt lgkmcnt(6)
    v_mfma_f32_16x16x32_bf16 v[120:123], a[48:51], a[8:11], v[120:123]
    ds_read_b64_tr_b16 a[4:5], v10 offset:56320
    v_mfma_f32_16x16x32_bf16 v[124:127], a[52:55], a[8:11], v[124:127]
    ds_read_b64_tr_b16 a[6:7], v10 offset:58880
    v_mfma_f32_16x16x32_bf16 v[128:131], a[48:51], a[12:15], v[128:131]
    ds_read_b64_tr_b16 a[8:9], v8 offset:51200
    v_mfma_f32_16x16x32_bf16 v[132:135], a[52:55], a[12:15], v[132:135]
    ds_read_b64_tr_b16 a[10:11], v8 offset:53760
    s_waitcnt lgkmcnt(6)
    v_mfma_f32_16x16x32_bf16 v[136:139], a[48:51], a[16:19], v[136:139]
    ds_read_b64_tr_b16 a[12:13], v8 offset:51240
    v_mfma_f32_16x16x32_bf16 v[140:143], a[52:55], a[16:19], v[140:143]
    ds_read_b64_tr_b16 a[14:15], v8 offset:53800
    v_mfma_f32_16x16x32_bf16 v[144:147], a[48:51], a[20:23], v[144:147]
    ds_read_b64_tr_b16 a[16:17], v8 offset:51280
    v_mfma_f32_16x16x32_bf16 v[148:151], a[52:55], a[20:23], v[148:151]
    ds_read_b64_tr_b16 a[18:19], v8 offset:53840
    s_waitcnt lgkmcnt(6)
    v_mfma_f32_16x16x32_bf16 v[168:171], a[68:71], a[0:3], v[168:171]
    ds_read_b64_tr_b16 a[20:21], v8 offset:51320
    ds_read_b64_tr_b16 a[22:23], v8 offset:53880
    v_mfma_f32_16x16x32_bf16 v[152:155], a[48:51], a[4:7], v[152:155]
    ds_read_b64_tr_b16 a[0:1], v12 offset:51200
    v_mfma_f32_16x16x32_bf16 v[156:159], a[52:55], a[4:7], v[156:159]
    ds_read_b64_tr_b16 a[2:3], v12 offset:53760
    v_mfma_f32_16x16x32_bf16 v[172:175], a[68:71], a[4:7], v[172:175]
    s_waitcnt lgkmcnt(6)
    v_mfma_f32_16x16x32_bf16 v[40:43], a[8:11], a[48:51], v[40:43]
    ds_read_b64_tr_b16 a[4:5], v10 offset:51200
    v_mfma_f32_16x16x32_bf16 v[60:63], a[8:11], a[52:55], v[60:63]
    ds_read_b64_tr_b16 a[6:7], v10 offset:53760
    s_barrier
    v_mfma_f32_16x16x32_bf16 v[44:47], a[12:15], a[48:51], v[44:47]
    ds_read_b64_tr_b16 a[8:9], v9 offset:10240
    ds_read_b128 a[24:27], v4 offset:16384
    v_mfma_f32_16x16x32_bf16 v[64:67], a[12:15], a[52:55], v[64:67]
    ds_read_b64_tr_b16 a[10:11], v9 offset:12800
    ds_read_b128 a[28:31], v4 offset:18432
    s_waitcnt lgkmcnt(8)
    v_mfma_f32_16x16x32_bf16 v[48:51], a[16:19], a[48:51], v[48:51]
    ds_read_b64_tr_b16 a[12:13], v9 offset:10280
    ds_read_b128 a[56:59], v6 offset:4096
    v_mfma_f32_16x16x32_bf16 v[68:71], a[16:19], a[52:55], v[68:71]
    ds_read_b64_tr_b16 a[14:15], v9 offset:12840
    ds_read_b128 a[32:35], v5 offset:16384
    v_mfma_f32_16x16x32_bf16 v[52:55], a[20:23], a[48:51], v[52:55]
    ds_read_b64_tr_b16 a[16:17], v9 offset:10320
    ds_read_b128 a[36:39], v5 offset:18432
    v_mfma_f32_16x16x32_bf16 v[72:75], a[20:23], a[52:55], v[72:75]
    ds_read_b64_tr_b16 a[18:19], v9 offset:12880
    ds_read_b128 a[60:63], v7 offset:4096
    s_waitcnt lgkmcnt(12)
    v_mfma_f32_16x16x32_bf16 v[160:163], a[0:3], a[68:71], v[160:163]
    ds_read_b64_tr_b16 a[20:21], v9 offset:10360
    ds_read_b64_tr_b16 a[22:23], v9 offset:12920
    v_mfma_f32_16x16x32_bf16 v[56:59], a[4:7], a[48:51], v[56:59]
    ds_read_b64_tr_b16 a[0:1], v13 offset:10240
    v_mfma_f32_16x16x32_bf16 v[76:79], a[4:7], a[52:55], v[76:79]
    ds_read_b64_tr_b16 a[2:3], v13 offset:12800
    v_mfma_f32_16x16x32_bf16 v[164:167], a[4:7], a[68:71], v[164:167]
    s_waitcnt lgkmcnt(4)
    v_mfma_f32_16x16x32_bf16 v[120:123], a[24:27], a[8:11], v[120:123]
    ds_read_b64_tr_b16 a[4:5], v11 offset:10240
    v_mfma_f32_16x16x32_bf16 v[124:127], a[28:31], a[8:11], v[124:127]
    ds_read_b64_tr_b16 a[6:7], v11 offset:12800
    v_mfma_f32_16x16x32_bf16 v[128:131], a[24:27], a[12:15], v[128:131]
    ds_read_b64_tr_b16 a[8:9], v9 offset:5120
    v_mfma_f32_16x16x32_bf16 v[132:135], a[28:31], a[12:15], v[132:135]
    ds_read_b64_tr_b16 a[10:11], v9 offset:7680
    s_waitcnt lgkmcnt(6)
    v_mfma_f32_16x16x32_bf16 v[136:139], a[24:27], a[16:19], v[136:139]
    ds_read_b64_tr_b16 a[12:13], v9 offset:5160
    v_mfma_f32_16x16x32_bf16 v[140:143], a[28:31], a[16:19], v[140:143]
    ds_read_b64_tr_b16 a[14:15], v9 offset:7720
    v_mfma_f32_16x16x32_bf16 v[144:147], a[24:27], a[20:23], v[144:147]
    ds_read_b64_tr_b16 a[16:17], v9 offset:5200
    v_mfma_f32_16x16x32_bf16 v[148:151], a[28:31], a[20:23], v[148:151]
    ds_read_b64_tr_b16 a[18:19], v9 offset:7760
    s_waitcnt lgkmcnt(6)
    v_mfma_f32_16x16x32_bf16 v[168:171], a[56:59], a[0:3], v[168:171]
    ds_read_b64_tr_b16 a[20:21], v9 offset:5240
    ds_read_b64_tr_b16 a[22:23], v9 offset:7800
    v_mfma_f32_16x16x32_bf16 v[152:155], a[24:27], a[4:7], v[152:155]
    ds_read_b64_tr_b16 a[0:1], v13 offset:5120
    v_mfma_f32_16x16x32_bf16 v[156:159], a[28:31], a[4:7], v[156:159]
    ds_read_b64_tr_b16 a[2:3], v13 offset:7680
    v_mfma_f32_16x16x32_bf16 v[172:175], a[56:59], a[4:7], v[172:175]
    s_waitcnt lgkmcnt(6)
    v_mfma_f32_16x16x32_bf16 v[40:43], a[8:11], a[24:27], v[40:43]
    ds_read_b64_tr_b16 a[4:5], v11 offset:5120
    v_mfma_f32_16x16x32_bf16 v[60:63], a[8:11], a[28:31], v[60:63]
    ds_read_b64_tr_b16 a[6:7], v11 offset:7680
    s_barrier
    v_mfma_f32_16x16x32_bf16 v[44:47], a[12:15], a[24:27], v[44:47]
    ds_read_b64_tr_b16 a[8:9], v9 offset:25600
    v_mfma_f32_16x16x32_bf16 v[64:67], a[12:15], a[28:31], v[64:67]
    ds_read_b64_tr_b16 a[10:11], v9 offset:28160
    s_waitcnt lgkmcnt(6)
    v_mfma_f32_16x16x32_bf16 v[48:51], a[16:19], a[24:27], v[48:51]
    ds_read_b64_tr_b16 a[12:13], v9 offset:25640
    v_mfma_f32_16x16x32_bf16 v[68:71], a[16:19], a[28:31], v[68:71]
    ds_read_b64_tr_b16 a[14:15], v9 offset:28200
    v_mfma_f32_16x16x32_bf16 v[52:55], a[20:23], a[24:27], v[52:55]
    ds_read_b64_tr_b16 a[16:17], v9 offset:25680
    v_mfma_f32_16x16x32_bf16 v[72:75], a[20:23], a[28:31], v[72:75]
    ds_read_b64_tr_b16 a[18:19], v9 offset:28240
    s_waitcnt lgkmcnt(6)
    v_mfma_f32_16x16x32_bf16 v[160:163], a[0:3], a[56:59], v[160:163]
    ds_read_b64_tr_b16 a[20:21], v9 offset:25720
    ds_read_b64_tr_b16 a[22:23], v9 offset:28280
    v_mfma_f32_16x16x32_bf16 v[56:59], a[4:7], a[24:27], v[56:59]
    ds_read_b64_tr_b16 a[0:1], v13 offset:25600
    v_mfma_f32_16x16x32_bf16 v[76:79], a[4:7], a[28:31], v[76:79]
    ds_read_b64_tr_b16 a[2:3], v13 offset:28160
    v_mfma_f32_16x16x32_bf16 v[164:167], a[4:7], a[56:59], v[164:167]
    s_waitcnt lgkmcnt(6)
    v_mfma_f32_16x16x32_bf16 v[120:123], a[32:35], a[8:11], v[120:123]
    ds_read_b64_tr_b16 a[4:5], v11 offset:25600
    v_mfma_f32_16x16x32_bf16 v[124:127], a[36:39], a[8:11], v[124:127]
    ds_read_b64_tr_b16 a[6:7], v11 offset:28160
    v_mfma_f32_16x16x32_bf16 v[128:131], a[32:35], a[12:15], v[128:131]
    ds_read_b64_tr_b16 a[8:9], v9 offset:20480
    v_mfma_f32_16x16x32_bf16 v[132:135], a[36:39], a[12:15], v[132:135]
    ds_read_b64_tr_b16 a[10:11], v9 offset:23040
    s_waitcnt lgkmcnt(6)
    v_mfma_f32_16x16x32_bf16 v[136:139], a[32:35], a[16:19], v[136:139]
    ds_read_b64_tr_b16 a[12:13], v9 offset:20520
    v_mfma_f32_16x16x32_bf16 v[140:143], a[36:39], a[16:19], v[140:143]
    ds_read_b64_tr_b16 a[14:15], v9 offset:23080
    v_mfma_f32_16x16x32_bf16 v[144:147], a[32:35], a[20:23], v[144:147]
    ds_read_b64_tr_b16 a[16:17], v9 offset:20560
    v_mfma_f32_16x16x32_bf16 v[148:151], a[36:39], a[20:23], v[148:151]
    ds_read_b64_tr_b16 a[18:19], v9 offset:23120
    s_waitcnt lgkmcnt(6)
    v_mfma_f32_16x16x32_bf16 v[168:171], a[60:63], a[0:3], v[168:171]
    ds_read_b64_tr_b16 a[20:21], v9 offset:20600
    ds_read_b64_tr_b16 a[22:23], v9 offset:23160
    v_mfma_f32_16x16x32_bf16 v[152:155], a[32:35], a[4:7], v[152:155]
    ds_read_b64_tr_b16 a[0:1], v13 offset:20480
    v_mfma_f32_16x16x32_bf16 v[156:159], a[36:39], a[4:7], v[156:159]
    ds_read_b64_tr_b16 a[2:3], v13 offset:23040
    v_mfma_f32_16x16x32_bf16 v[172:175], a[60:63], a[4:7], v[172:175]
    s_waitcnt lgkmcnt(6)
    v_mfma_f32_16x16x32_bf16 v[40:43], a[8:11], a[32:35], v[40:43]
    ds_read_b64_tr_b16 a[4:5], v11 offset:20480
    v_mfma_f32_16x16x32_bf16 v[60:63], a[8:11], a[36:39], v[60:63]
    ds_read_b64_tr_b16 a[6:7], v11 offset:23040
    s_barrier
    v_mfma_f32_16x16x32_bf16 v[44:47], a[12:15], a[32:35], v[44:47]
    ds_read_b64_tr_b16 a[8:9], v8 offset:10240
    ds_read_b128 a[40:43], v4 offset:40960
    v_mfma_f32_16x16x32_bf16 v[64:67], a[12:15], a[36:39], v[64:67]
    ds_read_b64_tr_b16 a[10:11], v8 offset:12800
    ds_read_b128 a[44:47], v4 offset:43008
    s_waitcnt lgkmcnt(8)
    v_mfma_f32_16x16x32_bf16 v[48:51], a[16:19], a[32:35], v[48:51]
    ds_read_b64_tr_b16 a[12:13], v8 offset:10280
    ds_read_b128 a[64:67], v6 offset:0
    v_mfma_f32_16x16x32_bf16 v[68:71], a[16:19], a[36:39], v[68:71]
    ds_read_b64_tr_b16 a[14:15], v8 offset:12840
    ds_read_b128 a[48:51], v5 offset:40960
    v_mfma_f32_16x16x32_bf16 v[52:55], a[20:23], a[32:35], v[52:55]
    ds_read_b64_tr_b16 a[16:17], v8 offset:10320
    ds_read_b128 a[52:55], v5 offset:43008
    v_mfma_f32_16x16x32_bf16 v[72:75], a[20:23], a[36:39], v[72:75]
    ds_read_b64_tr_b16 a[18:19], v8 offset:12880
    ds_read_b128 a[68:71], v7 offset:0
    s_waitcnt lgkmcnt(12)
    v_mfma_f32_16x16x32_bf16 v[160:163], a[0:3], a[60:63], v[160:163]
    ds_read_b64_tr_b16 a[20:21], v8 offset:10360
    ds_read_b64_tr_b16 a[22:23], v8 offset:12920
    v_mfma_f32_16x16x32_bf16 v[56:59], a[4:7], a[32:35], v[56:59]
    ds_read_b64_tr_b16 a[0:1], v12 offset:10240
    v_mfma_f32_16x16x32_bf16 v[76:79], a[4:7], a[36:39], v[76:79]
    ds_read_b64_tr_b16 a[2:3], v12 offset:12800
    v_mfma_f32_16x16x32_bf16 v[164:167], a[4:7], a[60:63], v[164:167]
    s_waitcnt lgkmcnt(4)
    v_mfma_f32_16x16x32_bf16 v[120:123], a[40:43], a[8:11], v[120:123]
    ds_read_b64_tr_b16 a[4:5], v10 offset:10240
    v_mfma_f32_16x16x32_bf16 v[124:127], a[44:47], a[8:11], v[124:127]
    ds_read_b64_tr_b16 a[6:7], v10 offset:12800
    v_mfma_f32_16x16x32_bf16 v[128:131], a[40:43], a[12:15], v[128:131]
    ds_read_b64_tr_b16 a[8:9], v8 offset:5120
    v_mfma_f32_16x16x32_bf16 v[132:135], a[44:47], a[12:15], v[132:135]
    ds_read_b64_tr_b16 a[10:11], v8 offset:7680
    s_waitcnt lgkmcnt(6)
    v_mfma_f32_16x16x32_bf16 v[136:139], a[40:43], a[16:19], v[136:139]
    ds_read_b64_tr_b16 a[12:13], v8 offset:5160
    v_mfma_f32_16x16x32_bf16 v[140:143], a[44:47], a[16:19], v[140:143]
    ds_read_b64_tr_b16 a[14:15], v8 offset:7720
    v_mfma_f32_16x16x32_bf16 v[144:147], a[40:43], a[20:23], v[144:147]
    ds_read_b64_tr_b16 a[16:17], v8 offset:5200
    v_mfma_f32_16x16x32_bf16 v[148:151], a[44:47], a[20:23], v[148:151]
    ds_read_b64_tr_b16 a[18:19], v8 offset:7760
    s_waitcnt lgkmcnt(6)
    v_mfma_f32_16x16x32_bf16 v[168:171], a[64:67], a[0:3], v[168:171]
    ds_read_b64_tr_b16 a[20:21], v8 offset:5240
    ds_read_b64_tr_b16 a[22:23], v8 offset:7800
    v_mfma_f32_16x16x32_bf16 v[152:155], a[40:43], a[4:7], v[152:155]
    ds_read_b64_tr_b16 a[0:1], v12 offset:5120
    v_mfma_f32_16x16x32_bf16 v[156:159], a[44:47], a[4:7], v[156:159]
    ds_read_b64_tr_b16 a[2:3], v12 offset:7680
    v_mfma_f32_16x16x32_bf16 v[172:175], a[64:67], a[4:7], v[172:175]
    s_waitcnt lgkmcnt(6)
    v_mfma_f32_16x16x32_bf16 v[40:43], a[8:11], a[40:43], v[40:43]
    ds_read_b64_tr_b16 a[4:5], v10 offset:5120
    v_mfma_f32_16x16x32_bf16 v[60:63], a[8:11], a[44:47], v[60:63]
    ds_read_b64_tr_b16 a[6:7], v10 offset:7680
    v_mfma_f32_16x16x32_bf16 v[44:47], a[12:15], a[40:43], v[44:47]
    ds_read_b64_tr_b16 a[8:9], v8 offset:25600
    ds_read_b32 v21, v22
    v_mfma_f32_16x16x32_bf16 v[64:67], a[12:15], a[44:47], v[64:67]
    ds_read_b64_tr_b16 a[10:11], v8 offset:28160
    s_waitcnt lgkmcnt(7)
    v_mfma_f32_16x16x32_bf16 v[48:51], a[16:19], a[40:43], v[48:51]
    ds_read_b64_tr_b16 a[12:13], v8 offset:25640
    v_mfma_f32_16x16x32_bf16 v[68:71], a[16:19], a[44:47], v[68:71]
    ds_read_b64_tr_b16 a[14:15], v8 offset:28200
    v_mfma_f32_16x16x32_bf16 v[52:55], a[20:23], a[40:43], v[52:55]
    ds_read_b64_tr_b16 a[16:17], v8 offset:25680
    v_mfma_f32_16x16x32_bf16 v[72:75], a[20:23], a[44:47], v[72:75]
    ds_read_b64_tr_b16 a[18:19], v8 offset:28240
    s_waitcnt lgkmcnt(7)
    v_mfma_f32_16x16x32_bf16 v[160:163], a[0:3], a[64:67], v[160:163]
    ds_read_b64_tr_b16 a[20:21], v8 offset:25720
    ds_read_b64_tr_b16 a[22:23], v8 offset:28280
    v_mfma_f32_16x16x32_bf16 v[56:59], a[4:7], a[40:43], v[56:59]
    ds_read_b64_tr_b16 a[0:1], v12 offset:25600
    v_mfma_f32_16x16x32_bf16 v[76:79], a[4:7], a[44:47], v[76:79]
    ds_read_b64_tr_b16 a[2:3], v12 offset:28160
    v_mfma_f32_16x16x32_bf16 v[164:167], a[4:7], a[64:67], v[164:167]
    s_waitcnt lgkmcnt(6)
    v_mfma_f32_16x16x32_bf16 v[120:123], a[48:51], a[8:11], v[120:123]
    ds_read_b64_tr_b16 a[4:5], v10 offset:25600
    v_mfma_f32_16x16x32_bf16 v[124:127], a[52:55], a[8:11], v[124:127]
    ds_read_b64_tr_b16 a[6:7], v10 offset:28160
    v_mfma_f32_16x16x32_bf16 v[128:131], a[48:51], a[12:15], v[128:131]
    ds_read_b64_tr_b16 a[8:9], v8 offset:20480
    v_mfma_f32_16x16x32_bf16 v[132:135], a[52:55], a[12:15], v[132:135]
    ds_read_b64_tr_b16 a[10:11], v8 offset:23040
    s_waitcnt lgkmcnt(6)
    v_mfma_f32_16x16x32_bf16 v[136:139], a[48:51], a[16:19], v[136:139]
    ds_read_b64_tr_b16 a[12:13], v8 offset:20520
    v_mfma_f32_16x16x32_bf16 v[140:143], a[52:55], a[16:19], v[140:143]
    ds_read_b64_tr_b16 a[14:15], v8 offset:23080
    v_mfma_f32_16x16x32_bf16 v[144:147], a[48:51], a[20:23], v[144:147]
    ds_read_b64_tr_b16 a[16:17], v8 offset:20560
    v_mfma_f32_16x16x32_bf16 v[148:151], a[52:55], a[20:23], v[148:151]
    ds_read_b64_tr_b16 a[18:19], v8 offset:23120
    s_waitcnt lgkmcnt(6)
    v_mfma_f32_16x16x32_bf16 v[168:171], a[68:71], a[0:3], v[168:171]
    ds_read_b64_tr_b16 a[20:21], v8 offset:20600
    ds_read_b64_tr_b16 a[22:23], v8 offset:23160
    v_mfma_f32_16x16x32_bf16 v[152:155], a[48:51], a[4:7], v[152:155]
    ds_read_b64_tr_b16 a[0:1], v12 offset:20480
    v_mfma_f32_16x16x32_bf16 v[156:159], a[52:55], a[4:7], v[156:159]
    ds_read_b64_tr_b16 a[2:3], v12 offset:23040
    v_mfma_f32_16x16x32_bf16 v[172:175], a[68:71], a[4:7], v[172:175]
    s_waitcnt lgkmcnt(6)
    v_mfma_f32_16x16x32_bf16 v[40:43], a[8:11], a[48:51], v[40:43]
    ds_read_b64_tr_b16 a[4:5], v10 offset:20480
    v_mfma_f32_16x16x32_bf16 v[60:63], a[8:11], a[52:55], v[60:63]
    ds_read_b64_tr_b16 a[6:7], v10 offset:23040
    v_mfma_f32_16x16x32_bf16 v[44:47], a[12:15], a[48:51], v[44:47]
    ds_read_b64_tr_b16 a[8:9], v9 offset:0
    v_mfma_f32_16x16x32_bf16 v[64:67], a[12:15], a[52:55], v[64:67]
    ds_read_b64_tr_b16 a[10:11], v9 offset:2560
    s_waitcnt lgkmcnt(6)
    v_mfma_f32_16x16x32_bf16 v[48:51], a[16:19], a[48:51], v[48:51]
    ds_read_b64_tr_b16 a[12:13], v9 offset:40
    v_mfma_f32_16x16x32_bf16 v[68:71], a[16:19], a[52:55], v[68:71]
    ds_read_b64_tr_b16 a[14:15], v9 offset:2600
    v_mfma_f32_16x16x32_bf16 v[52:55], a[20:23], a[48:51], v[52:55]
    ds_read_b64_tr_b16 a[16:17], v9 offset:80
    v_mfma_f32_16x16x32_bf16 v[72:75], a[20:23], a[52:55], v[72:75]
    ds_read_b64_tr_b16 a[18:19], v9 offset:2640
    s_waitcnt lgkmcnt(6)
    v_mfma_f32_16x16x32_bf16 v[160:163], a[0:3], a[68:71], v[160:163]
    ds_read_b64_tr_b16 a[20:21], v9 offset:120
    ds_read_b64_tr_b16 a[22:23], v9 offset:2680
    v_mfma_f32_16x16x32_bf16 v[56:59], a[4:7], a[48:51], v[56:59]
    ds_read_b64_tr_b16 a[0:1], v11 offset:0
    v_mfma_f32_16x16x32_bf16 v[76:79], a[4:7], a[52:55], v[76:79]
    ds_read_b64_tr_b16 a[2:3], v11 offset:2560
    v_mfma_f32_16x16x32_bf16 v[164:167], a[4:7], a[68:71], v[164:167]
    s_waitcnt lgkmcnt(6)
    v_mfma_f32_16x16x32_bf16 v[80:83], a[8:11], a[24:27], v[80:83]
    ds_read_b64_tr_b16 a[4:5], v9 offset:15360
    v_cvt_pk_bf16_f32 v124, v124, v125
    v_mfma_f32_16x16x32_bf16 v[100:103], a[8:11], a[28:31], v[100:103]
    ds_read_b64_tr_b16 a[6:7], v9 offset:17920
    v_cvt_pk_bf16_f32 v125, v126, v127
    v_mfma_f32_16x16x32_bf16 v[84:87], a[12:15], a[24:27], v[84:87]
    ds_read_b64_tr_b16 a[8:9], v9 offset:15400
    v_cvt_pk_bf16_f32 v123, v122, v123
    v_mfma_f32_16x16x32_bf16 v[104:107], a[12:15], a[28:31], v[104:107]
    ds_read_b64_tr_b16 a[10:11], v9 offset:17960
    v_cvt_pk_bf16_f32 v122, v120, v121
    s_waitcnt lgkmcnt(6)
    v_mfma_f32_16x16x32_bf16 v[88:91], a[16:19], a[24:27], v[88:91]
    ds_read_b64_tr_b16 a[12:13], v9 offset:15440
    ds_write_b64 v14, v[124:125] offset:2560
    v_mfma_f32_16x16x32_bf16 v[108:111], a[16:19], a[28:31], v[108:111]
    ds_read_b64_tr_b16 a[14:15], v9 offset:18000
    v_cvt_pk_bf16_f32 v132, v132, v133
    v_mfma_f32_16x16x32_bf16 v[92:95], a[20:23], a[24:27], v[92:95]
    ds_read_b64_tr_b16 a[16:17], v9 offset:15480
    v_cvt_pk_bf16_f32 v133, v134, v135
    v_mfma_f32_16x16x32_bf16 v[112:115], a[20:23], a[28:31], v[112:115]
    ds_read_b64_tr_b16 a[18:19], v9 offset:18040
    v_cvt_pk_bf16_f32 v131, v130, v131
    s_waitcnt lgkmcnt(7)
    v_mfma_f32_16x16x32_bf16 v[96:99], a[0:3], a[24:27], v[96:99]
    ds_read_b64_tr_b16 a[20:21], v11 offset:15360
    v_cvt_pk_bf16_f32 v130, v128, v129
    v_mfma_f32_16x16x32_bf16 v[116:119], a[0:3], a[28:31], v[116:119]
    ds_read_b64_tr_b16 a[22:23], v11 offset:17920
    ds_write_b64 v14, v[132:133] offset:3072
    v_mfma_f32_16x16x32_bf16 v[80:83], a[4:7], a[32:35], v[80:83]
    ds_read_b64_tr_b16 a[0:1], v8 offset:0
    v_cvt_pk_bf16_f32 v140, v140, v141
    v_mfma_f32_16x16x32_bf16 v[100:103], a[4:7], a[36:39], v[100:103]
    ds_read_b64_tr_b16 a[2:3], v8 offset:2560
    v_cvt_pk_bf16_f32 v141, v142, v143
    s_waitcnt lgkmcnt(7)
    v_mfma_f32_16x16x32_bf16 v[84:87], a[8:11], a[32:35], v[84:87]
    ds_read_b64_tr_b16 a[4:5], v8 offset:40
    v_cvt_pk_bf16_f32 v139, v138, v139
    v_mfma_f32_16x16x32_bf16 v[104:107], a[8:11], a[36:39], v[104:107]
    ds_read_b64_tr_b16 a[6:7], v8 offset:2600
    v_cvt_pk_bf16_f32 v138, v136, v137
    v_mfma_f32_16x16x32_bf16 v[88:91], a[12:15], a[32:35], v[88:91]
    ds_read_b64_tr_b16 a[8:9], v8 offset:80
    ds_write_b64 v14, v[140:141] offset:3584
    v_mfma_f32_16x16x32_bf16 v[108:111], a[12:15], a[36:39], v[108:111]
    ds_read_b64_tr_b16 a[10:11], v8 offset:2640
    v_cvt_pk_bf16_f32 v148, v148, v149
    s_waitcnt lgkmcnt(8)
    v_mfma_f32_16x16x32_bf16 v[92:95], a[16:19], a[32:35], v[92:95]
    ds_read_b64_tr_b16 a[12:13], v8 offset:120
    v_cvt_pk_bf16_f32 v149, v150, v151
    v_mfma_f32_16x16x32_bf16 v[112:115], a[16:19], a[36:39], v[112:115]
    ds_read_b64_tr_b16 a[14:15], v8 offset:2680
    v_cvt_pk_bf16_f32 v147, v146, v147
    v_mfma_f32_16x16x32_bf16 v[96:99], a[20:23], a[32:35], v[96:99]
    ds_read_b64_tr_b16 a[16:17], v10 offset:0
    v_cvt_pk_bf16_f32 v146, v144, v145
    v_mfma_f32_16x16x32_bf16 v[116:119], a[20:23], a[36:39], v[116:119]
    ds_read_b64_tr_b16 a[18:19], v10 offset:2560
    ds_write_b64 v14, v[148:149] offset:4096
    s_waitcnt lgkmcnt(8)
    v_mfma_f32_16x16x32_bf16 v[80:83], a[0:3], a[40:43], v[80:83]
    ds_read_b64_tr_b16 a[20:21], v8 offset:15360
    v_cvt_pk_bf16_f32 v156, v156, v157
    v_mfma_f32_16x16x32_bf16 v[100:103], a[0:3], a[44:47], v[100:103]
    ds_read_b64_tr_b16 a[22:23], v8 offset:17920
    v_cvt_pk_bf16_f32 v157, v158, v159
    v_mfma_f32_16x16x32_bf16 v[84:87], a[4:7], a[40:43], v[84:87]
    ds_read_b64_tr_b16 a[0:1], v8 offset:15400
    v_cvt_pk_bf16_f32 v155, v154, v155
    v_mfma_f32_16x16x32_bf16 v[104:107], a[4:7], a[44:47], v[104:107]
    ds_read_b64_tr_b16 a[2:3], v8 offset:17960
    v_cvt_pk_bf16_f32 v154, v152, v153
    s_waitcnt lgkmcnt(7)
    v_mfma_f32_16x16x32_bf16 v[88:91], a[8:11], a[40:43], v[88:91]
    ds_read_b64_tr_b16 a[4:5], v8 offset:15440
    ds_write_b64 v14, v[156:157] offset:4608
    v_mfma_f32_16x16x32_bf16 v[108:111], a[8:11], a[44:47], v[108:111]
    ds_read_b64_tr_b16 a[6:7], v8 offset:18000
    v_cvt_pk_bf16_f32 v168, v168, v169
    v_mfma_f32_16x16x32_bf16 v[92:95], a[12:15], a[40:43], v[92:95]
    ds_read_b64_tr_b16 a[8:9], v8 offset:15480
    v_cvt_pk_bf16_f32 v169, v170, v171
    v_mfma_f32_16x16x32_bf16 v[112:115], a[12:15], a[44:47], v[112:115]
    ds_read_b64_tr_b16 a[10:11], v8 offset:18040
    v_cvt_pk_bf16_f32 v172, v172, v173
    s_waitcnt lgkmcnt(7)
    v_mfma_f32_16x16x32_bf16 v[96:99], a[16:19], a[40:43], v[96:99]
    ds_read_b64_tr_b16 a[12:13], v10 offset:15360
    v_cvt_pk_bf16_f32 v173, v174, v175
    v_mfma_f32_16x16x32_bf16 v[116:119], a[16:19], a[44:47], v[116:119]
    ds_read_b64_tr_b16 a[14:15], v10 offset:17920
    ds_write_b64 v15, v[168:169] offset:2560
    v_mfma_f32_16x16x32_bf16 v[80:83], a[20:23], a[48:51], v[80:83]
    ds_write_b64 v16, v[172:173] offset:4608
    v_cvt_pk_bf16_f32 v160, v160, v161
    v_mfma_f32_16x16x32_bf16 v[100:103], a[20:23], a[52:55], v[100:103]
    v_cvt_pk_bf16_f32 v161, v162, v163
    v_cvt_pk_bf16_f32 v164, v164, v165
    s_waitcnt lgkmcnt(6)
    v_mfma_f32_16x16x32_bf16 v[84:87], a[0:3], a[48:51], v[84:87]
    v_cvt_pk_bf16_f32 v165, v166, v167
    ds_write_b64 v15, v[160:161]
    v_mfma_f32_16x16x32_bf16 v[104:107], a[0:3], a[52:55], v[104:107]
    ds_write_b64 v16, v[164:165] offset:2048
    v_cvt_pk_bf16_f32 v76, v76, v77
    v_mfma_f32_16x16x32_bf16 v[88:91], a[4:7], a[48:51], v[88:91]
    v_cvt_pk_bf16_f32 v77, v78, v79
    ds_write_b64 v14, v[76:77] offset:2048
    v_mfma_f32_16x16x32_bf16 v[108:111], a[4:7], a[52:55], v[108:111]
    v_cvt_pk_bf16_f32 v60, v60, v61
    v_cvt_pk_bf16_f32 v61, v62, v63
    s_waitcnt lgkmcnt(5)
    v_mfma_f32_16x16x32_bf16 v[92:95], a[8:11], a[48:51], v[92:95]
    v_mov_b32 v62, v76
    v_mov_b32 v63, v77
    v_mfma_f32_16x16x32_bf16 v[112:115], a[8:11], a[52:55], v[112:115]
    ds_write_b64 v14, v[60:61] offset:0
    v_cvt_pk_bf16_f32 v64, v64, v65
    v_mfma_f32_16x16x32_bf16 v[96:99], a[12:15], a[48:51], v[96:99]
    v_cvt_pk_bf16_f32 v65, v66, v67
    v_mov_b32 v66, v76
    v_mfma_f32_16x16x32_bf16 v[116:119], a[12:15], a[52:55], v[116:119]
    v_mov_b32 v67, v77
    ds_write_b64 v14, v[64:65] offset:512
    v_cvt_pk_bf16_f32 v68, v68, v69
    v_cvt_pk_bf16_f32 v69, v70, v71
    v_mov_b32 v70, v76
    v_mov_b32 v71, v77
    ds_write_b64 v14, v[68:69] offset:1024
    v_cvt_pk_bf16_f32 v72, v72, v73
    v_cvt_pk_bf16_f32 v73, v74, v75
    v_mov_b32 v74, v76
    v_mov_b32 v75, v77
    ds_write_b64 v14, v[72:73] offset:1536
    v_cvt_pk_bf16_f32 v56, v56, v57
    v_cvt_pk_bf16_f32 v57, v58, v59
    v_cvt_pk_bf16_f32 v40, v40, v41
    v_cvt_pk_bf16_f32 v41, v42, v43
    v_mov_b32 v42, v56
    v_mov_b32 v43, v57
    v_cvt_pk_bf16_f32 v44, v44, v45
    v_cvt_pk_bf16_f32 v45, v46, v47
    v_mov_b32 v46, v56
    v_mov_b32 v47, v57
    v_cvt_pk_bf16_f32 v48, v48, v49
    v_cvt_pk_bf16_f32 v49, v50, v51
    v_mov_b32 v50, v56
    v_mov_b32 v51, v57
    v_cvt_pk_bf16_f32 v52, v52, v53
    v_cvt_pk_bf16_f32 v53, v54, v55
    v_mov_b32 v54, v56
    v_mov_b32 v55, v57
    s_waitcnt vmcnt(0)
    v_mov_b32 v20, 1
    s_waitcnt lgkmcnt(0)
    s_mov_b64 exec, 1
    ds_add_u32 v22, v20 offset:4
    s_mov_b64 exec, -1
    v_cvt_pk_bf16_f32 v116, v116, v117
    v_cvt_pk_bf16_f32 v117, v118, v119
    v_cvt_pk_bf16_f32 v100, v100, v101
    v_cvt_pk_bf16_f32 v101, v102, v103
    v_cndmask_b32 v102, 0, v116, s[60:61]
    v_cndmask_b32 v103, 0, v117, s[60:61]
    v_cvt_pk_bf16_f32 v104, v104, v105
    v_cvt_pk_bf16_f32 v105, v106, v107
    v_cndmask_b32 v106, 0, v116, s[62:63]
    v_cndmask_b32 v107, 0, v117, s[62:63]
    v_cvt_pk_bf16_f32 v108, v108, v109
    v_cvt_pk_bf16_f32 v109, v110, v111
    v_cndmask_b32 v110, 0, v116, s[64:65]
    v_cndmask_b32 v111, 0, v117, s[64:65]
    v_cvt_pk_bf16_f32 v112, v112, v113
    v_cvt_pk_bf16_f32 v113, v114, v115
    v_cndmask_b32 v114, 0, v116, s[66:67]
    v_cndmask_b32 v115, 0, v117, s[66:67]
    v_readfirstlane_b32 s80, v21
LB_c1c:
    ds_read_b32 v20, v22 offset:4
    s_waitcnt lgkmcnt(0)
    v_readfirstlane_b32 s76, v20
    s_nop 0
    s_cmp_lt_u32 s76, 4
    s_cbranch_scc1 LB_c1c
    ds_read_b64 a[24:25], v17 offset:0
    ds_read_b64 a[26:27], v17 offset:2048
    ds_read_b64 a[28:29], v17 offset:512
    ds_read_b64 a[30:31], v17 offset:2048
    ds_read_b64 a[32:33], v17 offset:1024
    ds_read_b64 a[34:35], v17 offset:2048
    ds_read_b64 a[36:37], v17 offset:1536
    ds_read_b64 a[38:39], v17 offset:2048
    ds_read_b64 v[120:121], v17 offset:2560
    ds_read_b64 v[128:129], v17 offset:3072
    ds_read_b64 v[136:137], v17 offset:3584
    ds_read_b64 v[144:145], v17 offset:4096
    ds_read_b64 v[152:153], v17 offset:4608
    ds_read_b32 v1, v22 offset:8
    v_mfma_f32_16x16x32_bf16 v[160:163], v[40:43], v[100:103], v[28:31]
    v_mfma_f32_16x16x32_bf16 v[176:179], v[60:63], v[100:103], v[24:27]
    v_mfma_f32_16x16x32_bf16 v[164:167], v[44:47], v[104:107], v[28:31]
    v_mfma_f32_16x16x32_bf16 v[180:183], v[64:67], v[104:107], v[24:27]
    v_mfma_f32_16x16x32_bf16 v[168:171], v[48:51], v[108:111], v[28:31]
    v_mfma_f32_16x16x32_bf16 v[4:7], v[68:71], v[108:111], v[24:27]
    v_mfma_f32_16x16x32_bf16 v[172:175], v[52:55], v[112:115], v[28:31]
    v_mfma_f32_16x16x32_bf16 v[8:11], v[72:75], v[112:115], v[24:27]
    v_cvt_pk_bf16_f32 v96, v96, v97
    v_cvt_pk_bf16_f32 v97, v98, v99
    v_cvt_pk_bf16_f32 v80, v80, v81
    v_cvt_pk_bf16_f32 v81, v82, v83
    v_cndmask_b32 v82, 0, v96, s[60:61]
    v_cndmask_b32 v83, 0, v97, s[60:61]
    v_cvt_pk_bf16_f32 v84, v84, v85
    v_cvt_pk_bf16_f32 v85, v86, v87
    v_cndmask_b32 v86, 0, v96, s[62:63]
    v_cndmask_b32 v87, 0, v97, s[62:63]
    v_cvt_pk_bf16_f32 v88, v88, v89
    v_cvt_pk_bf16_f32 v89, v90, v91
    v_cndmask_b32 v90, 0, v96, s[64:65]
    v_cndmask_b32 v91, 0, v97, s[64:65]
    v_cvt_pk_bf16_f32 v92, v92, v93
    v_cvt_pk_bf16_f32 v93, v94, v95
    v_cndmask_b32 v94, 0, v96, s[66:67]
    v_cndmask_b32 v95, 0, v97, s[66:67]
    v_mfma_f32_16x16x32_bf16 v[60:63], v[40:43], v[80:83], v[24:27]
    v_mfma_f32_16x16x32_bf16 v[64:67], v[44:47], v[84:87], v[24:27]
    v_mfma_f32_16x16x32_bf16 v[68:71], v[48:51], v[88:91], v[24:27]
    v_mfma_f32_16x16x32_bf16 v[72:75], v[52:55], v[92:95], v[24:27]
    s_waitcnt lgkmcnt(6)
    v_mfma_f32_16x16x32_bf16 v[56:59], a[24:27], v[80:83], v[32:35]
    v_mfma_f32_16x16x32_bf16 v[76:79], a[28:31], v[84:87], v[32:35]
    v_mfma_f32_16x16x32_bf16 v[116:119], a[32:35], v[88:91], v[32:35]
    v_mfma_f32_16x16x32_bf16 v[96:99], a[36:39], v[92:95], v[32:35]
    v_max3_f32 v160, v160, v161, v176
    v_max3_f32 v162, v162, v163, v178
    v_max_f32 v160, v160, v177
    v_max_f32 v161, v162, v179
    v_max_f32 v162, v160, v161
    v_max3_f32 v164, v164, v165, v180
    v_max3_f32 v166, v166, v167, v182
    v_max_f32 v164, v164, v181
    v_max_f32 v165, v166, v183
    v_max_f32 v166, v164, v165
    v_max3_f32 v168, v168, v169, v4
    v_max3_f32 v170, v170, v171, v6
    v_max_f32 v168, v168, v5
    v_max_f32 v169, v170, v7
    v_max_f32 v170, v168, v169
    v_max3_f32 v172, v172, v173, v8
    v_max3_f32 v174, v174, v175, v10
    v_max_f32 v172, v172, v9
    v_max_f32 v173, v174, v11
    v_max_f32 v174, v172, v173
    v_permlane16_swap_b32 v162, v166
    v_max3_f32 v56, v56, v57, v60
    v_permlane16_swap_b32 v170, v174
    v_max3_f32 v58, v58, v59, v62
    v_max_f32 v162, v162, v166
    v_max_f32 v56, v56, v61
    v_max_f32 v170, v170, v174
    v_max_f32 v57, v58, v63
    s_nop 0
    v_permlane32_swap_b32 v162, v170
    v_max_f32 v58, v56, v57
    v_max_f32 v21, v162, v170
    v_max3_f32 v76, v76, v77, v64
    v_mul_f32 v21, s70, v21
    v_max3_f32 v78, v78, v79, v66
    v_mov_b32 v162, v21
    v_max_f32 v76, v76, v65
    v_mov_b32 v170, v21
    v_max_f32 v77, v78, v67
    s_nop 0
    v_permlane32_swap_b32 v162, v170
    v_max_f32 v78, v76, v77
    v_mov_b32 v166, v162
    v_max3_f32 v116, v116, v117, v68
    v_mov_b32 v174, v170
    v_max3_f32 v118, v118, v119, v70
    v_permlane16_swap_b32 v162, v166
    v_max_f32 v116, v116, v69
    v_permlane16_swap_b32 v170, v174
    v_max_f32 v117, v118, v71
    v_max_f32 v118, v116, v117
    v_max3_f32 v96, v96, v97, v72
    v_max3_f32 v98, v98, v99, v74
    v_max_f32 v96, v96, v73
    v_max_f32 v97, v98, v75
    v_max_f32 v98, v96, v97
    v_permlane16_swap_b32 v58, v78
    v_fma_f32 v160, v160, s70, -v162
    v_permlane16_swap_b32 v118, v98
    v_fma_f32 v161, v161, s70, -v162
    v_max_f32 v58, v58, v78
    v_fma_f32 v164, v164, s70, -v166
    v_max_f32 v118, v118, v98
    v_fma_f32 v165, v165, s70, -v166
    s_nop 0
    v_permlane32_swap_b32 v58, v118
    v_fma_f32 v168, v168, s70, -v170
    v_max_f32 v20, v58, v118
    v_fma_f32 v169, v169, s70, -v170
    v_mul_f32 v20, s70, v20
    v_fma_f32 v172, v172, s70, -v174
    v_mov_b32 v58, v20
    v_fma_f32 v173, v173, s70, -v174
    v_mov_b32 v118, v20
    v_exp_f32 v160, v160
    s_nop 0
    v_permlane32_swap_b32 v58, v118
    v_exp_f32 v161, v161
    v_mov_b32 v78, v58
    v_exp_f32 v164, v164
    v_mov_b32 v98, v118
    v_exp_f32 v165, v165
    v_permlane16_swap_b32 v58, v78
    v_exp_f32 v168, v168
    v_permlane16_swap_b32 v118, v98
    v_exp_f32 v169, v169
    v_exp_f32 v172, v172
    v_exp_f32 v173, v173
    v_add_f32 v162, v160, v161
    v_add_f32 v166, v164, v165
    v_add_f32 v170, v168, v169
    v_add_f32 v174, v172, v173
    v_permlane16_swap_b32 v162, v166
    v_fma_f32 v56, v56, s70, -v58
    v_permlane16_swap_b32 v170, v174
    v_fma_f32 v57, v57, s70, -v58
    v_add_f32 v162, v162, v166
    v_fma_f32 v76, v76, s70, -v78
    v_add_f32 v170, v170, v174
    v_fma_f32 v77, v77, s70, -v78
    s_nop 0
    v_permlane32_swap_b32 v162, v170
    v_fma_f32 v116, v116, s70, -v118
    v_add_f32 v21, v162, v170
    v_fma_f32 v117, v117, s70, -v118
    v_rcp_f32 v21, v21
    v_fma_f32 v96, v96, s70, -v98
    v_mov_b32 v162, v21
    v_fma_f32 v97, v97, s70, -v98
    v_mov_b32 v170, v21
    v_exp_f32 v56, v56
    s_nop 0
    v_permlane32_swap_b32 v162, v170
    v_exp_f32 v57, v57
    v_mov_b32 v166, v162
    v_exp_f32 v76, v76
    v_mov_b32 v174, v170
    v_exp_f32 v77, v77
    v_permlane16_swap_b32 v162, v166
    v_exp_f32 v116, v116
    v_permlane16_swap_b32 v170, v174
    v_exp_f32 v117, v117
    v_exp_f32 v96, v96
    v_exp_f32 v97, v97
    v_add_f32 v58, v56, v57
    v_add_f32 v78, v76, v77
    v_add_f32 v118, v116, v117
    v_add_f32 v98, v96, v97
    v_permlane16_swap_b32 v58, v78
    v_mul_f32 v160, v160, v162
    v_permlane16_swap_b32 v118, v98
    v_mul_f32 v161, v161, v162
    v_add_f32 v58, v58, v78
    v_cvt_pk_bf16_f32 v160, v160, v161
    v_add_f32 v118, v118, v98
    v_perm_b32 v176, v160, v160, v36
    s_nop 0
    v_permlane32_swap_b32 v58, v118
    v_perm_b32 v177, v160, v160, v37
    v_add_f32 v20, v58, v118
    v_perm_b32 v178, v160, v160, v38
    v_rcp_f32 v20, v20
    v_perm_b32 v179, v160, v160, v39
    v_mov_b32 v58, v20
    v_mul_f32 v164, v164, v166
    v_mov_b32 v118, v20
    v_mul_f32 v165, v165, v166
    s_nop 0
    v_permlane32_swap_b32 v58, v118
    v_cvt_pk_bf16_f32 v164, v164, v165
    v_mov_b32 v78, v58
    v_perm_b32 v180, v164, v164, v36
    v_mov_b32 v98, v118
    v_perm_b32 v181, v164, v164, v37
    v_permlane16_swap_b32 v58, v78
    v_perm_b32 v182, v164, v164, v38
    v_permlane16_swap_b32 v118, v98
    v_perm_b32 v183, v164, v164, v39
    v_mul_f32 v168, v168, v170
    v_mul_f32 v169, v169, v170
    v_cvt_pk_bf16_f32 v168, v168, v169
    v_perm_b32 v4, v168, v168, v36
    v_perm_b32 v5, v168, v168, v37
    v_perm_b32 v6, v168, v168, v38
    v_perm_b32 v7, v168, v168, v39
    v_mul_f32 v172, v172, v174
    v_mul_f32 v173, v173, v174
    v_cvt_pk_bf16_f32 v172, v172, v173
    v_perm_b32 v8, v172, v172, v36
    v_perm_b32 v9, v172, v172, v37
    v_perm_b32 v10, v172, v172, v38
    v_perm_b32 v11, v172, v172, v39
    v_mul_f32 v56, v56, v58
    v_mul_f32 v57, v57, v58
    v_cvt_pk_bf16_f32 v56, v56, v57
    v_mfma_f32_16x16x32_bf16 v[100:103], v[122:125], v[176:179], 0
    v_perm_b32 v60, v56, v56, v36
    v_perm_b32 v61, v56, v56, v37
    v_perm_b32 v62, v56, v56, v38
    v_mfma_f32_16x16x32_bf16 v[160:163], v[154:157], v[176:179], 0
    v_perm_b32 v63, v56, v56, v39
    v_mul_f32 v76, v76, v78
    v_mul_f32 v77, v77, v78
    v_mfma_f32_16x16x32_bf16 v[104:107], v[130:133], v[180:183], 0
    v_cvt_pk_bf16_f32 v76, v76, v77
    v_perm_b32 v64, v76, v76, v36
    v_perm_b32 v65, v76, v76, v37
    v_mfma_f32_16x16x32_bf16 v[164:167], v[154:157], v[180:183], 0
    v_perm_b32 v66, v76, v76, v38
    v_perm_b32 v67, v76, v76, v39
    v_mul_f32 v116, v116, v118
    v_mfma_f32_16x16x32_bf16 v[108:111], v[138:141], v[4:7], 0
    v_mul_f32 v117, v117, v118
    v_cvt_pk_bf16_f32 v116, v116, v117
    v_perm_b32 v68, v116, v116, v36
    v_mfma_f32_16x16x32_bf16 v[168:171], v[154:157], v[4:7], 0
    v_perm_b32 v69, v116, v116, v37
    v_perm_b32 v70, v116, v116, v38
    v_perm_b32 v71, v116, v116, v39
    v_mfma_f32_16x16x32_bf16 v[112:115], v[146:149], v[8:11], 0
    v_mul_f32 v96, v96, v98
    v_mul_f32 v97, v97, v98
    v_cvt_pk_bf16_f32 v96, v96, v97
    v_mfma_f32_16x16x32_bf16 v[172:175], v[154:157], v[8:11], 0
    v_perm_b32 v72, v96, v96, v36
    v_perm_b32 v73, v96, v96, v37
    v_perm_b32 v74, v96, v96, v38
    v_perm_b32 v75, v96, v96, v39
    s_waitcnt lgkmcnt(0)
    v_readfirstlane_b32 s76, v1
    s_nop 0
    s_cmp_ge_u32 s76, 4
    s_cbranch_scc1 LB_c2ok
LB_c2:
    ds_read_b32 v1, v22 offset:8
    s_waitcnt lgkmcnt(0)
    v_readfirstlane_b32 s76, v1
    s_nop 0
    s_cmp_lt_u32 s76, 4
    s_cbranch_scc1 LB_c2
LB_c2ok:
    v_cvt_pk_bf16_f32 v44, v100, v101
    v_cvt_pk_bf16_f32 v45, v102, v103
    v_mfma_f32_16x16x32_bf16 v[80:83], v[120:123], v[60:63], 0
    v_mfma_f32_16x16x32_bf16 v[56:59], v[152:155], v[60:63], 0
    v_cvt_pk_bf16_f32 v46, v104, v105
    v_cvt_pk_bf16_f32 v47, v106, v107
    v_mfma_f32_16x16x32_bf16 v[84:87], v[128:131], v[64:67], 0
    v_mfma_f32_16x16x32_bf16 v[76:79], v[152:155], v[64:67], 0
    v_cvt_pk_bf16_f32 v52, v108, v109
    v_cvt_pk_bf16_f32 v53, v110, v111
    v_mfma_f32_16x16x32_bf16 v[88:91], v[136:139], v[68:71], 0
    v_mfma_f32_16x16x32_bf16 v[116:119], v[152:155], v[68:71], 0
    v_cvt_pk_bf16_f32 v54, v112, v113
    v_cvt_pk_bf16_f32 v55, v114, v115
    v_mfma_f32_16x16x32_bf16 v[92:95], v[144:147], v[72:75], 0
    v_mfma_f32_16x16x32_bf16 v[96:99], v[152:155], v[72:75], 0
    s_mov_b64 exec, s[60:61]
    v_cvt_pk_bf16_f32 v4, v160, v161
    v_cvt_pk_bf16_f32 v5, v162, v163
    s_mov_b64 exec, s[62:63]
    v_cvt_pk_bf16_f32 v4, v164, v165
    v_cvt_pk_bf16_f32 v5, v166, v167
    s_mov_b64 exec, s[64:65]
    v_cvt_pk_bf16_f32 v4, v168, v169
    v_cvt_pk_bf16_f32 v5, v170, v171
    s_mov_b64 exec, s[66:67]
    v_cvt_pk_bf16_f32 v4, v172, v173
    v_cvt_pk_bf16_f32 v5, v174, v175
    s_mov_b64 exec, -1
    s_cmp_eq_u32 s80, s98
    s_cbranch_scc1 LB_st1_l2
    buffer_store_dwordx4 v[44:47], v18, s[48:51], s23 offen sc1
    buffer_store_dwordx4 v[52:55], v18, s[48:51], s23 offen offset:2560 sc1
    buffer_store_dwordx2 v[4:5], v19, s[48:51], s23 offen sc1
    s_branch LB_st1_e
LB_st1_l2:
    buffer_store_dwordx4 v[44:47], v18, s[48:51], s23 offen
    buffer_store_dwordx4 v[52:55], v18, s[48:51], s23 offen offset:2560
    buffer_store_dwordx2 v[4:5], v19, s[48:51], s23 offen
LB_st1_e:
    v_cvt_pk_bf16_f32 v40, v80, v81
    v_cvt_pk_bf16_f32 v41, v82, v83
    v_cvt_pk_bf16_f32 v42, v84, v85
    v_cvt_pk_bf16_f32 v43, v86, v87
    v_cvt_pk_bf16_f32 v48, v88, v89
    v_cvt_pk_bf16_f32 v49, v90, v91
    v_cvt_pk_bf16_f32 v50, v92, v93
    v_cvt_pk_bf16_f32 v51, v94, v95
    s_mov_b64 exec, s[60:61]
    v_cvt_pk_bf16_f32 v68, v56, v57
    v_cvt_pk_bf16_f32 v69, v58, v59
    s_mov_b64 exec, s[62:63]
    v_cvt_pk_bf16_f32 v68, v76, v77
    v_cvt_pk_bf16_f32 v69, v78, v79
    s_mov_b64 exec, s[64:65]
    v_cvt_pk_bf16_f32 v68, v116, v117
    v_cvt_pk_bf16_f32 v69, v118, v119
    s_mov_b64 exec, s[66:67]
    v_cvt_pk_bf16_f32 v68, v96, v97
    v_cvt_pk_bf16_f32 v69, v98, v99
    s_mov_b64 exec, -1
    s_cmp_eq_u32 s80, s98
    s_cbranch_scc1 LB_st0_l2
    buffer_store_dwordx4 v[40:43], v18, s[48:51], 0 offen sc1
    buffer_store_dwordx4 v[48:51], v18, s[48:51], 0 offen offset:2560 sc1
    buffer_store_dwordx2 v[68:69], v19, s[48:51], 0 offen sc1
    s_branch LB_st0_e
LB_st0_l2:
    buffer_store_dwordx4 v[40:43], v18, s[48:51], 0 offen
    buffer_store_dwordx4 v[48:51], v18, s[48:51], 0 offen offset:2560
    buffer_store_dwordx2 v[68:69], v19, s[48:51], 0 offen
LB_st0_e:
    s_waitcnt vmcnt(0)
    s_lshl_b32 s76, s55, 2
    s_add_u32 s76, s76, s19
    v_mov_b32 v1, 1
    s_mov_b64 exec, 1
    s_cmp_eq_u32 s80, s98
    s_cbranch_scc1 LB_fl_l2
    buffer_store_dword v1, off, s[36:39], s76 sc1
    s_branch LB_fl_e
LB_fl_l2:
    buffer_store_dword v1, off, s[36:39], s76
LB_fl_e:
    s_mov_b64 exec, -1
    s_mov_b32 s13, 0
LP2:
    s_mul_i32 s76, s13, 40960
    s_add_u32 s77, s92, s76
    s_sub_u32 s76, s92, s76
    s_add_u32 s76, s76, 40960
    v_lshlrev_b32 v1, 4, v0
    v_add_u32 v4, s77, v1
    v_add_u32 v5, s76, v1
    s_mov_b32 s11, 0
    s_mov_b32 s12, 0
    v_lshrrev_b32 v1, 2, v0
    v_mul_u32_u24 v1, 160, v1
    v_and_b32 v2, 3, v0
    v_lshl_add_u32 v3, v2, 3, v1
    v_add_u32 v6, s87, v3
    v_add_u32 v7, s88, v3
    v_add_u32 v8, s89, v3
    v_add_u32 v9, s90, v3
    v_add_u32 v10, s91, v3
    s_cmp_eq_u32 s13, 0
    s_cbranch_scc0 LP2_poller
    s_barrier
    s_branch LP2_p1
LP2_poller:
    v_lshlrev_b32 v11, 2, v0
LP2_arr:
    buffer_load_dword v3, off, s[44:47], s97 sc1
    s_waitcnt vmcnt(0)
    v_readfirstlane_b32 s80, v3
    s_nop 0
    s_lshr_b32 s77, s80, 4
    s_and_b32 s76, s80, 0x0f0f0f0f
    s_and_b32 s77, s77, 0x0f0f0f0f
    s_add_u32 s76, s76, s77
    s_mul_i32 s76, s76, 0x01010101
    s_lshr_b32 s76, s76, 24
    s_add_u32 s12, s12, 1
    s_cmp_ge_u32 s12, 32768
    s_cbranch_scc1 LP2_arr_ok
    s_cmp_eq_u32 s76, 8
    s_cbranch_scc0 LP2_arr
LP2_arr_ok:
    s_barrier
    s_mov_b64 exec, 0xff
LP2_poll:
    buffer_load_dword v2, v11, s[36:39], s19 offen sc1
    s_add_u32 s11, s11, 1
    s_cmp_ge_u32 s11, 32768
    s_waitcnt vmcnt(0)
    v_cmp_ne_u32 vcc, 1, v2
    s_cbranch_scc1 LP2_bar
    s_cbranch_vccnz LP2_poll
LP2_bar:
    s_mov_b64 exec, -1
    buffer_load_dwordx4 v[40:43], v4, s[48:51], s82 offen offset:0 sc1
    buffer_load_dwordx4 v[44:47], v5, s[48:51], s82 offen offset:0 sc1
    s_barrier
    s_setprio 3
LP2_p1:
    s_movk_i32 s14, 2400
    ds_read_b64_tr_b16 a[0:1], v6 offset:0
    ds_read_b64_tr_b16 a[2:3], v6 offset:2560
    ds_read_b64_tr_b16 a[4:5], v6 offset:32
    ds_read_b64_tr_b16 a[6:7], v6 offset:2592
    ds_read_b64_tr_b16 a[8:9], v6 offset:64
    ds_read_b64_tr_b16 a[10:11], v6 offset:2624
    ds_read_b64_tr_b16 a[12:13], v6 offset:96
    ds_read_b64_tr_b16 a[14:15], v6 offset:2656
    ds_read_b64_tr_b16 a[16:17], v6 offset:128
    ds_read_b64_tr_b16 a[18:19], v6 offset:2688
    s_cmp_eq_u32 s13, 0
    s_cbranch_scc1 LP2_s0
    buffer_load_dwordx4 v[48:51], v4, s[48:51], s82 offen offset:2560 sc1
    buffer_load_dwordx4 v[52:55], v5, s[48:51], s82 offen offset:2560 sc1
    s_waitcnt vmcnt(2)
    buffer_load_dwordx4 v[56:59], v4, s[48:51], s83 offen offset:0 sc1
    buffer_load_dwordx4 v[60:63], v5, s[48:51], s83 offen offset:0 sc1
LP2_s0:
    s_waitcnt lgkmcnt(6)
    v_mfma_f32_16x16x32_bf16 v[120:123], a[0:3], v[40:43], 0
    ds_read_b64_tr_b16 a[20:21], v6 offset:5120
    v_lshrrev_b32 v1, 5, v0
    v_mfma_f32_16x16x32_bf16 v[140:143], a[0:3], v[44:47], 0
    ds_read_b64_tr_b16 a[22:23], v6 offset:7680
    v_mul_u32_u24 v1, 2304, v1
    v_mfma_f32_16x16x32_bf16 v[124:127], a[4:7], v[40:43], 0
    ds_read_b64_tr_b16 a[0:1], v6 offset:5152
    v_lshlrev_b32 v2, 3, v0
    v_mfma_f32_16x16x32_bf16 v[144:147], a[4:7], v[44:47], 0
    ds_read_b64_tr_b16 a[2:3], v6 offset:7712
    v_sub_u32 v1, v1, v2
    s_waitcnt lgkmcnt(6)
    v_mfma_f32_16x16x32_bf16 v[128:131], a[8:11], v[40:43], 0
    ds_read_b64_tr_b16 a[4:5], v6 offset:5184
    v_add_u32 v21, v4, v1
    v_mfma_f32_16x16x32_bf16 v[148:151], a[8:11], v[44:47], 0
    ds_read_b64_tr_b16 a[6:7], v6 offset:7744
    v_add_u32 v22, v5, v1
    v_mfma_f32_16x16x32_bf16 v[132:135], a[12:15], v[40:43], 0
    ds_read_b64_tr_b16 a[8:9], v6 offset:5216
    v_lshlrev_b32 v11, 2, v0
    v_mfma_f32_16x16x32_bf16 v[152:155], a[12:15], v[44:47], 0
    ds_read_b64_tr_b16 a[10:11], v6 offset:7776
    v_lshlrev_b32 v1, 4, v0
    s_waitcnt lgkmcnt(6)
    v_mfma_f32_16x16x32_bf16 v[136:139], a[16:19], v[40:43], 0
    ds_read_b64_tr_b16 a[12:13], v6 offset:5248
    v_add_u32 v12, s94, v1
    v_mfma_f32_16x16x32_bf16 v[156:159], a[16:19], v[44:47], 0
    ds_read_b64_tr_b16 a[14:15], v6 offset:7808
    v_add_u32 v13, s95, v1
    s_cmp_eq_u32 s13, 0
    s_cbranch_scc1 LP2_s1
    s_waitcnt vmcnt(2)
    buffer_load_dwordx4 v[64:67], v4, s[48:51], s83 offen offset:2560 sc1
    buffer_load_dwordx4 v[68:71], v5, s[48:51], s83 offen offset:2560 sc1
LP2_s1:
    v_mfma_f32_16x16x32_bf16 v[120:123], a[20:23], v[48:51], v[120:123]
    v_and_b32 v1, 15, v0
    v_mul_u32_u24 v1, 176, v1
    v_mfma_f32_16x16x32_bf16 v[140:143], a[20:23], v[52:55], v[140:143]
    v_lshrrev_b32 v2, 4, v0
    v_lshl_add_u32 v1, v2, 3, v1
    s_waitcnt lgkmcnt(4)
    v_mfma_f32_16x16x32_bf16 v[124:127], a[0:3], v[48:51], v[124:127]
    v_add_u32 v14, s95, v1
    v_add_u32 v1, 0, v0
    v_mfma_f32_16x16x32_bf16 v[144:147], a[0:3], v[52:55], v[144:147]
    v_mfma_f32_16x16x32_bf16 v[128:131], a[4:7], v[48:51], v[128:131]
    v_mfma_f32_16x16x32_bf16 v[148:151], a[4:7], v[52:55], v[148:151]
    s_waitcnt lgkmcnt(0)
    v_mfma_f32_16x16x32_bf16 v[132:135], a[8:11], v[48:51], v[132:135]
    v_mfma_f32_16x16x32_bf16 v[152:155], a[8:11], v[52:55], v[152:155]
    v_mfma_f32_16x16x32_bf16 v[136:139], a[12:15], v[48:51], v[136:139]
    v_mfma_f32_16x16x32_bf16 v[156:159], a[12:15], v[52:55], v[156:159]
    s_cmp_eq_u32 s13, 0
    s_cbranch_scc0 LP2_p2
    s_barrier
    s_setprio 3
    buffer_load_dwordx4 v[56:59], v4, s[48:51], s83 offen offset:0 sc1
    buffer_load_dwordx4 v[60:63], v5, s[48:51], s83 offen offset:0 sc1
    buffer_load_dwordx4 v[64:67], v4, s[48:51], s83 offen offset:2560 sc1
    buffer_load_dwordx4 v[68:71], v5, s[48:51], s83 offen offset:2560 sc1
LP2_p2:
    ds_read_b64_tr_b16 a[0:1], v7 offset:0
    ds_read_b64_tr_b16 a[2:3], v7 offset:2560
    ds_read_b64_tr_b16 a[4:5], v7 offset:32
    ds_read_b64_tr_b16 a[6:7], v7 offset:2592
    ds_read_b64_tr_b16 a[8:9], v7 offset:64
    ds_read_b64_tr_b16 a[10:11], v7 offset:2624
    ds_read_b64_tr_b16 a[12:13], v7 offset:96
    ds_read_b64_tr_b16 a[14:15], v7 offset:2656
    ds_read_b64_tr_b16 a[16:17], v7 offset:128
    ds_read_b64_tr_b16 a[18:19], v7 offset:2688
    buffer_load_dwordx4 v[72:75], v4, s[48:51], s84 offen offset:0 sc1
    buffer_load_dwordx4 v[76:79], v5, s[48:51], s84 offen offset:0 sc1
    s_waitcnt vmcnt(4)
    s_waitcnt lgkmcnt(6)
    v_mfma_f32_16x16x32_bf16 v[120:123], a[0:3], v[56:59], v[120:123]
    ds_read_b64_tr_b16 a[20:21], v7 offset:5120
    buffer_load_dwordx4 v[80:83], v4, s[48:51], s84 offen offset:2560 sc1
    v_mfma_f32_16x16x32_bf16 v[140:143], a[0:3], v[60:63], v[140:143]
    ds_read_b64_tr_b16 a[22:23], v7 offset:7680
    buffer_load_dwordx4 v[84:87], v5, s[48:51], s84 offen offset:2560 sc1
    v_mfma_f32_16x16x32_bf16 v[124:127], a[4:7], v[56:59], v[124:127]
    ds_read_b64_tr_b16 a[0:1], v7 offset:5152
    v_mul_u32_u24 v2, 6554, v1
    v_mfma_f32_16x16x32_bf16 v[144:147], a[4:7], v[60:63], v[144:147]
    ds_read_b64_tr_b16 a[2:3], v7 offset:7712
    v_lshrrev_b32 v2, 16, v2
    s_waitcnt lgkmcnt(6)
    v_mfma_f32_16x16x32_bf16 v[128:131], a[8:11], v[56:59], v[128:131]
    ds_read_b64_tr_b16 a[4:5], v7 offset:5184
    v_lshlrev_b32 v1, 4, v1
    v_mfma_f32_16x16x32_bf16 v[148:151], a[8:11], v[60:63], v[148:151]
    ds_read_b64_tr_b16 a[6:7], v7 offset:7744
    v_mad_u32_u24 v15, v2, 16, v1
    v_mfma_f32_16x16x32_bf16 v[132:135], a[12:15], v[56:59], v[132:135]
    ds_read_b64_tr_b16 a[8:9], v7 offset:5216
    v_add_u32 v15, s95, v15
    v_mfma_f32_16x16x32_bf16 v[152:155], a[12:15], v[60:63], v[152:155]
    ds_read_b64_tr_b16 a[10:11], v7 offset:7776
    v_mad_u32_u24 v18, v2, s14, v1
    s_waitcnt lgkmcnt(6)
    v_mfma_f32_16x16x32_bf16 v[136:139], a[16:19], v[56:59], v[136:139]
    ds_read_b64_tr_b16 a[12:13], v7 offset:5248
    v_add_u32 v18, s96, v18
    v_mfma_f32_16x16x32_bf16 v[156:159], a[16:19], v[60:63], v[156:159]
    ds_read_b64_tr_b16 a[14:15], v7 offset:7808
    v_add_u32 v1, 64, v0
    s_waitcnt vmcnt(4)
    v_mfma_f32_16x16x32_bf16 v[120:123], a[20:23], v[64:67], v[120:123]
    ds_read_b64_tr_b16 a[16:17], v8 offset:0
    buffer_load_dwordx4 v[88:91], v4, s[48:51], s85 offen offset:0 sc1
    v_mfma_f32_16x16x32_bf16 v[140:143], a[20:23], v[68:71], v[140:143]
    ds_read_b64_tr_b16 a[18:19], v8 offset:2560
    buffer_load_dwordx4 v[92:95], v5, s[48:51], s85 offen offset:0 sc1
    s_waitcnt lgkmcnt(6)
    v_mfma_f32_16x16x32_bf16 v[124:127], a[0:3], v[64:67], v[124:127]
    ds_read_b64_tr_b16 a[20:21], v8 offset:32
    v_mul_u32_u24 v2, 6554, v1
    v_mfma_f32_16x16x32_bf16 v[144:147], a[0:3], v[68:71], v[144:147]
    ds_read_b64_tr_b16 a[22:23], v8 offset:2592
    v_lshrrev_b32 v2, 16, v2
    v_mfma_f32_16x16x32_bf16 v[128:131], a[4:7], v[64:67], v[128:131]
    ds_read_b64_tr_b16 a[0:1], v8 offset:64
    v_lshlrev_b32 v1, 4, v1
    v_mfma_f32_16x16x32_bf16 v[148:151], a[4:7], v[68:71], v[148:151]
    ds_read_b64_tr_b16 a[2:3], v8 offset:2624
    v_mad_u32_u24 v16, v2, 16, v1
    s_waitcnt lgkmcnt(6)
    v_mfma_f32_16x16x32_bf16 v[132:135], a[8:11], v[64:67], v[132:135]
    ds_read_b64_tr_b16 a[4:5], v8 offset:96
    v_add_u32 v16, s95, v16
    v_mfma_f32_16x16x32_bf16 v[152:155], a[8:11], v[68:71], v[152:155]
    ds_read_b64_tr_b16 a[6:7], v8 offset:2656
    v_mad_u32_u24 v19, v2, s14, v1
    v_mfma_f32_16x16x32_bf16 v[136:139], a[12:15], v[64:67], v[136:139]
    ds_read_b64_tr_b16 a[8:9], v8 offset:128
    v_add_u32 v19, s96, v19
    v_mfma_f32_16x16x32_bf16 v[156:159], a[12:15], v[68:71], v[156:159]
    ds_read_b64_tr_b16 a[10:11], v8 offset:2688
    v_add_u32 v1, 128, v0
    s_waitcnt vmcnt(4)
    s_setprio 2
    s_waitcnt lgkmcnt(6)
    v_mfma_f32_16x16x32_bf16 v[120:123], a[16:19], v[72:75], v[120:123]
    ds_read_b64_tr_b16 a[12:13], v8 offset:5120
    buffer_load_dwordx4 v[96:99], v4, s[48:51], s85 offen offset:2560 sc1
    v_mfma_f32_16x16x32_bf16 v[140:143], a[16:19], v[76:79], v[140:143]
    ds_read_b64_tr_b16 a[14:15], v8 offset:7680
    buffer_load_dwordx4 v[100:103], v5, s[48:51], s85 offen offset:2560 sc1
    v_mfma_f32_16x16x32_bf16 v[124:127], a[20:23], v[72:75], v[124:127]
    ds_read_b64_tr_b16 a[16:17], v8 offset:5152
    v_mul_u32_u24 v2, 6554, v1
    v_mfma_f32_16x16x32_bf16 v[144:147], a[20:23], v[76:79], v[144:147]
    ds_read_b64_tr_b16 a[18:19], v8 offset:7712
    v_lshrrev_b32 v2, 16, v2
    s_waitcnt lgkmcnt(6)
    v_mfma_f32_16x16x32_bf16 v[128:131], a[0:3], v[72:75], v[128:131]
    ds_read_b64_tr_b16 a[20:21], v8 offset:5184
    v_lshlrev_b32 v1, 4, v1
    v_mfma_f32_16x16x32_bf16 v[148:151], a[0:3], v[76:79], v[148:151]
    ds_read_b64_tr_b16 a[22:23], v8 offset:7744
    v_mad_u32_u24 v17, v2, 16, v1
    v_mfma_f32_16x16x32_bf16 v[132:135], a[4:7], v[72:75], v[132:135]
    ds_read_b64_tr_b16 a[0:1], v8 offset:5216
    v_add_u32 v17, s95, v17
    v_mfma_f32_16x16x32_bf16 v[152:155], a[4:7], v[76:79], v[152:155]
    ds_read_b64_tr_b16 a[2:3], v8 offset:7776
    v_mad_u32_u24 v20, v2, s14, v1
    s_waitcnt lgkmcnt(6)
    v_mfma_f32_16x16x32_bf16 v[136:139], a[8:11], v[72:75], v[136:139]
    ds_read_b64_tr_b16 a[4:5], v8 offset:5248
    v_add_u32 v20, s96, v20
    v_mfma_f32_16x16x32_bf16 v[156:159], a[8:11], v[76:79], v[156:159]
    ds_read_b64_tr_b16 a[6:7], v8 offset:7808
    s_waitcnt vmcnt(4)
    v_mfma_f32_16x16x32_bf16 v[120:123], a[12:15], v[80:83], v[120:123]
    ds_read_b64_tr_b16 a[8:9], v9 offset:0
    s_add_u32 s15, s86, 0
    buffer_load_dwordx2 v[104:105], v21, s[48:51], s15 offen offset:1024 sc1
    v_mfma_f32_16x16x32_bf16 v[140:143], a[12:15], v[84:87], v[140:143]
    ds_read_b64_tr_b16 a[10:11], v9 offset:2560
    s_add_u32 s15, s86, 0
    buffer_load_dwordx2 v[108:109], v22, s[48:51], s15 offen offset:1024 sc1
    s_waitcnt lgkmcnt(6)
    v_mfma_f32_16x16x32_bf16 v[124:127], a[16:19], v[80:83], v[124:127]
    ds_read_b64_tr_b16 a[12:13], v9 offset:32
    s_add_u32 s15, s86, 5120
    buffer_load_dwordx2 v[106:107], v21, s[48:51], s15 offen offset:1024 sc1
    v_mfma_f32_16x16x32_bf16 v[144:147], a[16:19], v[84:87], v[144:147]
    ds_read_b64_tr_b16 a[14:15], v9 offset:2592
    s_add_u32 s15, s86, 5120
    buffer_load_dwordx2 v[110:111], v22, s[48:51], s15 offen offset:1024 sc1
    v_mfma_f32_16x16x32_bf16 v[128:131], a[20:23], v[80:83], v[128:131]
    ds_read_b64_tr_b16 a[16:17], v9 offset:64
    v_mfma_f32_16x16x32_bf16 v[148:151], a[20:23], v[84:87], v[148:151]
    ds_read_b64_tr_b16 a[18:19], v9 offset:2624
    s_waitcnt lgkmcnt(6)
    v_mfma_f32_16x16x32_bf16 v[132:135], a[0:3], v[80:83], v[132:135]
    ds_read_b64_tr_b16 a[20:21], v9 offset:96
    v_mfma_f32_16x16x32_bf16 v[152:155], a[0:3], v[84:87], v[152:155]
    ds_read_b64_tr_b16 a[22:23], v9 offset:2656
    v_mfma_f32_16x16x32_bf16 v[136:139], a[4:7], v[80:83], v[136:139]
    ds_read_b64_tr_b16 a[0:1], v9 offset:128
    v_mfma_f32_16x16x32_bf16 v[156:159], a[4:7], v[84:87], v[156:159]
    ds_read_b64_tr_b16 a[2:3], v9 offset:2688
    s_waitcnt vmcnt(6)
    s_setprio 1
    s_waitcnt lgkmcnt(6)
    v_mfma_f32_16x16x32_bf16 v[120:123], a[8:11], v[88:91], v[120:123]
    ds_read_b64_tr_b16 a[4:5], v9 offset:5120
    s_add_u32 s15, s86, 10240
    buffer_load_dwordx2 v[112:113], v21, s[48:51], s15 offen offset:1024 sc1
    v_mfma_f32_16x16x32_bf16 v[140:143], a[8:11], v[92:95], v[140:143]
    ds_read_b64_tr_b16 a[6:7], v9 offset:7680
    s_add_u32 s15, s86, 10240
    buffer_load_dwordx2 v[116:117], v22, s[48:51], s15 offen offset:1024 sc1
    v_mfma_f32_16x16x32_bf16 v[124:127], a[12:15], v[88:91], v[124:127]
    ds_read_b64_tr_b16 a[8:9], v9 offset:5152
    s_add_u32 s15, s86, 15360
    buffer_load_dwordx2 v[114:115], v21, s[48:51], s15 offen offset:1024 sc1
    v_mfma_f32_16x16x32_bf16 v[144:147], a[12:15], v[92:95], v[144:147]
    ds_read_b64_tr_b16 a[10:11], v9 offset:7712
    s_add_u32 s15, s86, 15360
    buffer_load_dwordx2 v[118:119], v22, s[48:51], s15 offen offset:1024 sc1
    s_waitcnt lgkmcnt(6)
    v_mfma_f32_16x16x32_bf16 v[128:131], a[16:19], v[88:91], v[128:131]
    ds_read_b64_tr_b16 a[12:13], v9 offset:5184
    v_mfma_f32_16x16x32_bf16 v[148:151], a[16:19], v[92:95], v[148:151]
    ds_read_b64_tr_b16 a[14:15], v9 offset:7744
    v_mfma_f32_16x16x32_bf16 v[132:135], a[20:23], v[88:91], v[132:135]
    ds_read_b64_tr_b16 a[16:17], v9 offset:5216
    v_mfma_f32_16x16x32_bf16 v[152:155], a[20:23], v[92:95], v[152:155]
    ds_read_b64_tr_b16 a[18:19], v9 offset:7776
    s_waitcnt lgkmcnt(6)
    v_mfma_f32_16x16x32_bf16 v[136:139], a[0:3], v[88:91], v[136:139]
    ds_read_b64_tr_b16 a[20:21], v9 offset:5248
    v_mfma_f32_16x16x32_bf16 v[156:159], a[0:3], v[92:95], v[156:159]
    ds_read_b64_tr_b16 a[22:23], v9 offset:7808
    s_waitcnt vmcnt(8)
    v_mfma_f32_16x16x32_bf16 v[120:123], a[4:7], v[96:99], v[120:123]
    ds_read_b64_tr_b16 a[24:25], v10 offset:0
    v_mfma_f32_16x16x32_bf16 v[140:143], a[4:7], v[100:103], v[140:143]
    ds_read_b64_tr_b16 a[26:27], v10 offset:2560
    s_waitcnt lgkmcnt(6)
    v_mfma_f32_16x16x32_bf16 v[124:127], a[8:11], v[96:99], v[124:127]
    ds_read_b64_tr_b16 a[28:29], v10 offset:32
    v_mfma_f32_16x16x32_bf16 v[144:147], a[8:11], v[100:103], v[144:147]
    ds_read_b64_tr_b16 a[30:31], v10 offset:2592
    v_mfma_f32_16x16x32_bf16 v[128:131], a[12:15], v[96:99], v[128:131]
    ds_read_b64_tr_b16 a[32:33], v10 offset:64
    v_mfma_f32_16x16x32_bf16 v[148:151], a[12:15], v[100:103], v[148:151]
    ds_read_b64_tr_b16 a[34:35], v10 offset:2624
    s_waitcnt lgkmcnt(6)
    v_mfma_f32_16x16x32_bf16 v[132:135], a[16:19], v[96:99], v[132:135]
    ds_read_b64_tr_b16 a[36:37], v10 offset:96
    v_mfma_f32_16x16x32_bf16 v[152:155], a[16:19], v[100:103], v[152:155]
    ds_read_b64_tr_b16 a[38:39], v10 offset:2656
    v_mfma_f32_16x16x32_bf16 v[136:139], a[20:23], v[96:99], v[136:139]
    ds_read_b64_tr_b16 a[40:41], v10 offset:128
    v_mfma_f32_16x16x32_bf16 v[156:159], a[20:23], v[100:103], v[156:159]
    ds_read_b64_tr_b16 a[42:43], v10 offset:2688
    s_waitcnt vmcnt(4)
    s_setprio 0
    s_waitcnt lgkmcnt(6)
    v_mfma_f32_16x16x32_bf16 v[120:123], a[24:27], v[104:107], v[120:123]
    ds_read_b64_tr_b16 a[44:45], v10 offset:5120
    ds_read_b64_tr_b16 a[46:47], v10 offset:7680
    v_mfma_f32_16x16x32_bf16 v[124:127], a[28:31], v[104:107], v[124:127]
    ds_read_b64_tr_b16 a[48:49], v10 offset:5152
    ds_read_b64_tr_b16 a[50:51], v10 offset:7712
    s_waitcnt lgkmcnt(6)
    v_mfma_f32_16x16x32_bf16 v[128:131], a[32:35], v[104:107], v[128:131]
    ds_read_b64_tr_b16 a[52:53], v10 offset:5184
    ds_read_b64_tr_b16 a[54:55], v10 offset:7744
    v_mfma_f32_16x16x32_bf16 v[132:135], a[36:39], v[104:107], v[132:135]
    ds_read_b64_tr_b16 a[56:57], v10 offset:5216
    ds_read_b64_tr_b16 a[58:59], v10 offset:7776
    s_waitcnt lgkmcnt(6)
    v_mfma_f32_16x16x32_bf16 v[136:139], a[40:43], v[104:107], v[136:139]
    ds_read_b64_tr_b16 a[60:61], v10 offset:5248
    ds_read_b64_tr_b16 a[62:63], v10 offset:7808
    s_waitcnt vmcnt(0)
    s_lshl_b32 s76, s55, 1
    s_add_u32 s76, s76, s13
    s_add_u32 s76, s76, 8
    s_lshl_b32 s76, s76, 2
    s_add_u32 s76, s76, s19
    v_mov_b32 v3, 1
    s_mov_b64 exec, 1
    s_cmp_eq_u32 s80, s98
    s_cbranch_scc1 LP2_dn_l2
    buffer_store_dword v3, off, s[36:39], s76 sc1
    s_branch LP2_dn_e
LP2_dn_l2:
    buffer_store_dword v3, off, s[36:39], s76
LP2_dn_e:
    s_mov_b64 exec, -1
    v_mfma_f32_16x16x32_bf16 v[120:123], a[44:47], v[112:115], v[120:123]
    s_waitcnt lgkmcnt(4)
    v_mfma_f32_16x16x32_bf16 v[124:127], a[48:51], v[112:115], v[124:127]
    v_mfma_f32_16x16x32_bf16 v[128:131], a[52:55], v[112:115], v[128:131]
    s_waitcnt lgkmcnt(0)
    v_mfma_f32_16x16x32_bf16 v[132:135], a[56:59], v[112:115], v[132:135]
    v_mfma_f32_16x16x32_bf16 v[136:139], a[60:63], v[112:115], v[136:139]
    v_mfma_f32_16x16x32_bf16 v[140:143], a[24:27], v[108:111], v[140:143]
    v_mfma_f32_16x16x32_bf16 v[144:147], a[28:31], v[108:111], v[144:147]
    ds_write_b128 v12, v[120:123] offset:0
    v_mfma_f32_16x16x32_bf16 v[148:151], a[32:35], v[108:111], v[148:151]
    ds_write_b128 v12, v[124:127] offset:1024
    v_mfma_f32_16x16x32_bf16 v[152:155], a[36:39], v[108:111], v[152:155]
    ds_write_b128 v12, v[128:131] offset:2048
    v_mfma_f32_16x16x32_bf16 v[156:159], a[40:43], v[108:111], v[156:159]
    ds_write_b128 v12, v[132:135] offset:3072
    v_mfma_f32_16x16x32_bf16 v[140:143], a[44:47], v[116:119], v[140:143]
    ds_write_b128 v12, v[136:139] offset:4096
    v_mfma_f32_16x16x32_bf16 v[144:147], a[48:51], v[116:119], v[144:147]
    v_mfma_f32_16x16x32_bf16 v[148:151], a[52:55], v[116:119], v[148:151]
    v_mfma_f32_16x16x32_bf16 v[152:155], a[56:59], v[116:119], v[152:155]
    v_mfma_f32_16x16x32_bf16 v[156:159], a[60:63], v[116:119], v[156:159]
    s_waitcnt lgkmcnt(0)
    s_barrier
    s_mov_b64 exec, 0xffff
    buffer_load_dword v3, v11, s[36:39], s19 offen offset:32 sc1
    s_mov_b64 exec, -1
    ds_read_b128 v[40:43], v13 offset:0
    ds_read_b128 v[44:47], v13 offset:1024
    ds_read_b128 v[48:51], v13 offset:2048
    ds_read_b128 v[52:55], v13 offset:3072
    ds_read_b128 v[56:59], v13 offset:4096
    s_waitcnt lgkmcnt(4)
    v_add_f32 v140, v140, v40
    v_add_f32 v141, v141, v41
    v_add_f32 v142, v142, v42
    v_add_f32 v143, v143, v43
    v_cvt_pk_bf16_f32 v140, v140, v141
    v_cvt_pk_bf16_f32 v141, v142, v143
    s_waitcnt lgkmcnt(3)
    v_add_f32 v144, v144, v44
    v_add_f32 v145, v145, v45
    v_add_f32 v146, v146, v46
    v_add_f32 v147, v147, v47
    v_cvt_pk_bf16_f32 v144, v144, v145
    v_cvt_pk_bf16_f32 v145, v146, v147
    s_waitcnt lgkmcnt(2)
    v_add_f32 v148, v148, v48
    v_add_f32 v149, v149, v49
    v_add_f32 v150, v150, v50
    v_add_f32 v151, v151, v51
    v_cvt_pk_bf16_f32 v148, v148, v149
    v_cvt_pk_bf16_f32 v149, v150, v151
    s_waitcnt lgkmcnt(1)
    v_add_f32 v152, v152, v52
    v_add_f32 v153, v153, v53
    v_add_f32 v154, v154, v54
    v_add_f32 v155, v155, v55
    v_cvt_pk_bf16_f32 v152, v152, v153
    v_cvt_pk_bf16_f32 v153, v154, v155
    s_waitcnt lgkmcnt(0)
    v_add_f32 v156, v156, v56
    v_add_f32 v157, v157, v57
    v_add_f32 v158, v158, v58
    v_add_f32 v159, v159, v59
    v_cvt_pk_bf16_f32 v156, v156, v157
    v_cvt_pk_bf16_f32 v157, v158, v159
    ds_write_b64 v14, v[140:141] offset:0
    ds_write_b64 v14, v[144:145] offset:32
    ds_write_b64 v14, v[148:149] offset:64
    ds_write_b64 v14, v[152:153] offset:96
    ds_write_b64 v14, v[156:157] offset:128
    s_waitcnt lgkmcnt(0)
    ds_read_b128 v[40:43], v15
    ds_read_b128 v[44:47], v16
    ds_read_b128 v[48:51], v17
    s_mov_b32 s12, 0
LP2_dw:
    s_waitcnt vmcnt(0)
    s_mov_b64 exec, 0xffff
    v_cmp_ne_u32 vcc, 1, v3
    s_mov_b64 exec, -1
    s_cbranch_vccz LP2_dok
    s_mov_b64 exec, 0xffff
    buffer_load_dword v3, v11, s[36:39], s19 offen offset:32 sc1
    s_mov_b64 exec, -1
    s_add_u32 s12, s12, 1
    s_cmp_lt_u32 s12, 32768
    s_cbranch_scc1 LP2_dw
LP2_dok:
    s_waitcnt lgkmcnt(2)
    buffer_store_dwordx4 v[40:43], v18, s[48:51], 0 offen nt
    s_waitcnt lgkmcnt(1)
    buffer_store_dwordx4 v[44:47], v19, s[48:51], 0 offen nt
    s_waitcnt lgkmcnt(0)
    s_mov_b64 exec, 0xffffffff
    buffer_store_dwordx4 v[48:51], v20, s[48:51], 0 offen nt
    s_endpgm
L_end:
    s_endpgm
.section .rodata,"a"
.p2align 6
.amdhsa_kernel concat_heads__linear_attn_block__sliding_local_dilated__prompt_kernel
  .amdhsa_next_free_vgpr 256
  .amdhsa_next_free_sgpr 102
  .amdhsa_accum_offset 184
  .amdhsa_group_segment_fixed_size 0
  .amdhsa_kernarg_size 72
  .amdhsa_user_sgpr_count 2
  .amdhsa_user_sgpr_kernarg_segment_ptr 1
  .amdhsa_system_sgpr_workgroup_id_x 1
.end_amdhsa_kernel
```
